```python
import torch

def _softmax(x, axis=-1):
    return torch.softmax(x, dim=axis)
def _gelu(x):
    return torch.nn.functional.gelu(x, approximate="tanh")
def _silu(x):
    return torch.nn.functional.silu(x)
def _sigmoid(x):
    return torch.sigmoid(x)
def _layernorm(x, axis=-1, eps=1e-5):
    m = x.mean(dim=axis, keepdim=True)
    v = x.var(dim=axis, keepdim=True, unbiased=False)
    return (x - m) / torch.sqrt(v + eps)
def _scatter_add(tgt, idx, src, axis=0):
    return tgt.clone().index_add_(axis, idx, src)
def _segment_sum(src, seg, n):
    out = torch.zeros((n,) + src.shape[1:], dtype=src.dtype)
    return out.index_add_(0, seg, src)
def _pad(x, pw):
    flat = tuple(v for pair in reversed(pw) for v in pair)
    return torch.nn.functional.pad(x, flat)

kernel_name = 'sequential_preLN__ssm_conv_s4__dense_activation_relu__prompt'

def setup_inputs():

    _w = (lambda a: (lambda t: t.to(torch.bfloat16) if t.is_floating_point() else t)(torch.as_tensor(a)))
    def _A_setup():
        B, L, D, N = 1, 2048, 576, 128
        A_re = -(lambda _x: torch.exp(torch.as_tensor(_x)))((lambda *s: torch.randn(*s, dtype=torch.bfloat16) * 6.4)(D, N))
        A_im = torch.pi * (lambda *s: torch.randn(*s, dtype=torch.bfloat16) * 0.05)(D, N)
        B_re = (lambda *s: torch.randn(*s, dtype=torch.bfloat16) * 0.05)(D, N)
        B_im = (lambda *s: torch.randn(*s, dtype=torch.bfloat16) * 0.05)(D, N)
        C_re = (lambda *s: torch.randn(*s, dtype=torch.bfloat16) * 0.05)(D, N)
        C_im = (lambda *s: torch.randn(*s, dtype=torch.bfloat16) * 0.05)(D, N)
        log_dt = (lambda *s: torch.randn(*s, dtype=torch.bfloat16) * 0.05)(D) * 0.5 - 4.0
        Dskip = (lambda *s: torch.randn(*s, dtype=torch.bfloat16) * 0.05)(D)
        return {
            "u": _w((lambda *s: torch.randn(*s, dtype=torch.bfloat16) * 0.05)(B, L, D)),
            "A_re": _w(A_re),
            "A_im": _w(A_im),
            "B_re": _w(B_re),
            "B_im": _w(B_im),
            "C_re": _w(C_re),
            "C_im": _w(C_im),
            "log_dt": _w(log_dt),
            "Dskip": _w(Dskip),
        }
    _A_in = _A_setup()

    def _B_setup():
        B, S, D, Dff = 1, 2048, 576, 4608
        return {
            "x": _w((lambda *s: torch.randn(*s, dtype=torch.bfloat16) * 0.05)(B, S, D)),
            "w1": _w((lambda *s: torch.randn(*s, dtype=torch.bfloat16) * 0.05)(D, Dff)),
            "w2": _w((lambda *s: torch.randn(*s, dtype=torch.bfloat16) * 0.05)(Dff, D)),
        }
    _B_in = _B_setup()

    return {
        "A_u": _A_in["u"],
        "A_A_re": _A_in["A_re"],
        "A_A_im": _A_in["A_im"],
        "A_B_re": _A_in["B_re"],
        "A_B_im": _A_in["B_im"],
        "A_C_re": _A_in["C_re"],
        "A_C_im": _A_in["C_im"],
        "A_log_dt": _A_in["log_dt"],
        "A_Dskip": _A_in["Dskip"],
        "B_x": _B_in["x"],
        "B_w1": _B_in["w1"],
        "B_w2": _B_in["w2"],
    }

def reference(A_u, A_A_re, A_A_im, A_B_re, A_B_im, A_C_re, A_C_im, A_log_dt, A_Dskip, B_x, B_w1, B_w2):
    def _A_ref(u, A_re, A_im, B_re, B_im, C_re, C_im, log_dt, Dskip):
        Bsz, L, D = u.shape
        dt = torch.exp(log_dt)[:, None]
        A = A_re + 1j * A_im
        Bc = B_re + 1j * B_im
        Cc = C_re + 1j * C_im
        logdA = dt * A
        dB = dt * Bc
        l = (lambda x, dt: x.to(dt))(torch.arange(L), A_re.dtype)
        P = torch.exp(logdA[:, :, None] * l[None, None, :])
        K = torch.einsum("dn,dnl,dn->dl", Cc, P, dB).real
        L2 = 2 * L
        Kp = _pad(K, ((0, 0), (0, L)))
        up = (lambda x, *d: x.permute(*d))(u, 0, 2, 1)
        up = _pad(up, ((0, 0), (0, 0), (0, L)))
        Kf = (lambda x, axes=(-2,-1): torch.fft.rfft2(x.float(), dim=axes))(Kp[:, None, :], axes=(-2, -1))
        Uf = (lambda x, axes=(-2,-1): torch.fft.rfft2(x.float(), dim=axes))(up[:, :, None, :], axes=(-2, -1))
        Yf = Uf * Kf[None, :, :, :]
        y = (lambda x, s, axes=(-2,-1): torch.fft.irfft2(x, s=s, dim=axes).to(torch.bfloat16))(Yf, (1, L2), axes=(-2, -1))[:, :, 0, :L]
        y = (lambda x, *d: x.permute(*d))(y, 0, 2, 1) + u * Dskip[None, None, :]
        return y

    def _B_ref(x, w1, w2):
        h = torch.einsum("bsd,df->bsf", x, w1)
        zero = torch.zeros_like(h)
        h = torch.maximum(h, zero)
        return torch.einsum("bsf,fd->bsd", h, w2)

    x = A_u
    h = x + _A_ref(_layernorm(x, axis=-1), A_A_re, A_A_im, A_B_re, A_B_im, A_C_re, A_C_im, A_log_dt, A_Dskip)
    h2 = h + _B_ref(_layernorm(h, axis=-1), B_w1, B_w2)
    return h2
```

```asm
; @launch grid=(256,1,1) block=(256,1,1) lds=160768
.amdgcn_target "amdgcn-amd-amdhsa--gfx950"
.text
.globl sequential_preLN__ssm_conv_s4__dense_activation_relu__prompt_kernel
.p2align 8
.type sequential_preLN__ssm_conv_s4__dense_activation_relu__prompt_kernel,@function
sequential_preLN__ssm_conv_s4__dense_activation_relu__prompt_kernel:
    s_cmp_ge_u32 s2, 256
    s_cbranch_scc1 L_end
    s_load_dwordx16 s[4:19], s[0:1], 0
    s_load_dwordx2 s[20:21], s[0:1], 64
    s_load_dwordx4 s[24:27], s[0:1], 80
    s_load_dwordx2 s[22:23], s[0:1], 112
    s_load_dwordx2 s[62:63], s[0:1], 96
    v_lshrrev_b32 v1, 6, v0
    v_and_b32 v2, 63, v0
    s_and_b32 s28, s2, 7
    v_readfirstlane_b32 s30, v1
    s_lshr_b32 s29, s2, 3
    s_mul_i32 s31, s28, 72
    s_lshl_b32 s32, s29, 2
    s_add_u32 s31, s31, s32
    s_add_u32 s33, s31, s30
    s_lshl_b32 s34, s33, 8
    s_lshl_b32 s35, s33, 1
    s_and_b32 s35, s35, 0xfffc
    v_lshl_add_u32 v3, v2, 2, s34
    v_lshlrev_b32 v4, 4, v0
    v_lshrrev_b32 v8, 5, v2
    v_and_b32 v6, 31, v2
    v_mul_u32_u24 v5, 1152, v8
    v_mad_u32_u24 v5, v6, 12, v5
    s_lshl_b32 s36, s2, 2
    s_add_u32 s36, s36, s30
    s_mul_i32 s36, s36, 2304
    v_add_u32 v5, s36, v5
    v_and_b32 v6, 15, v2
    v_mul_u32_u24 v6, 1152, v6
    v_bfe_u32 v7, v2, 4, 1
    v_lshl_add_u32 v6, v7, 7, v6
    s_add_u32 s36, s32, s30
    s_mul_i32 s36, s36, 18432
    s_lshl_b32 s37, s28, 7
    s_add_u32 s36, s36, s37
    v_add_u32 v6, s36, v6
    s_min_u32 s35, s35, 1148
    s_lshl_b32 s36, s2, 2
    s_add_u32 s36, s36, s30
    s_lshl_b32 s36, s36, 7
    s_add_u32 s36, s36, 13107200
    s_lshl_b32 s37, s28, 4
    s_add_u32 s37, s37, s29
    s_lshl_b32 s37, s37, 7
    s_add_u32 s37, s37, 10700544
    s_mul_i32 s38, s28, 20
    s_add_u32 s38, s38, s29
    s_lshl_b32 s38, s38, 7
    s_add_u32 s38, s38, 10682368
    s_cmp_lt_u32 s29, 18
    s_cselect_b32 s37, s38, s37
    v_mov_b32 v44, s36
    s_add_u32 s38, s37, 16384
    s_add_u32 s39, s37, 128
    v_writelane_b32 v44, s37, 1
    v_writelane_b32 v44, s38, 2
    v_writelane_b32 v44, s39, 3
    s_waitcnt lgkmcnt(0)
    global_load_dwordx3 v[16:18], v5, s[4:5]
    s_add_u32 s56, s22, 10743808
    s_addc_u32 s57, s23, 0
    s_load_dword s58, s[56:57], 0
    s_load_dword s59, s[18:19], s35
    global_load_dwordx3 v[20:22], v5, s[4:5] offset:384
    global_load_dwordx3 v[24:26], v5, s[4:5] offset:768
    global_load_dword v47, v6, s[4:5]
    s_cmp_ge_u32 s29, 18
    s_cbranch_scc1 L_nopar
    global_load_dword v48, v3, s[6:7]
    global_load_dword v49, v3, s[8:9]
    s_barrier
    global_load_dword v50, v3, s[10:11]
    global_load_dword v51, v3, s[12:13]
    global_load_dword v52, v3, s[14:15]
    global_load_dword v53, v3, s[16:17]
    global_load_dword v44, v44, s[22:23]
    s_mov_b32 s40, s4
    s_and_b32 s41, s5, 0xffff
    s_mov_b32 s42, 2359296
    s_mov_b32 s43, 0x20000
    s_mul_i32 s38, s30, 33792
    s_add_u32 s38, s38, 256
    v_mul_u32_u24 v5, 9216, v0
    s_lshl_b32 s37, s31, 1
    v_add_u32 v5, s37, v5
    v_lshl_add_u32 v7, v2, 3, s38
    v_and_b32 v126, 31, v2
    v_mul_u32_u24 v126, 528, v126
    v_lshl_add_u32 v126, v8, 4, v126
    v_add_u32 v126, s38, v126
    v_sub_u32 v9, 63, v2
    v_lshl_add_u32 v9, v9, 4, s38
    v_and_b32 v104, 15, v2
    v_lshrrev_b32 v105, 4, v2
    v_sub_u32 v120, 3, v104
    v_and_b32 v120, 3, v120
    v_mul_u32_u24 v121, 4160, v120
    v_add_u32 v120, v120, v104
    v_sub_u32 v120, 15, v120
    v_lshl_add_u32 v120, v105, 3, v120
    v_lshl_add_u32 v120, v120, 1, v121
    v_add_u32 v120, s38, v120
    v_lshlrev_b32 v106, 5, v104
    v_lshl_add_u32 v121, v105, 4, v106
    s_mul_i32 s39, s30, 4608
    s_add_u32 s39, s39, 135424
    v_min_u32 v107, 29, v2
    v_lshl_add_u32 v107, v107, 4, s39
    v_add_u32 v121, s39, v121
    v_and_b32 v108, 1, v105
    v_lshl_add_u32 v122, v108, 4, v106
    s_add_u32 s39, s38, 16640
    v_add_u32 v122, s39, v122
    v_lshl_add_u32 v123, v108, 9, v106
    v_and_b32 v108, 2, v105
    v_lshl_add_u32 v123, v108, 3, v123
    v_mov_b32 v112, 0
    v_mov_b32 v113, 0
    v_mov_b32 v114, 0
    v_mov_b32 v115, 0
    ds_write_b128 v107, v[112:115]
    v_bfe_u32 v127, v2, 1, 2
    v_mul_u32_u24 v127, 4160, v127
    v_and_b32 v110, 1, v2
    v_lshl_add_u32 v127, v110, 4, v127
    v_add_u32 v127, s38, v127
    v_cmp_eq_u32 s[52:53], 1, v110
    v_cmp_lt_u32 s[54:55], 31, v2
    v_add_u32 v124, 135904, v4
    v_add_u32 v125, 16896, v4
    s_bfe_u32 s36, s31, 0x20003
    s_mul_i32 s36, s36, 36
    s_lshr_b32 s37, s31, 5
    s_lshl_b32 s37, s37, 1
    s_add_u32 s36, s36, s37
    s_bfe_u32 s37, s31, 0x10002
    s_add_u32 s36, s36, s37
    s_lshl_b32 s61, s36, 4
    s_mov_b32 s48, 0
    s_movk_i32 s49, 4096
    s_movk_i32 s50, 8192
    s_movk_i32 s51, 12288
L_wret0:
    s_branch L_stats
L_nopar:
    s_getpc_b64 s[36:37]
L_pc:
    s_sub_u32 s36, s36, L_pc-sequential_preLN__ssm_conv_s4__dense_activation_relu__prompt_kernel
    s_subb_u32 s37, s37, 0
    s_sub_u32 s39, s29, 18
    s_lshl_b32 s32, s39, 2
    s_add_u32 s32, s32, s30
    s_lshl_b32 s32, s32, 10
    v_and_b32 v6, 7, v2
    v_lshl_add_u32 v6, v6, 7, s32
    v_min_u32 v6, 0xaf58, v6
    global_load_dword v46, v6, s[36:37]
    global_load_dword v44, v44, s[22:23]
    s_mov_b32 s40, s24
    s_and_b32 s41, s25, 0xffff
    s_mov_b32 s42, 5308416
    s_mov_b32 s43, 0x20000
    s_mov_b32 s8, s26
    s_and_b32 s9, s27, 0xffff
    s_mov_b32 s10, 5308416
    s_mov_b32 s11, 0x20000
    s_lshl_b32 s33, s39, 2
    s_add_u32 s33, s33, s30
    s_mul_i32 s33, s33, 73728
    s_mul_i32 s34, s28, 1152
    s_add_u32 s6, s33, s34
    v_and_b32 v7, 7, v2
    v_lshrrev_b32 v9, 3, v2
    v_mul_u32_u24 v13, 9216, v7
    v_lshl_add_u32 v12, v9, 7, v13
    buffer_load_dword v45, v12, s[40:43], s6 offen
    buffer_load_dword v45, v13, s[40:43], s6 offen offset:1024
    s_add_u32 s7, s6, 4128768
    s_mov_b32 s52, s40
    s_mov_b32 s53, s41
    s_mov_b32 s54, s42
    s_mov_b32 s55, 0x20000
    v_mul_u32_u24 v27, 1152, v7
    s_cmp_lt_u32 s39, 4
    s_cbranch_scc1 L_src1
    s_sub_u32 s36, s39, 4
    s_lshr_b32 s32, s36, 2
    s_lshl_b32 s32, s32, 4
    s_and_b32 s33, s36, 3
    s_lshl_b32 s33, s33, 7
    s_add_u32 s32, s32, s33
    s_lshr_b32 s33, s30, 1
    s_lshl_b32 s33, s33, 6
    s_add_u32 s32, s32, s33
    s_and_b32 s33, s30, 1
    s_lshl_b32 s33, s33, 3
    s_add_u32 s32, s32, s33
    s_mul_i32 s33, s28, 576
    s_add_u32 s32, s32, s33
    s_mul_i32 s7, s32, 1152
    s_mov_b32 s52, s8
    s_mov_b32 s53, s9
    v_mov_b32 v13, v27
    v_lshl_add_u32 v12, v9, 7, v13
L_src1:
    s_branch L_other
L_stats:
    s_waitcnt vmcnt(8)
    v_lshlrev_b32 v28, 16, v16
    v_and_b32 v29, 0xffff0000, v16
    v_lshlrev_b32 v30, 16, v17
    v_and_b32 v31, 0xffff0000, v17
    v_lshlrev_b32 v32, 16, v18
    v_and_b32 v33, 0xffff0000, v18
    v_lshlrev_b32 v34, 16, v20
    v_and_b32 v35, 0xffff0000, v20
    v_lshlrev_b32 v36, 16, v21
    v_and_b32 v37, 0xffff0000, v21
    v_lshlrev_b32 v38, 16, v22
    v_and_b32 v39, 0xffff0000, v22
    v_lshlrev_b32 v40, 16, v24
    v_and_b32 v41, 0xffff0000, v24
    v_lshlrev_b32 v42, 16, v25
    v_and_b32 v43, 0xffff0000, v25
    v_lshlrev_b32 v10, 16, v26
    v_and_b32 v11, 0xffff0000, v26
    v_pk_add_f32 v[16:17], v[28:29], v[30:31]
    v_pk_mul_f32 v[18:19], v[28:29], v[28:29]
    v_pk_fma_f32 v[18:19], v[30:31], v[30:31], v[18:19]
    v_pk_add_f32 v[16:17], v[16:17], v[32:33]
    v_pk_fma_f32 v[18:19], v[32:33], v[32:33], v[18:19]
    v_pk_add_f32 v[16:17], v[16:17], v[34:35]
    v_pk_fma_f32 v[18:19], v[34:35], v[34:35], v[18:19]
    v_pk_add_f32 v[16:17], v[16:17], v[36:37]
    v_pk_fma_f32 v[18:19], v[36:37], v[36:37], v[18:19]
    v_pk_add_f32 v[16:17], v[16:17], v[38:39]
    v_pk_fma_f32 v[18:19], v[38:39], v[38:39], v[18:19]
    v_pk_add_f32 v[16:17], v[16:17], v[40:41]
    v_pk_fma_f32 v[18:19], v[40:41], v[40:41], v[18:19]
    v_pk_add_f32 v[16:17], v[16:17], v[42:43]
    v_pk_fma_f32 v[18:19], v[42:43], v[42:43], v[18:19]
    v_pk_add_f32 v[16:17], v[16:17], v[10:11]
    v_pk_fma_f32 v[18:19], v[10:11], v[10:11], v[18:19]
    v_add_f32 v16, v16, v17
    v_add_f32 v17, v18, v19
    s_nop 0
    v_add_f32_dpp v16, v16, v16 quad_perm:[1,0,3,2] row_mask:0xf bank_mask:0xf
    v_add_f32_dpp v17, v17, v17 quad_perm:[1,0,3,2] row_mask:0xf bank_mask:0xf
    s_nop 0
    v_add_f32_dpp v16, v16, v16 quad_perm:[2,3,0,1] row_mask:0xf bank_mask:0xf
    v_add_f32_dpp v17, v17, v17 quad_perm:[2,3,0,1] row_mask:0xf bank_mask:0xf
    s_nop 0
    v_add_f32_dpp v16, v16, v16 row_half_mirror row_mask:0xf bank_mask:0xf
    v_add_f32_dpp v17, v17, v17 row_half_mirror row_mask:0xf bank_mask:0xf
    s_nop 0
    v_add_f32_dpp v16, v16, v16 row_mirror row_mask:0xf bank_mask:0xf
    v_add_f32_dpp v17, v17, v17 row_mirror row_mask:0xf bank_mask:0xf
    v_mov_b32 v18, v16
    v_mov_b32 v19, v17
    s_add_u32 s44, s22, 10649600
    s_addc_u32 s45, s23, 0
    s_and_b32 s45, s45, 0xffff
    s_mov_b32 s46, 16384
    s_mov_b32 s47, 0x20000
    v_permlane16_swap_b32 v16, v18
    v_permlane16_swap_b32 v17, v19
    v_add_f32 v16, v16, v18
    v_add_f32 v17, v17, v19
    v_mul_f32 v16, 0x3ae38e39, v16
    v_mul_f32 v17, 0x3ae38e39, v17
    v_fma_f32 v17, -v16, v16, v17
    v_max_f32 v17, 0, v17
    v_cvt_pk_bf16_f32 v16, v16, v17
    v_and_b32 v17, 0xffff0000, v16
    v_add_f32 v17, 0x3727c5ac, v17
    v_cvt_pk_bf16_f32 v17, v17, v17
    v_and_b32 v17, 0xffff0000, v17
    v_sqrt_f32 v17, v17
    s_nop 0
    v_cvt_pk_bf16_f32 v17, v17, v17
    v_and_b32 v17, 0xffff0000, v17
    v_and_b32 v16, 0xffff, v16
    v_or_b32 v14, v16, v17
    s_lshl_b32 s36, s30, 12
    s_lshl_b32 s37, s2, 4
    s_add_u32 s36, s36, s37
    v_lshlrev_b32 v8, 3, v8
    s_waitcnt lgkmcnt(0)
    s_add_u32 s58, s58, 1
    v_mov_b32 v15, s58
    s_mov_b32 exec_lo, 1
    s_mov_b32 exec_hi, 1
    buffer_store_dwordx2 v[14:15], v8, s[44:47], s36 offen sc1
    s_mov_b64 exec, -1
    s_movk_i32 s37, 4608
    s_and_b32 s36, s33, 1
    s_lshl_b32 s36, s36, 4
    s_lshr_b32 s59, s59, s36
    s_lshl_b32 s59, s59, 16
    s_load_dword s60, s[20:21], s35
    v_mov_b32 v68, s59
    s_waitcnt vmcnt(6)
    v_mul_f32 v68, 0x3fb8aa3b, v68
    v_exp_f32 v68, v68
    v_lshlrev_b32 v56, 16, v48
    v_lshlrev_b32 v57, 16, v49
    v_and_b32 v58, 0xffff0000, v48
    v_and_b32 v59, 0xffff0000, v49
    v_cvt_pk_bf16_f32 v68, v68, v68
    v_and_b32 v68, 0xffff0000, v68
    v_mul_f32 v56, v68, v56
    v_mul_f32 v57, v68, v57
    v_mul_f32 v58, v68, v58
    v_mul_f32 v59, v68, v59
    v_mul_f32 v56, 0x3fb8aa3b, v56
    v_mul_f32 v57, 0x3e22f983, v57
    v_mul_f32 v58, 0x3fb8aa3b, v58
    v_mul_f32 v59, 0x3e22f983, v59
    buffer_load_dwordx2 v[16:17], v5, s[40:43], 0 offen offset:0
    v_exp_f32 v76, v56
    v_fract_f32 v77, v57
    v_exp_f32 v78, v58
    v_fract_f32 v79, v59
    v_cos_f32 v80, v77
    v_sin_f32 v81, v77
    v_cos_f32 v82, v79
    v_sin_f32 v83, v79
    v_mul_f32 v80, v76, v80
    v_mul_f32 v81, v76, v81
    v_mul_f32 v82, v78, v82
    v_mul_f32 v83, v78, v83
    v_mul_f32 v76, 0x43800000, v56
    v_mul_f32 v77, 0x43800000, v57
    v_exp_f32 v76, v76
    v_fract_f32 v77, v77
    v_mul_f32 v78, 0x43800000, v58
    v_mul_f32 v79, 0x43800000, v59
    v_exp_f32 v78, v78
    v_fract_f32 v79, v79
    v_cos_f32 v88, v77
    v_sin_f32 v89, v77
    v_cos_f32 v90, v79
    v_sin_f32 v91, v79
    v_mul_f32 v88, v76, v88
    v_mul_f32 v89, v76, v89
    v_mul_f32 v90, v78, v90
    v_mul_f32 v91, v78, v91
.p2align 3
    v_mov_b32 v12, 0x3f80
    v_mov_b32 v13, 0x3f80
    ds_write_b64 v7, v[12:13] offset:16896
    v_cvt_pk_bf16_f32 v10, v80, -v81
    v_cvt_pk_bf16_f32 v11, v82, -v83
    ds_write_b64 v7, v[10:11] offset:17424
    v_pk_mul_f32 v[76:77], v[80:81], v[80:81] op_sel:[0,0] op_sel_hi:[1,0]
    v_pk_mul_f32 v[78:79], v[82:83], v[82:83] op_sel:[0,0] op_sel_hi:[1,0]
    v_pk_fma_f32 v[92:93], v[80:81], v[80:81], v[76:77] op_sel:[1,1,0] op_sel_hi:[0,1,1] neg_lo:[1,0,0]
    v_pk_fma_f32 v[94:95], v[82:83], v[82:83], v[78:79] op_sel:[1,1,0] op_sel_hi:[0,1,1] neg_lo:[1,0,0]
    v_cvt_pk_bf16_f32 v12, v92, -v93
    v_cvt_pk_bf16_f32 v13, v94, -v95
    ds_write_b64 v7, v[12:13] offset:17952
    buffer_load_dwordx2 v[18:19], v5, s[40:43], 0 offen offset:1152
    v_pk_mul_f32 v[76:77], v[92:93], v[80:81] op_sel:[0,0] op_sel_hi:[1,0]
    v_pk_mul_f32 v[78:79], v[94:95], v[82:83] op_sel:[0,0] op_sel_hi:[1,0]
    v_pk_fma_f32 v[96:97], v[92:93], v[80:81], v[76:77] op_sel:[1,1,0] op_sel_hi:[0,1,1] neg_lo:[1,0,0]
    v_pk_fma_f32 v[98:99], v[94:95], v[82:83], v[78:79] op_sel:[1,1,0] op_sel_hi:[0,1,1] neg_lo:[1,0,0]
    v_cvt_pk_bf16_f32 v10, v96, -v97
    v_cvt_pk_bf16_f32 v11, v98, -v99
    ds_write_b64 v7, v[10:11] offset:18480
    v_pk_mul_f32 v[76:77], v[96:97], v[80:81] op_sel:[0,0] op_sel_hi:[1,0]
    v_pk_mul_f32 v[78:79], v[98:99], v[82:83] op_sel:[0,0] op_sel_hi:[1,0]
    v_pk_fma_f32 v[100:101], v[96:97], v[80:81], v[76:77] op_sel:[1,1,0] op_sel_hi:[0,1,1] neg_lo:[1,0,0]
    v_pk_fma_f32 v[102:103], v[98:99], v[82:83], v[78:79] op_sel:[1,1,0] op_sel_hi:[0,1,1] neg_lo:[1,0,0]
    v_cvt_pk_bf16_f32 v12, v100, -v101
    v_cvt_pk_bf16_f32 v13, v102, -v103
    ds_write_b64 v7, v[12:13] offset:21120
    v_pk_mul_f32 v[76:77], v[100:101], v[80:81] op_sel:[0,0] op_sel_hi:[1,0]
    v_pk_mul_f32 v[78:79], v[102:103], v[82:83] op_sel:[0,0] op_sel_hi:[1,0]
    v_pk_fma_f32 v[104:105], v[100:101], v[80:81], v[76:77] op_sel:[1,1,0] op_sel_hi:[0,1,1] neg_lo:[1,0,0]
    v_pk_fma_f32 v[106:107], v[102:103], v[82:83], v[78:79] op_sel:[1,1,0] op_sel_hi:[0,1,1] neg_lo:[1,0,0]
    v_cvt_pk_bf16_f32 v10, v104, -v105
    v_cvt_pk_bf16_f32 v11, v106, -v107
    ds_write_b64 v7, v[10:11] offset:21648
    v_pk_mul_f32 v[76:77], v[104:105], v[80:81] op_sel:[0,0] op_sel_hi:[1,0]
    v_pk_mul_f32 v[78:79], v[106:107], v[82:83] op_sel:[0,0] op_sel_hi:[1,0]
    v_pk_fma_f32 v[108:109], v[104:105], v[80:81], v[76:77] op_sel:[1,1,0] op_sel_hi:[0,1,1] neg_lo:[1,0,0]
    v_pk_fma_f32 v[110:111], v[106:107], v[82:83], v[78:79] op_sel:[1,1,0] op_sel_hi:[0,1,1] neg_lo:[1,0,0]
    v_cvt_pk_bf16_f32 v12, v108, -v109
    v_cvt_pk_bf16_f32 v13, v110, -v111
    ds_write_b64 v7, v[12:13] offset:22176
    v_pk_mul_f32 v[76:77], v[108:109], v[80:81] op_sel:[0,0] op_sel_hi:[1,0]
    v_pk_mul_f32 v[78:79], v[110:111], v[82:83] op_sel:[0,0] op_sel_hi:[1,0]
    v_pk_fma_f32 v[112:113], v[108:109], v[80:81], v[76:77] op_sel:[1,1,0] op_sel_hi:[0,1,1] neg_lo:[1,0,0]
    v_pk_fma_f32 v[114:115], v[110:111], v[82:83], v[78:79] op_sel:[1,1,0] op_sel_hi:[0,1,1] neg_lo:[1,0,0]
    v_cvt_pk_bf16_f32 v10, v112, -v113
    v_cvt_pk_bf16_f32 v11, v114, -v115
    ds_write_b64 v7, v[10:11] offset:22704
    v_pk_mul_f32 v[76:77], v[100:101], v[100:101] op_sel:[0,0] op_sel_hi:[1,0]
    v_pk_mul_f32 v[78:79], v[102:103], v[102:103] op_sel:[0,0] op_sel_hi:[1,0]
    v_pk_fma_f32 v[84:85], v[100:101], v[100:101], v[76:77] op_sel:[1,1,0] op_sel_hi:[0,1,1] neg_lo:[1,0,0]
    v_pk_fma_f32 v[86:87], v[102:103], v[102:103], v[78:79] op_sel:[1,1,0] op_sel_hi:[0,1,1] neg_lo:[1,0,0]
    v_cvt_pk_bf16_f32 v12, v88, -v89
    v_cvt_pk_bf16_f32 v13, v90, -v91
    ds_write_b64 v7, v[12:13] offset:19008
    ds_write_b64 v7, v[12:13] offset:19536
    v_pk_mul_f32 v[76:77], v[88:89], v[92:93] op_sel:[0,0] op_sel_hi:[1,0]
    v_pk_mul_f32 v[78:79], v[90:91], v[94:95] op_sel:[0,0] op_sel_hi:[1,0]
    v_pk_fma_f32 v[116:117], v[88:89], v[92:93], v[76:77] op_sel:[1,1,0] op_sel_hi:[0,1,1] neg_lo:[1,0,0]
    v_pk_fma_f32 v[118:119], v[90:91], v[94:95], v[78:79] op_sel:[1,1,0] op_sel_hi:[0,1,1] neg_lo:[1,0,0]
    v_cvt_pk_bf16_f32 v10, v116, -v117
    v_cvt_pk_bf16_f32 v11, v118, -v119
    ds_write_b64 v7, v[10:11] offset:20064
    v_pk_mul_f32 v[76:77], v[88:89], v[100:101] op_sel:[0,0] op_sel_hi:[1,0]
    v_pk_mul_f32 v[78:79], v[90:91], v[102:103] op_sel:[0,0] op_sel_hi:[1,0]
    v_pk_fma_f32 v[116:117], v[88:89], v[100:101], v[76:77] op_sel:[1,1,0] op_sel_hi:[0,1,1] neg_lo:[1,0,0]
    v_pk_fma_f32 v[118:119], v[90:91], v[102:103], v[78:79] op_sel:[1,1,0] op_sel_hi:[0,1,1] neg_lo:[1,0,0]
    v_cvt_pk_bf16_f32 v12, v116, -v117
    v_cvt_pk_bf16_f32 v13, v118, -v119
    ds_write_b64 v7, v[12:13] offset:20592
    ds_write_b64 v7, v[12:13] offset:23232
    ds_write_b64 v7, v[12:13] offset:23760
    v_pk_mul_f32 v[76:77], v[88:89], v[108:109] op_sel:[0,0] op_sel_hi:[1,0]
    v_pk_mul_f32 v[78:79], v[90:91], v[110:111] op_sel:[0,0] op_sel_hi:[1,0]
    v_pk_fma_f32 v[116:117], v[88:89], v[108:109], v[76:77] op_sel:[1,1,0] op_sel_hi:[0,1,1] neg_lo:[1,0,0]
    v_pk_fma_f32 v[118:119], v[90:91], v[110:111], v[78:79] op_sel:[1,1,0] op_sel_hi:[0,1,1] neg_lo:[1,0,0]
    v_cvt_pk_bf16_f32 v10, v116, -v117
    v_cvt_pk_bf16_f32 v11, v118, -v119
    ds_write_b64 v7, v[10:11] offset:24288
    buffer_load_dwordx2 v[20:21], v5, s[40:43], 0 offen offset:2304
    v_pk_mul_f32 v[76:77], v[88:89], v[88:89] op_sel:[0,0] op_sel_hi:[1,0]
    v_pk_mul_f32 v[78:79], v[90:91], v[90:91] op_sel:[0,0] op_sel_hi:[1,0]
    v_pk_fma_f32 v[96:97], v[88:89], v[88:89], v[76:77] op_sel:[1,1,0] op_sel_hi:[0,1,1] neg_lo:[1,0,0]
    v_pk_fma_f32 v[98:99], v[90:91], v[90:91], v[78:79] op_sel:[1,1,0] op_sel_hi:[0,1,1] neg_lo:[1,0,0]
    v_cvt_pk_bf16_f32 v12, v96, -v97
    v_cvt_pk_bf16_f32 v13, v98, -v99
    ds_write_b64 v7, v[12:13] offset:25344
    v_pk_mul_f32 v[76:77], v[96:97], v[100:101] op_sel:[0,0] op_sel_hi:[1,0]
    v_pk_mul_f32 v[78:79], v[98:99], v[102:103] op_sel:[0,0] op_sel_hi:[1,0]
    v_pk_fma_f32 v[116:117], v[96:97], v[100:101], v[76:77] op_sel:[1,1,0] op_sel_hi:[0,1,1] neg_lo:[1,0,0]
    v_pk_fma_f32 v[118:119], v[98:99], v[102:103], v[78:79] op_sel:[1,1,0] op_sel_hi:[0,1,1] neg_lo:[1,0,0]
    v_cvt_pk_bf16_f32 v10, v116, -v117
    v_cvt_pk_bf16_f32 v11, v118, -v119
    ds_write_b64 v7, v[10:11] offset:25872
    v_pk_mul_f32 v[76:77], v[96:97], v[88:89] op_sel:[0,0] op_sel_hi:[1,0]
    v_pk_mul_f32 v[78:79], v[98:99], v[90:91] op_sel:[0,0] op_sel_hi:[1,0]
    v_pk_fma_f32 v[96:97], v[96:97], v[88:89], v[76:77] op_sel:[1,1,0] op_sel_hi:[0,1,1] neg_lo:[1,0,0]
    v_pk_fma_f32 v[98:99], v[98:99], v[90:91], v[78:79] op_sel:[1,1,0] op_sel_hi:[0,1,1] neg_lo:[1,0,0]
    v_cvt_pk_bf16_f32 v12, v96, -v97
    v_cvt_pk_bf16_f32 v13, v98, -v99
    ds_write_b64 v7, v[12:13] offset:27456
    v_pk_mul_f32 v[76:77], v[96:97], v[100:101] op_sel:[0,0] op_sel_hi:[1,0]
    v_pk_mul_f32 v[78:79], v[98:99], v[102:103] op_sel:[0,0] op_sel_hi:[1,0]
    v_pk_fma_f32 v[116:117], v[96:97], v[100:101], v[76:77] op_sel:[1,1,0] op_sel_hi:[0,1,1] neg_lo:[1,0,0]
    v_pk_fma_f32 v[118:119], v[98:99], v[102:103], v[78:79] op_sel:[1,1,0] op_sel_hi:[0,1,1] neg_lo:[1,0,0]
    v_cvt_pk_bf16_f32 v10, v116, -v117
    v_cvt_pk_bf16_f32 v11, v118, -v119
    ds_write_b64 v7, v[10:11] offset:27984
    v_pk_mul_f32 v[76:77], v[96:97], v[88:89] op_sel:[0,0] op_sel_hi:[1,0]
    v_pk_mul_f32 v[78:79], v[98:99], v[90:91] op_sel:[0,0] op_sel_hi:[1,0]
    v_pk_fma_f32 v[96:97], v[96:97], v[88:89], v[76:77] op_sel:[1,1,0] op_sel_hi:[0,1,1] neg_lo:[1,0,0]
    v_pk_fma_f32 v[98:99], v[98:99], v[90:91], v[78:79] op_sel:[1,1,0] op_sel_hi:[0,1,1] neg_lo:[1,0,0]
    v_cvt_pk_bf16_f32 v12, v96, -v97
    v_cvt_pk_bf16_f32 v13, v98, -v99
    ds_write_b64 v7, v[12:13] offset:26400
    v_pk_mul_f32 v[76:77], v[96:97], v[88:89] op_sel:[0,0] op_sel_hi:[1,0]
    v_pk_mul_f32 v[78:79], v[98:99], v[90:91] op_sel:[0,0] op_sel_hi:[1,0]
    v_pk_fma_f32 v[96:97], v[96:97], v[88:89], v[76:77] op_sel:[1,1,0] op_sel_hi:[0,1,1] neg_lo:[1,0,0]
    v_pk_fma_f32 v[98:99], v[98:99], v[90:91], v[78:79] op_sel:[1,1,0] op_sel_hi:[0,1,1] neg_lo:[1,0,0]
    v_cvt_pk_bf16_f32 v10, v96, -v97
    v_cvt_pk_bf16_f32 v11, v98, -v99
    ds_write_b64 v7, v[10:11] offset:28512
    v_pk_mul_f32 v[76:77], v[96:97], v[88:89] op_sel:[0,0] op_sel_hi:[1,0]
    v_pk_mul_f32 v[78:79], v[98:99], v[90:91] op_sel:[0,0] op_sel_hi:[1,0]
    v_pk_fma_f32 v[96:97], v[96:97], v[88:89], v[76:77] op_sel:[1,1,0] op_sel_hi:[0,1,1] neg_lo:[1,0,0]
    v_pk_fma_f32 v[98:99], v[98:99], v[90:91], v[78:79] op_sel:[1,1,0] op_sel_hi:[0,1,1] neg_lo:[1,0,0]
    v_cvt_pk_bf16_f32 v12, v96, -v97
    v_cvt_pk_bf16_f32 v13, v98, -v99
    ds_write_b64 v7, v[12:13] offset:26928
    v_pk_mul_f32 v[76:77], v[96:97], v[88:89] op_sel:[0,0] op_sel_hi:[1,0]
    v_pk_mul_f32 v[78:79], v[98:99], v[90:91] op_sel:[0,0] op_sel_hi:[1,0]
    v_pk_fma_f32 v[96:97], v[96:97], v[88:89], v[76:77] op_sel:[1,1,0] op_sel_hi:[0,1,1] neg_lo:[1,0,0]
    v_pk_fma_f32 v[98:99], v[98:99], v[90:91], v[78:79] op_sel:[1,1,0] op_sel_hi:[0,1,1] neg_lo:[1,0,0]
    v_cvt_pk_bf16_f32 v10, v96, -v97
    v_cvt_pk_bf16_f32 v11, v98, -v99
    ds_write_b64 v7, v[10:11] offset:29040
    v_pk_mul_f32 v[76:77], v[96:97], v[88:89] op_sel:[0,0] op_sel_hi:[1,0]
    v_pk_mul_f32 v[78:79], v[98:99], v[90:91] op_sel:[0,0] op_sel_hi:[1,0]
    v_pk_fma_f32 v[96:97], v[96:97], v[88:89], v[76:77] op_sel:[1,1,0] op_sel_hi:[0,1,1] neg_lo:[1,0,0]
    v_pk_fma_f32 v[98:99], v[98:99], v[90:91], v[78:79] op_sel:[1,1,0] op_sel_hi:[0,1,1] neg_lo:[1,0,0]
    v_cvt_pk_bf16_f32 v12, v96, -v97
    v_cvt_pk_bf16_f32 v13, v98, -v99
    ds_write_b64 v7, v[12:13] offset:29568
    buffer_load_dwordx2 v[22:23], v5, s[40:43], 0 offen offset:3456
    s_waitcnt vmcnt(6)
    v_lshlrev_b32 v60, 16, v50
    v_lshlrev_b32 v61, 16, v51
    v_and_b32 v62, 0xffff0000, v50
    v_and_b32 v63, 0xffff0000, v51
    v_lshlrev_b32 v64, 16, v52
    v_lshlrev_b32 v65, 16, v53
    v_and_b32 v66, 0xffff0000, v52
    v_and_b32 v67, 0xffff0000, v53
    v_mul_f32 v60, v68, v60
    v_mul_f32 v61, v68, v61
    v_mul_f32 v62, v68, v62
    v_mul_f32 v63, v68, v63
.p2align 3
    v_pk_mul_f32 v[76:77], v[64:65], v[60:61] op_sel:[0,0] op_sel_hi:[1,0]
    v_pk_mul_f32 v[78:79], v[66:67], v[62:63] op_sel:[0,0] op_sel_hi:[1,0]
    v_pk_fma_f32 v[72:73], v[64:65], v[60:61], v[76:77] op_sel:[1,1,0] op_sel_hi:[0,1,1] neg_lo:[1,0,0]
    v_pk_fma_f32 v[74:75], v[66:67], v[62:63], v[78:79] op_sel:[1,1,0] op_sel_hi:[0,1,1] neg_lo:[1,0,0]
    v_cvt_pk_bf16_f32 v10, v72, v73
    v_cvt_pk_bf16_f32 v11, v74, v75
    ds_write_b64 v7, v[10:11] offset:0
    v_pk_mul_f32 v[76:77], v[72:73], v[84:85] op_sel:[0,0] op_sel_hi:[1,0]
    v_pk_mul_f32 v[78:79], v[74:75], v[86:87] op_sel:[0,0] op_sel_hi:[1,0]
    v_pk_fma_f32 v[72:73], v[72:73], v[84:85], v[76:77] op_sel:[1,1,0] op_sel_hi:[0,1,1] neg_lo:[1,0,0]
    v_pk_fma_f32 v[74:75], v[74:75], v[86:87], v[78:79] op_sel:[1,1,0] op_sel_hi:[0,1,1] neg_lo:[1,0,0]
    v_cvt_pk_bf16_f32 v12, v72, v73
L_pg1:
    s_cbranch_execz L_wret0
    s_nop 0
    v_cvt_pk_bf16_f32 v13, v74, v75
    ds_write_b64 v7, v[12:13] offset:528
    v_pk_mul_f32 v[76:77], v[72:73], v[84:85] op_sel:[0,0] op_sel_hi:[1,0]
    v_pk_mul_f32 v[78:79], v[74:75], v[86:87] op_sel:[0,0] op_sel_hi:[1,0]
    v_pk_fma_f32 v[72:73], v[72:73], v[84:85], v[76:77] op_sel:[1,1,0] op_sel_hi:[0,1,1] neg_lo:[1,0,0]
    v_pk_fma_f32 v[74:75], v[74:75], v[86:87], v[78:79] op_sel:[1,1,0] op_sel_hi:[0,1,1] neg_lo:[1,0,0]
    v_cvt_pk_bf16_f32 v10, v72, v73
    v_cvt_pk_bf16_f32 v11, v74, v75
    ds_write_b64 v7, v[10:11] offset:1056
    v_pk_mul_f32 v[76:77], v[72:73], v[84:85] op_sel:[0,0] op_sel_hi:[1,0]
    v_pk_mul_f32 v[78:79], v[74:75], v[86:87] op_sel:[0,0] op_sel_hi:[1,0]
    v_pk_fma_f32 v[72:73], v[72:73], v[84:85], v[76:77] op_sel:[1,1,0] op_sel_hi:[0,1,1] neg_lo:[1,0,0]
    v_pk_fma_f32 v[74:75], v[74:75], v[86:87], v[78:79] op_sel:[1,1,0] op_sel_hi:[0,1,1] neg_lo:[1,0,0]
    v_cvt_pk_bf16_f32 v12, v72, v73
    v_cvt_pk_bf16_f32 v13, v74, v75
    ds_write_b64 v7, v[12:13] offset:1584
    v_pk_mul_f32 v[76:77], v[72:73], v[84:85] op_sel:[0,0] op_sel_hi:[1,0]
    v_pk_mul_f32 v[78:79], v[74:75], v[86:87] op_sel:[0,0] op_sel_hi:[1,0]
    v_pk_fma_f32 v[72:73], v[72:73], v[84:85], v[76:77] op_sel:[1,1,0] op_sel_hi:[0,1,1] neg_lo:[1,0,0]
    v_pk_fma_f32 v[74:75], v[74:75], v[86:87], v[78:79] op_sel:[1,1,0] op_sel_hi:[0,1,1] neg_lo:[1,0,0]
    v_cvt_pk_bf16_f32 v10, v72, v73
    v_cvt_pk_bf16_f32 v11, v74, v75
    ds_write_b64 v7, v[10:11] offset:2112
    v_pk_mul_f32 v[76:77], v[72:73], v[84:85] op_sel:[0,0] op_sel_hi:[1,0]
    v_pk_mul_f32 v[78:79], v[74:75], v[86:87] op_sel:[0,0] op_sel_hi:[1,0]
    v_pk_fma_f32 v[72:73], v[72:73], v[84:85], v[76:77] op_sel:[1,1,0] op_sel_hi:[0,1,1] neg_lo:[1,0,0]
    v_pk_fma_f32 v[74:75], v[74:75], v[86:87], v[78:79] op_sel:[1,1,0] op_sel_hi:[0,1,1] neg_lo:[1,0,0]
    v_cvt_pk_bf16_f32 v12, v72, v73
    v_cvt_pk_bf16_f32 v13, v74, v75
    ds_write_b64 v7, v[12:13] offset:2640
    v_pk_mul_f32 v[76:77], v[72:73], v[84:85] op_sel:[0,0] op_sel_hi:[1,0]
    v_pk_mul_f32 v[78:79], v[74:75], v[86:87] op_sel:[0,0] op_sel_hi:[1,0]
    v_pk_fma_f32 v[72:73], v[72:73], v[84:85], v[76:77] op_sel:[1,1,0] op_sel_hi:[0,1,1] neg_lo:[1,0,0]
    v_pk_fma_f32 v[74:75], v[74:75], v[86:87], v[78:79] op_sel:[1,1,0] op_sel_hi:[0,1,1] neg_lo:[1,0,0]
    v_cvt_pk_bf16_f32 v10, v72, v73
    v_cvt_pk_bf16_f32 v11, v74, v75
    ds_write_b64 v7, v[10:11] offset:3168
    v_pk_mul_f32 v[76:77], v[72:73], v[84:85] op_sel:[0,0] op_sel_hi:[1,0]
    v_pk_mul_f32 v[78:79], v[74:75], v[86:87] op_sel:[0,0] op_sel_hi:[1,0]
    v_pk_fma_f32 v[72:73], v[72:73], v[84:85], v[76:77] op_sel:[1,1,0] op_sel_hi:[0,1,1] neg_lo:[1,0,0]
    v_pk_fma_f32 v[74:75], v[74:75], v[86:87], v[78:79] op_sel:[1,1,0] op_sel_hi:[0,1,1] neg_lo:[1,0,0]
    v_cvt_pk_bf16_f32 v12, v72, v73
    v_cvt_pk_bf16_f32 v13, v74, v75
    ds_write_b64 v7, v[12:13] offset:3696
    v_pk_mul_f32 v[76:77], v[72:73], v[84:85] op_sel:[0,0] op_sel_hi:[1,0]
    v_pk_mul_f32 v[78:79], v[74:75], v[86:87] op_sel:[0,0] op_sel_hi:[1,0]
    v_pk_fma_f32 v[72:73], v[72:73], v[84:85], v[76:77] op_sel:[1,1,0] op_sel_hi:[0,1,1] neg_lo:[1,0,0]
    v_pk_fma_f32 v[74:75], v[74:75], v[86:87], v[78:79] op_sel:[1,1,0] op_sel_hi:[0,1,1] neg_lo:[1,0,0]
    v_cvt_pk_bf16_f32 v10, v72, v73
    v_cvt_pk_bf16_f32 v11, v74, v75
    ds_write_b64 v7, v[10:11] offset:4224
    buffer_load_dwordx2 v[24:25], v5, s[40:43], s37 offen offset:0
    v_pk_mul_f32 v[76:77], v[72:73], v[84:85] op_sel:[0,0] op_sel_hi:[1,0]
    v_pk_mul_f32 v[78:79], v[74:75], v[86:87] op_sel:[0,0] op_sel_hi:[1,0]
    v_pk_fma_f32 v[72:73], v[72:73], v[84:85], v[76:77] op_sel:[1,1,0] op_sel_hi:[0,1,1] neg_lo:[1,0,0]
    v_pk_fma_f32 v[74:75], v[74:75], v[86:87], v[78:79] op_sel:[1,1,0] op_sel_hi:[0,1,1] neg_lo:[1,0,0]
    v_cvt_pk_bf16_f32 v12, v72, v73
    v_cvt_pk_bf16_f32 v13, v74, v75
    ds_write_b64 v7, v[12:13] offset:4752
    v_pk_mul_f32 v[76:77], v[72:73], v[84:85] op_sel:[0,0] op_sel_hi:[1,0]
    v_pk_mul_f32 v[78:79], v[74:75], v[86:87] op_sel:[0,0] op_sel_hi:[1,0]
    v_pk_fma_f32 v[72:73], v[72:73], v[84:85], v[76:77] op_sel:[1,1,0] op_sel_hi:[0,1,1] neg_lo:[1,0,0]
    v_pk_fma_f32 v[74:75], v[74:75], v[86:87], v[78:79] op_sel:[1,1,0] op_sel_hi:[0,1,1] neg_lo:[1,0,0]
    v_cvt_pk_bf16_f32 v10, v72, v73
    v_cvt_pk_bf16_f32 v11, v74, v75
    ds_write_b64 v7, v[10:11] offset:5280
    v_pk_mul_f32 v[76:77], v[72:73], v[84:85] op_sel:[0,0] op_sel_hi:[1,0]
    v_pk_mul_f32 v[78:79], v[74:75], v[86:87] op_sel:[0,0] op_sel_hi:[1,0]
    v_pk_fma_f32 v[72:73], v[72:73], v[84:85], v[76:77] op_sel:[1,1,0] op_sel_hi:[0,1,1] neg_lo:[1,0,0]
    v_pk_fma_f32 v[74:75], v[74:75], v[86:87], v[78:79] op_sel:[1,1,0] op_sel_hi:[0,1,1] neg_lo:[1,0,0]
    v_cvt_pk_bf16_f32 v12, v72, v73
    v_cvt_pk_bf16_f32 v13, v74, v75
    ds_write_b64 v7, v[12:13] offset:5808
    v_pk_mul_f32 v[76:77], v[72:73], v[84:85] op_sel:[0,0] op_sel_hi:[1,0]
    v_pk_mul_f32 v[78:79], v[74:75], v[86:87] op_sel:[0,0] op_sel_hi:[1,0]
    v_pk_fma_f32 v[72:73], v[72:73], v[84:85], v[76:77] op_sel:[1,1,0] op_sel_hi:[0,1,1] neg_lo:[1,0,0]
    v_pk_fma_f32 v[74:75], v[74:75], v[86:87], v[78:79] op_sel:[1,1,0] op_sel_hi:[0,1,1] neg_lo:[1,0,0]
    v_cvt_pk_bf16_f32 v10, v72, v73
    v_cvt_pk_bf16_f32 v11, v74, v75
    ds_write_b64 v7, v[10:11] offset:6336
    v_pk_mul_f32 v[76:77], v[72:73], v[84:85] op_sel:[0,0] op_sel_hi:[1,0]
    v_pk_mul_f32 v[78:79], v[74:75], v[86:87] op_sel:[0,0] op_sel_hi:[1,0]
    v_pk_fma_f32 v[72:73], v[72:73], v[84:85], v[76:77] op_sel:[1,1,0] op_sel_hi:[0,1,1] neg_lo:[1,0,0]
    v_pk_fma_f32 v[74:75], v[74:75], v[86:87], v[78:79] op_sel:[1,1,0] op_sel_hi:[0,1,1] neg_lo:[1,0,0]
    v_cvt_pk_bf16_f32 v12, v72, v73
    v_cvt_pk_bf16_f32 v13, v74, v75
    ds_write_b64 v7, v[12:13] offset:6864
    v_pk_mul_f32 v[76:77], v[72:73], v[84:85] op_sel:[0,0] op_sel_hi:[1,0]
    v_pk_mul_f32 v[78:79], v[74:75], v[86:87] op_sel:[0,0] op_sel_hi:[1,0]
    v_pk_fma_f32 v[72:73], v[72:73], v[84:85], v[76:77] op_sel:[1,1,0] op_sel_hi:[0,1,1] neg_lo:[1,0,0]
    v_pk_fma_f32 v[74:75], v[74:75], v[86:87], v[78:79] op_sel:[1,1,0] op_sel_hi:[0,1,1] neg_lo:[1,0,0]
    v_cvt_pk_bf16_f32 v10, v72, v73
    v_cvt_pk_bf16_f32 v11, v74, v75
    ds_write_b64 v7, v[10:11] offset:7392
    v_pk_mul_f32 v[76:77], v[72:73], v[84:85] op_sel:[0,0] op_sel_hi:[1,0]
    v_pk_mul_f32 v[78:79], v[74:75], v[86:87] op_sel:[0,0] op_sel_hi:[1,0]
    v_pk_fma_f32 v[72:73], v[72:73], v[84:85], v[76:77] op_sel:[1,1,0] op_sel_hi:[0,1,1] neg_lo:[1,0,0]
    v_pk_fma_f32 v[74:75], v[74:75], v[86:87], v[78:79] op_sel:[1,1,0] op_sel_hi:[0,1,1] neg_lo:[1,0,0]
    v_cvt_pk_bf16_f32 v12, v72, v73
    v_cvt_pk_bf16_f32 v13, v74, v75
    ds_write_b64 v7, v[12:13] offset:7920
    v_pk_mul_f32 v[76:77], v[72:73], v[84:85] op_sel:[0,0] op_sel_hi:[1,0]
    v_pk_mul_f32 v[78:79], v[74:75], v[86:87] op_sel:[0,0] op_sel_hi:[1,0]
    v_pk_fma_f32 v[72:73], v[72:73], v[84:85], v[76:77] op_sel:[1,1,0] op_sel_hi:[0,1,1] neg_lo:[1,0,0]
    v_pk_fma_f32 v[74:75], v[74:75], v[86:87], v[78:79] op_sel:[1,1,0] op_sel_hi:[0,1,1] neg_lo:[1,0,0]
    v_cvt_pk_bf16_f32 v10, v72, v73
    v_cvt_pk_bf16_f32 v11, v74, v75
    ds_write_b64 v7, v[10:11] offset:8448
    v_pk_mul_f32 v[76:77], v[72:73], v[84:85] op_sel:[0,0] op_sel_hi:[1,0]
    v_pk_mul_f32 v[78:79], v[74:75], v[86:87] op_sel:[0,0] op_sel_hi:[1,0]
    v_pk_fma_f32 v[72:73], v[72:73], v[84:85], v[76:77] op_sel:[1,1,0] op_sel_hi:[0,1,1] neg_lo:[1,0,0]
    v_pk_fma_f32 v[74:75], v[74:75], v[86:87], v[78:79] op_sel:[1,1,0] op_sel_hi:[0,1,1] neg_lo:[1,0,0]
    v_cvt_pk_bf16_f32 v12, v72, v73
    v_cvt_pk_bf16_f32 v13, v74, v75
    ds_write_b64 v7, v[12:13] offset:8976
    buffer_load_dwordx2 v[26:27], v5, s[40:43], s37 offen offset:1152
    v_pk_mul_f32 v[76:77], v[72:73], v[84:85] op_sel:[0,0] op_sel_hi:[1,0]
    v_pk_mul_f32 v[78:79], v[74:75], v[86:87] op_sel:[0,0] op_sel_hi:[1,0]
    v_pk_fma_f32 v[72:73], v[72:73], v[84:85], v[76:77] op_sel:[1,1,0] op_sel_hi:[0,1,1] neg_lo:[1,0,0]
    v_pk_fma_f32 v[74:75], v[74:75], v[86:87], v[78:79] op_sel:[1,1,0] op_sel_hi:[0,1,1] neg_lo:[1,0,0]
    v_cvt_pk_bf16_f32 v10, v72, v73
    v_cvt_pk_bf16_f32 v11, v74, v75
    ds_write_b64 v7, v[10:11] offset:9504
    v_pk_mul_f32 v[76:77], v[72:73], v[84:85] op_sel:[0,0] op_sel_hi:[1,0]
    v_pk_mul_f32 v[78:79], v[74:75], v[86:87] op_sel:[0,0] op_sel_hi:[1,0]
    v_pk_fma_f32 v[72:73], v[72:73], v[84:85], v[76:77] op_sel:[1,1,0] op_sel_hi:[0,1,1] neg_lo:[1,0,0]
    v_pk_fma_f32 v[74:75], v[74:75], v[86:87], v[78:79] op_sel:[1,1,0] op_sel_hi:[0,1,1] neg_lo:[1,0,0]
    v_cvt_pk_bf16_f32 v12, v72, v73
    v_cvt_pk_bf16_f32 v13, v74, v75
    ds_write_b64 v7, v[12:13] offset:10032
    v_pk_mul_f32 v[76:77], v[72:73], v[84:85] op_sel:[0,0] op_sel_hi:[1,0]
    v_pk_mul_f32 v[78:79], v[74:75], v[86:87] op_sel:[0,0] op_sel_hi:[1,0]
    v_pk_fma_f32 v[72:73], v[72:73], v[84:85], v[76:77] op_sel:[1,1,0] op_sel_hi:[0,1,1] neg_lo:[1,0,0]
    v_pk_fma_f32 v[74:75], v[74:75], v[86:87], v[78:79] op_sel:[1,1,0] op_sel_hi:[0,1,1] neg_lo:[1,0,0]
    v_cvt_pk_bf16_f32 v10, v72, v73
    v_cvt_pk_bf16_f32 v11, v74, v75
    ds_write_b64 v7, v[10:11] offset:10560
    v_pk_mul_f32 v[76:77], v[72:73], v[84:85] op_sel:[0,0] op_sel_hi:[1,0]
    v_pk_mul_f32 v[78:79], v[74:75], v[86:87] op_sel:[0,0] op_sel_hi:[1,0]
    v_pk_fma_f32 v[72:73], v[72:73], v[84:85], v[76:77] op_sel:[1,1,0] op_sel_hi:[0,1,1] neg_lo:[1,0,0]
    v_pk_fma_f32 v[74:75], v[74:75], v[86:87], v[78:79] op_sel:[1,1,0] op_sel_hi:[0,1,1] neg_lo:[1,0,0]
    v_cvt_pk_bf16_f32 v12, v72, v73
    v_cvt_pk_bf16_f32 v13, v74, v75
    ds_write_b64 v7, v[12:13] offset:11088
    v_pk_mul_f32 v[76:77], v[72:73], v[84:85] op_sel:[0,0] op_sel_hi:[1,0]
    v_pk_mul_f32 v[78:79], v[74:75], v[86:87] op_sel:[0,0] op_sel_hi:[1,0]
    v_pk_fma_f32 v[72:73], v[72:73], v[84:85], v[76:77] op_sel:[1,1,0] op_sel_hi:[0,1,1] neg_lo:[1,0,0]
    v_pk_fma_f32 v[74:75], v[74:75], v[86:87], v[78:79] op_sel:[1,1,0] op_sel_hi:[0,1,1] neg_lo:[1,0,0]
    v_cvt_pk_bf16_f32 v10, v72, v73
    v_cvt_pk_bf16_f32 v11, v74, v75
    ds_write_b64 v7, v[10:11] offset:11616
    v_pk_mul_f32 v[76:77], v[72:73], v[84:85] op_sel:[0,0] op_sel_hi:[1,0]
    v_pk_mul_f32 v[78:79], v[74:75], v[86:87] op_sel:[0,0] op_sel_hi:[1,0]
    v_pk_fma_f32 v[72:73], v[72:73], v[84:85], v[76:77] op_sel:[1,1,0] op_sel_hi:[0,1,1] neg_lo:[1,0,0]
    v_pk_fma_f32 v[74:75], v[74:75], v[86:87], v[78:79] op_sel:[1,1,0] op_sel_hi:[0,1,1] neg_lo:[1,0,0]
    v_cvt_pk_bf16_f32 v12, v72, v73
    v_cvt_pk_bf16_f32 v13, v74, v75
    ds_write_b64 v7, v[12:13] offset:12144
    v_pk_mul_f32 v[76:77], v[72:73], v[84:85] op_sel:[0,0] op_sel_hi:[1,0]
    v_pk_mul_f32 v[78:79], v[74:75], v[86:87] op_sel:[0,0] op_sel_hi:[1,0]
    v_pk_fma_f32 v[72:73], v[72:73], v[84:85], v[76:77] op_sel:[1,1,0] op_sel_hi:[0,1,1] neg_lo:[1,0,0]
    v_pk_fma_f32 v[74:75], v[74:75], v[86:87], v[78:79] op_sel:[1,1,0] op_sel_hi:[0,1,1] neg_lo:[1,0,0]
    v_cvt_pk_bf16_f32 v10, v72, v73
    v_cvt_pk_bf16_f32 v11, v74, v75
    ds_write_b64 v7, v[10:11] offset:12672
    v_pk_mul_f32 v[76:77], v[72:73], v[84:85] op_sel:[0,0] op_sel_hi:[1,0]
    v_pk_mul_f32 v[78:79], v[74:75], v[86:87] op_sel:[0,0] op_sel_hi:[1,0]
    v_pk_fma_f32 v[72:73], v[72:73], v[84:85], v[76:77] op_sel:[1,1,0] op_sel_hi:[0,1,1] neg_lo:[1,0,0]
    v_pk_fma_f32 v[74:75], v[74:75], v[86:87], v[78:79] op_sel:[1,1,0] op_sel_hi:[0,1,1] neg_lo:[1,0,0]
    v_cvt_pk_bf16_f32 v12, v72, v73
    v_cvt_pk_bf16_f32 v13, v74, v75
    ds_write_b64 v7, v[12:13] offset:13200
    v_pk_mul_f32 v[76:77], v[72:73], v[84:85] op_sel:[0,0] op_sel_hi:[1,0]
    v_pk_mul_f32 v[78:79], v[74:75], v[86:87] op_sel:[0,0] op_sel_hi:[1,0]
    v_pk_fma_f32 v[72:73], v[72:73], v[84:85], v[76:77] op_sel:[1,1,0] op_sel_hi:[0,1,1] neg_lo:[1,0,0]
    v_pk_fma_f32 v[74:75], v[74:75], v[86:87], v[78:79] op_sel:[1,1,0] op_sel_hi:[0,1,1] neg_lo:[1,0,0]
    v_cvt_pk_bf16_f32 v10, v72, v73
    v_cvt_pk_bf16_f32 v11, v74, v75
    ds_write_b64 v7, v[10:11] offset:13728
    buffer_load_dwordx2 v[28:29], v5, s[40:43], s37 offen offset:2304
    v_pk_mul_f32 v[76:77], v[72:73], v[84:85] op_sel:[0,0] op_sel_hi:[1,0]
    v_pk_mul_f32 v[78:79], v[74:75], v[86:87] op_sel:[0,0] op_sel_hi:[1,0]
    v_pk_fma_f32 v[72:73], v[72:73], v[84:85], v[76:77] op_sel:[1,1,0] op_sel_hi:[0,1,1] neg_lo:[1,0,0]
    v_pk_fma_f32 v[74:75], v[74:75], v[86:87], v[78:79] op_sel:[1,1,0] op_sel_hi:[0,1,1] neg_lo:[1,0,0]
    v_cvt_pk_bf16_f32 v12, v72, v73
    v_cvt_pk_bf16_f32 v13, v74, v75
    ds_write_b64 v7, v[12:13] offset:14256
    v_pk_mul_f32 v[76:77], v[72:73], v[84:85] op_sel:[0,0] op_sel_hi:[1,0]
    v_pk_mul_f32 v[78:79], v[74:75], v[86:87] op_sel:[0,0] op_sel_hi:[1,0]
    v_pk_fma_f32 v[72:73], v[72:73], v[84:85], v[76:77] op_sel:[1,1,0] op_sel_hi:[0,1,1] neg_lo:[1,0,0]
    v_pk_fma_f32 v[74:75], v[74:75], v[86:87], v[78:79] op_sel:[1,1,0] op_sel_hi:[0,1,1] neg_lo:[1,0,0]
    v_cvt_pk_bf16_f32 v10, v72, v73
    v_cvt_pk_bf16_f32 v11, v74, v75
    ds_write_b64 v7, v[10:11] offset:14784
    v_pk_mul_f32 v[76:77], v[72:73], v[84:85] op_sel:[0,0] op_sel_hi:[1,0]
    v_pk_mul_f32 v[78:79], v[74:75], v[86:87] op_sel:[0,0] op_sel_hi:[1,0]
    v_pk_fma_f32 v[72:73], v[72:73], v[84:85], v[76:77] op_sel:[1,1,0] op_sel_hi:[0,1,1] neg_lo:[1,0,0]
    v_pk_fma_f32 v[74:75], v[74:75], v[86:87], v[78:79] op_sel:[1,1,0] op_sel_hi:[0,1,1] neg_lo:[1,0,0]
    v_cvt_pk_bf16_f32 v12, v72, v73
    v_cvt_pk_bf16_f32 v13, v74, v75
    ds_write_b64 v7, v[12:13] offset:15312
    v_pk_mul_f32 v[76:77], v[72:73], v[84:85] op_sel:[0,0] op_sel_hi:[1,0]
    v_pk_mul_f32 v[78:79], v[74:75], v[86:87] op_sel:[0,0] op_sel_hi:[1,0]
    v_pk_fma_f32 v[72:73], v[72:73], v[84:85], v[76:77] op_sel:[1,1,0] op_sel_hi:[0,1,1] neg_lo:[1,0,0]
    v_pk_fma_f32 v[74:75], v[74:75], v[86:87], v[78:79] op_sel:[1,1,0] op_sel_hi:[0,1,1] neg_lo:[1,0,0]
    v_cvt_pk_bf16_f32 v10, v72, v73
    v_cvt_pk_bf16_f32 v11, v74, v75
    ds_write_b64 v7, v[10:11] offset:15840
    v_pk_mul_f32 v[76:77], v[72:73], v[84:85] op_sel:[0,0] op_sel_hi:[1,0]
    v_pk_mul_f32 v[78:79], v[74:75], v[86:87] op_sel:[0,0] op_sel_hi:[1,0]
    v_pk_fma_f32 v[72:73], v[72:73], v[84:85], v[76:77] op_sel:[1,1,0] op_sel_hi:[0,1,1] neg_lo:[1,0,0]
    v_pk_fma_f32 v[74:75], v[74:75], v[86:87], v[78:79] op_sel:[1,1,0] op_sel_hi:[0,1,1] neg_lo:[1,0,0]
    v_cvt_pk_bf16_f32 v12, v72, v73
    v_cvt_pk_bf16_f32 v13, v74, v75
    ds_write_b64 v7, v[12:13] offset:16368
    s_waitcnt lgkmcnt(0)
    buffer_load_dwordx2 v[30:31], v5, s[40:43], s37 offen offset:3456
    ds_read_b128 v[128:131], v126 offset:16896
    ds_read_b128 v[132:135], v126 offset:0
    ds_read_b128 v[136:139], v126 offset:16928
    ds_read_b128 v[140:143], v126 offset:32
    ds_read_b128 v[144:147], v126 offset:16960
    ds_read_b128 v[148:151], v126 offset:64
    ds_read_b128 v[152:155], v126 offset:16992
    ds_read_b128 v[156:159], v126 offset:96
    ds_read_b128 v[160:163], v126 offset:17024
    ds_read_b128 v[164:167], v126 offset:128
    ds_read_b128 v[168:171], v126 offset:17056
    ds_read_b128 v[172:175], v126 offset:160
    ds_read_b128 v[176:179], v126 offset:17088
    ds_read_b128 v[180:183], v126 offset:192
    buffer_load_dwordx4 v[32:35], v4, s[44:47], s48 offen sc1
    buffer_load_dwordx4 v[36:39], v4, s[44:47], s49 offen sc1
    buffer_load_dwordx4 v[40:43], v4, s[44:47], s50 offen sc1
    buffer_load_dwordx4 v[44:47], v4, s[44:47], s51 offen sc1
    s_waitcnt lgkmcnt(12)
    v_mfma_f32_32x32x16_bf16 v[56:71], v[128:131], v[132:135], 0
    ds_read_b128 v[184:187], v126 offset:17120
    ds_read_b128 v[188:191], v126 offset:224
    v_mov_b32 v112, 0
    v_mov_b32 v113, 0
    v_mov_b32 v114, 0
    s_waitcnt lgkmcnt(12)
    v_mfma_f32_32x32x16_bf16 v[56:71], v[136:139], v[140:143], v[56:71]
    ds_read_b128 v[192:195], v126 offset:17152
    ds_read_b128 v[196:199], v126 offset:256
    v_mov_b32 v115, 0
    s_lshr_b32 s60, s60, s36
    s_lshl_b32 s60, s60, 16
    s_waitcnt lgkmcnt(12)
    v_mfma_f32_32x32x16_bf16 v[56:71], v[144:147], v[148:151], v[56:71]
    ds_read_b128 v[200:203], v126 offset:17184
    ds_read_b128 v[204:207], v126 offset:288
    v_mov_b32 v111, s60
    v_cmp_eq_u32 vcc, 0, v2
    v_and_b32 v104, 15, v2
    s_waitcnt lgkmcnt(12)
    v_mfma_f32_32x32x16_bf16 v[56:71], v[152:155], v[156:159], v[56:71]
    ds_read_b128 v[208:211], v126 offset:17216
    ds_read_b128 v[212:215], v126 offset:320
    v_lshrrev_b32 v105, 4, v2
    v_cndmask_b32 v111, 0, v111, vcc
    v_lshlrev_b32 v105, 3, v105
    s_waitcnt lgkmcnt(12)
    v_mfma_f32_32x32x16_bf16 v[56:71], v[160:163], v[164:167], v[56:71]
    ds_read_b128 v[216:219], v126 offset:17248
    ds_read_b128 v[220:223], v126 offset:352
    v_sub_u32 v104, v104, v105
    v_and_b32 v105, 1, v104
    v_lshlrev_b32 v105, 4, v105
    s_waitcnt lgkmcnt(12)
    v_mfma_f32_32x32x16_bf16 v[56:71], v[168:171], v[172:175], v[56:71]
    ds_read_b128 v[224:227], v126 offset:17280
    ds_read_b128 v[228:231], v126 offset:384
    v_mov_b32 v106, 0x3f80
    v_lshlrev_b32 v105, v105, v106
    v_ashrrev_i32 v104, 1, v104
    s_waitcnt lgkmcnt(12)
    v_mfma_f32_32x32x16_bf16 v[56:71], v[176:179], v[180:183], v[56:71]
    ds_read_b128 v[232:235], v126 offset:17312
    ds_read_b128 v[236:239], v126 offset:416
    v_cmp_eq_u32 vcc, 0, v104
    s_nop 1
    v_cndmask_b32 v52, 0, v105, vcc
    s_waitcnt lgkmcnt(12)
    v_mfma_f32_32x32x16_bf16 v[56:71], v[184:187], v[188:191], v[56:71]
    ds_read_b128 v[240:243], v126 offset:17344
    ds_read_b128 v[244:247], v126 offset:448
    v_cmp_eq_u32 vcc, 1, v104
    s_nop 1
    v_cndmask_b32 v53, 0, v105, vcc
    s_waitcnt lgkmcnt(12)
    v_mfma_f32_32x32x16_bf16 v[56:71], v[192:195], v[196:199], v[56:71]
    ds_read_b128 v[248:251], v126 offset:17376
    ds_read_b128 v[252:255], v126 offset:480
    v_cmp_eq_u32 vcc, 2, v104
    s_nop 1
    v_cndmask_b32 v54, 0, v105, vcc
    s_waitcnt lgkmcnt(12)
    v_mfma_f32_32x32x16_bf16 v[56:71], v[200:203], v[204:207], v[56:71]
    v_cmp_eq_u32 vcc, 3, v104
    s_nop 1
    v_cndmask_b32 v55, 0, v105, vcc
    s_waitcnt vmcnt(7)
    v_lshlrev_b32 v72, 16, v16
    s_waitcnt lgkmcnt(10)
    v_mfma_f32_32x32x16_bf16 v[56:71], v[208:211], v[212:215], v[56:71]
    v_and_b32 v73, 0xffff0000, v16
    v_lshlrev_b32 v74, 16, v17
    v_and_b32 v75, 0xffff0000, v17
    v_lshlrev_b32 v76, 16, v18
    v_and_b32 v77, 0xffff0000, v18
    s_waitcnt lgkmcnt(8)
    v_mfma_f32_32x32x16_bf16 v[56:71], v[216:219], v[220:223], v[56:71]
    v_lshlrev_b32 v78, 16, v19
    v_and_b32 v79, 0xffff0000, v19
    v_lshlrev_b32 v80, 16, v20
    v_and_b32 v81, 0xffff0000, v20
    v_lshlrev_b32 v82, 16, v21
    s_waitcnt lgkmcnt(6)
    v_mfma_f32_32x32x16_bf16 v[56:71], v[224:227], v[228:231], v[56:71]
    v_and_b32 v83, 0xffff0000, v21
    v_lshlrev_b32 v84, 16, v22
    v_and_b32 v85, 0xffff0000, v22
    v_lshlrev_b32 v86, 16, v23
    v_and_b32 v87, 0xffff0000, v23
    s_waitcnt lgkmcnt(4)
    v_mfma_f32_32x32x16_bf16 v[56:71], v[232:235], v[236:239], v[56:71]
    v_lshlrev_b32 v88, 16, v24
    v_and_b32 v89, 0xffff0000, v24
    v_lshlrev_b32 v90, 16, v25
    v_and_b32 v91, 0xffff0000, v25
    s_waitcnt lgkmcnt(2)
    v_mfma_f32_32x32x16_bf16 v[56:71], v[240:243], v[244:247], v[56:71]
    s_waitcnt lgkmcnt(0)
    v_mfma_f32_32x32x16_bf16 v[56:71], v[248:251], v[252:255], v[56:71]
    ds_write_b128 v127, v[112:115] offset:4096
    s_nop 10
    v_mov_b32_dpp v104, v64 wave_rol:1 row_mask:0xf bank_mask:0xf
    v_mov_b32_dpp v105, v66 wave_rol:1 row_mask:0xf bank_mask:0xf
    v_mov_b32_dpp v106, v67 wave_rol:1 row_mask:0xf bank_mask:0xf
    v_mov_b32_dpp v107, v68 wave_rol:1 row_mask:0xf bank_mask:0xf
    v_mov_b32_dpp v104, v56 wave_shl:1 row_mask:0xf bank_mask:0xf
    v_mov_b32_dpp v105, v64 wave_shl:1 row_mask:0xf bank_mask:0xf
    v_mov_b32_dpp v106, v66 wave_shl:1 row_mask:0xf bank_mask:0xf
    v_mov_b32_dpp v107, v67 wave_shl:1 row_mask:0xf bank_mask:0xf
    v_add_f32 v56, v56, v111
    v_cndmask_b32 v63, v63, v104, s[54:55]
    v_mov_b32 v139, 0
    v_mov_b32 v108, 0
    v_cvt_pk_bf16_f32 v128, v63, v62
    v_cvt_pk_bf16_f32 v129, v61, v60
    v_cvt_pk_bf16_f32 v130, v59, v58
    v_cvt_pk_bf16_f32 v131, v57, v56
    v_mov_b32_dpp v139, v128 wave_shr:1 row_mask:0xf bank_mask:0xf
    v_mov_b32_dpp v108, v129 wave_shr:1 row_mask:0xf bank_mask:0xf
    ds_write_b128 v9, v[128:131] offset:3072
    v_alignbit_b32 v132, v129, v128, 16
    v_alignbit_b32 v133, v130, v129, 16
    v_alignbit_b32 v134, v131, v130, 16
    v_alignbit_b32 v135, v139, v131, 16
    ds_write_b128 v9, v[132:135] offset:7232
    v_mov_b32 v136, v129
    v_mov_b32 v137, v130
    v_mov_b32 v138, v131
    ds_write_b128 v9, v[136:139] offset:11392
    v_alignbit_b32 v140, v130, v129, 16
    v_alignbit_b32 v141, v131, v130, 16
    v_alignbit_b32 v142, v139, v131, 16
    v_alignbit_b32 v143, v108, v139, 16
    ds_write_b128 v9, v[140:143] offset:15552
    v_mov_b32_dpp v155, v128 wave_ror:1 row_mask:0xf bank_mask:0xf
    v_mov_b32_dpp v108, v129 wave_ror:1 row_mask:0xf bank_mask:0xf
    v_cvt_pk_bf16_f32 v144, v105, v105
    v_cvt_pk_bf16_f32 v145, v65, v65
    v_cvt_pk_bf16_f32 v146, v65, v64
    v_cvt_pk_bf16_f32 v147, v64, v64
    v_mov_b32_dpp v155, v144 wave_shr:1 row_mask:0xf bank_mask:0xf
    v_mov_b32_dpp v108, v145 wave_shr:1 row_mask:0xf bank_mask:0xf
    ds_write_b128 v9, v[144:147] offset:2048
    v_alignbit_b32 v148, v145, v144, 16
    v_alignbit_b32 v149, v146, v145, 16
    v_alignbit_b32 v150, v147, v146, 16
    v_alignbit_b32 v151, v155, v147, 16
    ds_write_b128 v9, v[148:151] offset:6208
    v_mov_b32 v152, v145
    v_mov_b32 v153, v146
    v_mov_b32 v154, v147
    ds_write_b128 v9, v[152:155] offset:10368
    v_alignbit_b32 v156, v146, v145, 16
    v_alignbit_b32 v157, v147, v146, 16
    v_alignbit_b32 v158, v155, v147, 16
    v_alignbit_b32 v159, v108, v155, 16
    ds_write_b128 v9, v[156:159] offset:14528
    v_cndmask_b32 v71, v66, v106, s[52:53]
    v_mov_b32_dpp v139, v144 wave_ror:1 row_mask:0xf bank_mask:0xf
    v_mov_b32_dpp v108, v145 wave_ror:1 row_mask:0xf bank_mask:0xf
    v_cvt_pk_bf16_f32 v128, v106, v106
    v_cvt_pk_bf16_f32 v129, v106, v71
    v_cvt_pk_bf16_f32 v130, v66, v66
    v_cvt_pk_bf16_f32 v131, v66, v66
    v_mov_b32_dpp v139, v128 wave_shr:1 row_mask:0xf bank_mask:0xf
    v_mov_b32_dpp v108, v129 wave_shr:1 row_mask:0xf bank_mask:0xf
    ds_write_b128 v9, v[128:131] offset:1024
    v_alignbit_b32 v132, v129, v128, 16
    v_alignbit_b32 v133, v130, v129, 16
    v_alignbit_b32 v134, v131, v130, 16
    v_alignbit_b32 v135, v139, v131, 16
    ds_write_b128 v9, v[132:135] offset:5184
    v_mov_b32 v136, v129
    v_mov_b32 v137, v130
    v_mov_b32 v138, v131
    ds_write_b128 v9, v[136:139] offset:9344
    v_alignbit_b32 v140, v130, v129, 16
    v_alignbit_b32 v141, v131, v130, 16
    v_alignbit_b32 v142, v139, v131, 16
    v_alignbit_b32 v143, v108, v139, 16
    ds_write_b128 v9, v[140:143] offset:13504
    v_cndmask_b32 v71, v67, v107, s[52:53]
    v_mov_b32_dpp v155, v128 wave_ror:1 row_mask:0xf bank_mask:0xf
    v_mov_b32_dpp v108, v129 wave_ror:1 row_mask:0xf bank_mask:0xf
    v_cvt_pk_bf16_f32 v144, v107, v107
    v_cvt_pk_bf16_f32 v145, v107, v71
    v_cvt_pk_bf16_f32 v146, v67, v67
    v_cvt_pk_bf16_f32 v147, v67, v67
    v_mov_b32_dpp v155, v144 wave_shr:1 row_mask:0xf bank_mask:0xf
    v_mov_b32_dpp v108, v145 wave_shr:1 row_mask:0xf bank_mask:0xf
    ds_write_b128 v9, v[144:147] offset:0
    v_alignbit_b32 v148, v145, v144, 16
    v_alignbit_b32 v149, v146, v145, 16
    v_alignbit_b32 v150, v147, v146, 16
    v_alignbit_b32 v151, v155, v147, 16
    ds_write_b128 v9, v[148:151] offset:4160
    v_mov_b32 v152, v145
    v_mov_b32 v153, v146
    v_mov_b32 v154, v147
    ds_write_b128 v9, v[152:155] offset:8320
    v_alignbit_b32 v156, v146, v145, 16
    v_alignbit_b32 v157, v147, v146, 16
    v_alignbit_b32 v158, v155, v147, 16
    v_alignbit_b32 v159, v108, v155, 16
    ds_write_b128 v9, v[156:159] offset:12480
    s_mov_b32 s39, 0x40000
L_spoll:
    s_waitcnt vmcnt(0)
    v_xor_b32 v104, s58, v33
    v_xor_b32 v105, s58, v35
    v_or_b32 v104, v104, v105
    v_xor_b32 v105, s58, v37
    v_or_b32 v104, v104, v105
    v_xor_b32 v105, s58, v39
    v_or_b32 v104, v104, v105
    v_xor_b32 v105, s58, v41
    v_or_b32 v104, v104, v105
    v_xor_b32 v105, s58, v43
    v_or_b32 v104, v104, v105
    v_xor_b32 v105, s58, v45
    v_or_b32 v104, v104, v105
    v_xor_b32 v105, s58, v47
    v_or_b32 v104, v104, v105
    v_cmp_ne_u32 vcc, 0, v104
    s_cbranch_vccnz L_spoll_spin
L_spoll_ok:
    s_waitcnt lgkmcnt(0)
    v_and_b32 v33, 0xffff0000, v32
    v_and_b32 v35, 0xffff0000, v34
    v_and_b32 v37, 0xffff0000, v36
    v_and_b32 v39, 0xffff0000, v38
    v_and_b32 v41, 0xffff0000, v40
    v_and_b32 v43, 0xffff0000, v42
    v_and_b32 v45, 0xffff0000, v44
    v_and_b32 v47, 0xffff0000, v46
    v_rcp_f32 v33, v33
    v_lshlrev_b32 v32, 16, v32
    ds_read_b64 v[128:129], v120 offset:4032
    ds_read_b64 v[130:131], v120 offset:4040
    v_rcp_f32 v35, v35
    v_lshlrev_b32 v34, 16, v34
    ds_read_b64 v[132:133], v120 offset:3520
    ds_read_b64 v[134:135], v120 offset:3528
    v_rcp_f32 v37, v37
    v_lshlrev_b32 v36, 16, v36
    ds_read_b64 v[136:137], v120 offset:3008
    ds_read_b64 v[138:139], v120 offset:3016
    v_rcp_f32 v39, v39
    v_lshlrev_b32 v38, 16, v38
    ds_read_b64 v[140:141], v120 offset:2496
    ds_read_b64 v[142:143], v120 offset:2504
    v_rcp_f32 v41, v41
    v_lshlrev_b32 v40, 16, v40
    ds_read_b64 v[144:145], v120 offset:1984
    ds_read_b64 v[146:147], v120 offset:1992
    v_rcp_f32 v43, v43
    v_lshlrev_b32 v42, 16, v42
    ds_read_b64 v[148:149], v120 offset:1472
    ds_read_b64 v[150:151], v120 offset:1480
    v_rcp_f32 v45, v45
    v_lshlrev_b32 v44, 16, v44
    ds_read_b64 v[152:153], v120 offset:960
    ds_read_b64 v[154:155], v120 offset:968
    v_rcp_f32 v47, v47
    v_lshlrev_b32 v46, 16, v46
    ds_read_b64 v[156:157], v120 offset:448
    ds_read_b64 v[158:159], v120 offset:456
    v_lshlrev_b32 v92, 16, v26
    v_and_b32 v93, 0xffff0000, v26
    v_lshlrev_b32 v94, 16, v27
    v_and_b32 v95, 0xffff0000, v27
    v_lshlrev_b32 v96, 16, v28
    v_and_b32 v97, 0xffff0000, v28
    v_lshlrev_b32 v98, 16, v29
    v_and_b32 v99, 0xffff0000, v29
    v_lshlrev_b32 v100, 16, v30
    v_and_b32 v101, 0xffff0000, v30
    v_lshlrev_b32 v102, 16, v31
    v_and_b32 v103, 0xffff0000, v31
    v_mul_f32 v32, v32, v33
    v_mul_f32 v34, v34, v35
    v_mul_f32 v36, v36, v37
    v_mul_f32 v38, v38, v39
    v_mul_f32 v40, v40, v41
    v_mul_f32 v42, v42, v43
    v_mul_f32 v44, v44, v45
    v_mul_f32 v46, v46, v47
    v_pk_fma_f32 v[72:73], v[72:73], v[32:33], v[32:33] op_sel:[0,1,0] op_sel_hi:[1,1,0] neg_lo:[0,0,1] neg_hi:[0,0,1]
    v_pk_fma_f32 v[76:77], v[76:77], v[34:35], v[34:35] op_sel:[0,1,0] op_sel_hi:[1,1,0] neg_lo:[0,0,1] neg_hi:[0,0,1]
    v_pk_fma_f32 v[80:81], v[80:81], v[36:37], v[36:37] op_sel:[0,1,0] op_sel_hi:[1,1,0] neg_lo:[0,0,1] neg_hi:[0,0,1]
    v_pk_fma_f32 v[84:85], v[84:85], v[38:39], v[38:39] op_sel:[0,1,0] op_sel_hi:[1,1,0] neg_lo:[0,0,1] neg_hi:[0,0,1]
    v_pk_fma_f32 v[88:89], v[88:89], v[40:41], v[40:41] op_sel:[0,1,0] op_sel_hi:[1,1,0] neg_lo:[0,0,1] neg_hi:[0,0,1]
    v_pk_fma_f32 v[92:93], v[92:93], v[42:43], v[42:43] op_sel:[0,1,0] op_sel_hi:[1,1,0] neg_lo:[0,0,1] neg_hi:[0,0,1]
    v_pk_fma_f32 v[96:97], v[96:97], v[44:45], v[44:45] op_sel:[0,1,0] op_sel_hi:[1,1,0] neg_lo:[0,0,1] neg_hi:[0,0,1]
    v_pk_fma_f32 v[100:101], v[100:101], v[46:47], v[46:47] op_sel:[0,1,0] op_sel_hi:[1,1,0] neg_lo:[0,0,1] neg_hi:[0,0,1]
    v_cvt_pk_bf16_f32 v104, v72, v76
    v_cvt_pk_bf16_f32 v105, v80, v84
    v_cvt_pk_bf16_f32 v106, v88, v92
    v_cvt_pk_bf16_f32 v107, v96, v100
    ds_write_b128 v124, v[104:107] offset:0
    v_cvt_pk_bf16_f32 v108, v73, v77
    v_cvt_pk_bf16_f32 v109, v81, v85
    v_cvt_pk_bf16_f32 v110, v89, v93
    v_cvt_pk_bf16_f32 v111, v97, v101
    ds_write_b128 v124, v[108:111] offset:4608
    v_pk_fma_f32 v[74:75], v[74:75], v[32:33], v[32:33] op_sel:[0,1,0] op_sel_hi:[1,1,0] neg_lo:[0,0,1] neg_hi:[0,0,1]
    v_pk_fma_f32 v[78:79], v[78:79], v[34:35], v[34:35] op_sel:[0,1,0] op_sel_hi:[1,1,0] neg_lo:[0,0,1] neg_hi:[0,0,1]
    v_pk_fma_f32 v[82:83], v[82:83], v[36:37], v[36:37] op_sel:[0,1,0] op_sel_hi:[1,1,0] neg_lo:[0,0,1] neg_hi:[0,0,1]
    v_pk_fma_f32 v[86:87], v[86:87], v[38:39], v[38:39] op_sel:[0,1,0] op_sel_hi:[1,1,0] neg_lo:[0,0,1] neg_hi:[0,0,1]
    v_pk_fma_f32 v[90:91], v[90:91], v[40:41], v[40:41] op_sel:[0,1,0] op_sel_hi:[1,1,0] neg_lo:[0,0,1] neg_hi:[0,0,1]
    v_pk_fma_f32 v[94:95], v[94:95], v[42:43], v[42:43] op_sel:[0,1,0] op_sel_hi:[1,1,0] neg_lo:[0,0,1] neg_hi:[0,0,1]
    v_pk_fma_f32 v[98:99], v[98:99], v[44:45], v[44:45] op_sel:[0,1,0] op_sel_hi:[1,1,0] neg_lo:[0,0,1] neg_hi:[0,0,1]
    v_pk_fma_f32 v[102:103], v[102:103], v[46:47], v[46:47] op_sel:[0,1,0] op_sel_hi:[1,1,0] neg_lo:[0,0,1] neg_hi:[0,0,1]
    v_cvt_pk_bf16_f32 v112, v74, v78
    v_cvt_pk_bf16_f32 v113, v82, v86
    v_cvt_pk_bf16_f32 v114, v90, v94
    v_cvt_pk_bf16_f32 v115, v98, v102
    ds_write_b128 v124, v[112:115] offset:9216
    v_cvt_pk_bf16_f32 v116, v75, v79
    v_cvt_pk_bf16_f32 v117, v83, v87
    v_cvt_pk_bf16_f32 v118, v91, v95
    v_cvt_pk_bf16_f32 v119, v99, v103
    ds_write_b128 v124, v[116:119] offset:13824
    s_waitcnt lgkmcnt(0)
    s_barrier
    ds_read_b128 v[160:163], v121 offset:448
    ds_read_b128 v[164:167], v121 offset:960
    ds_read_b128 v[168:171], v121 offset:1472
    ds_read_b128 v[172:175], v121 offset:1984
    ds_read_b128 v[176:179], v121 offset:2496
    ds_read_b128 v[180:183], v121 offset:3008
    ds_read_b128 v[184:187], v121 offset:3520
    ds_read_b128 v[188:191], v121 offset:4032
    s_waitcnt lgkmcnt(0)
    v_mfma_f32_16x16x32_bf16 v[56:59], v[128:131], v[160:163], 0
    ds_read_b128 v[224:227], v121 offset:384
    s_lshl_b32 s36, s29, 2
    s_add_u32 s36, s36, s30
    v_mfma_f32_16x16x32_bf16 v[60:63], v[128:131], v[164:167], 0
    ds_read_b64 v[192:193], v120 offset:3968
L_pg2:
    s_cbranch_execz L_wret0
    s_nop 0
    s_lshl_b32 s36, s36, 10
    v_mfma_f32_16x16x32_bf16 v[60:63], v[132:135], v[160:163], v[60:63]
    ds_read_b64 v[194:195], v120 offset:3976
    s_mul_i32 s37, s28, 663552
    s_add_u32 s36, s36, s37
    v_mfma_f32_16x16x32_bf16 v[64:67], v[128:131], v[168:171], 0
    ds_read_b128 v[228:231], v121 offset:896
    s_add_u32 s36, s36, 589824
    v_mfma_f32_16x16x32_bf16 v[64:67], v[132:135], v[164:167], v[64:67]
    ds_read_b64 v[196:197], v120 offset:3456
    v_and_b32 v34, 7, v2
    v_mfma_f32_16x16x32_bf16 v[64:67], v[136:139], v[160:163], v[64:67]
    ds_read_b64 v[198:199], v120 offset:3464
    v_lshl_add_u32 v34, v34, 7, s36
    v_mfma_f32_16x16x32_bf16 v[68:71], v[128:131], v[172:175], 0
    v_mfma_f32_16x16x32_bf16 v[68:71], v[132:135], v[168:171], v[68:71]
    ds_read_b128 v[232:235], v121 offset:1408
    global_load_dword v34, v34, s[26:27]
    v_mfma_f32_16x16x32_bf16 v[68:71], v[136:139], v[164:167], v[68:71]
    ds_read_b64 v[200:201], v120 offset:2944
    s_mov_b32 s54, 0x05040100
    v_mfma_f32_16x16x32_bf16 v[68:71], v[140:143], v[160:163], v[68:71]
    ds_read_b64 v[202:203], v120 offset:2952
    s_mov_b32 s55, 0x07060302
    v_mfma_f32_16x16x32_bf16 v[72:75], v[128:131], v[176:179], 0
    ds_read_b128 v[236:239], v121 offset:1920
    v_add_u32 v124, 67584, v125
    v_mfma_f32_16x16x32_bf16 v[72:75], v[132:135], v[172:175], v[72:75]
    ds_read_b64 v[204:205], v120 offset:2432
    v_perm_b32 v104, v18, v16, s54
    v_mfma_f32_16x16x32_bf16 v[72:75], v[136:139], v[168:171], v[72:75]
    ds_read_b64 v[206:207], v120 offset:2440
    v_perm_b32 v105, v22, v20, s54
    v_mfma_f32_16x16x32_bf16 v[72:75], v[140:143], v[164:167], v[72:75]
    v_mfma_f32_16x16x32_bf16 v[72:75], v[144:147], v[160:163], v[72:75]
    ds_read_b128 v[240:243], v121 offset:2432
    v_perm_b32 v106, v26, v24, s54
    v_mfma_f32_16x16x32_bf16 v[76:79], v[128:131], v[180:183], 0
    ds_read_b64 v[208:209], v120 offset:1920
    v_perm_b32 v107, v30, v28, s54
    v_mfma_f32_16x16x32_bf16 v[76:79], v[132:135], v[176:179], v[76:79]
    ds_read_b64 v[210:211], v120 offset:1928
    ds_write_b128 v125, v[104:107] offset:0
    v_mfma_f32_16x16x32_bf16 v[76:79], v[136:139], v[172:175], v[76:79]
    ds_read_b128 v[244:247], v121 offset:2944
    v_perm_b32 v108, v18, v16, s55
    v_mfma_f32_16x16x32_bf16 v[76:79], v[140:143], v[168:171], v[76:79]
    ds_read_b64 v[212:213], v120 offset:1408
    v_perm_b32 v109, v22, v20, s55
    v_mfma_f32_16x16x32_bf16 v[76:79], v[144:147], v[164:167], v[76:79]
    ds_read_b64 v[214:215], v120 offset:1416
    v_perm_b32 v110, v26, v24, s55
    v_mfma_f32_16x16x32_bf16 v[76:79], v[148:151], v[160:163], v[76:79]
    v_mfma_f32_16x16x32_bf16 v[80:83], v[128:131], v[184:187], 0
    ds_read_b128 v[248:251], v121 offset:3456
    v_perm_b32 v111, v30, v28, s55
    v_mfma_f32_16x16x32_bf16 v[80:83], v[132:135], v[180:183], v[80:83]
    ds_read_b64 v[216:217], v120 offset:896
    ds_write_b128 v125, v[108:111] offset:33792
    v_mfma_f32_16x16x32_bf16 v[80:83], v[136:139], v[176:179], v[80:83]
    ds_read_b64 v[218:219], v120 offset:904
    v_perm_b32 v112, v19, v17, s54
    v_mfma_f32_16x16x32_bf16 v[80:83], v[140:143], v[172:175], v[80:83]
    ds_read_b128 v[252:255], v121 offset:3968
    v_perm_b32 v113, v23, v21, s54
    v_mfma_f32_16x16x32_bf16 v[80:83], v[144:147], v[168:171], v[80:83]
    ds_read_b64 v[220:221], v120 offset:384
    v_perm_b32 v114, v27, v25, s54
    v_mfma_f32_16x16x32_bf16 v[80:83], v[148:151], v[164:167], v[80:83]
    ds_read_b64 v[222:223], v120 offset:392
    v_perm_b32 v115, v31, v29, s54
    v_mfma_f32_16x16x32_bf16 v[80:83], v[152:155], v[160:163], v[80:83]
    v_mfma_f32_16x16x32_bf16 v[84:87], v[128:131], v[188:191], 0
    ds_write_b128 v124, v[112:115] offset:0
    v_mfma_f32_16x16x32_bf16 v[84:87], v[132:135], v[184:187], v[84:87]
    v_perm_b32 v116, v19, v17, s55
    v_mfma_f32_16x16x32_bf16 v[84:87], v[136:139], v[180:183], v[84:87]
    v_perm_b32 v117, v23, v21, s55
    v_mfma_f32_16x16x32_bf16 v[84:87], v[140:143], v[176:179], v[84:87]
    v_perm_b32 v118, v27, v25, s55
    v_mfma_f32_16x16x32_bf16 v[84:87], v[144:147], v[172:175], v[84:87]
    v_perm_b32 v119, v31, v29, s55
    v_mfma_f32_16x16x32_bf16 v[84:87], v[148:151], v[168:171], v[84:87]
    ds_write_b128 v124, v[116:119] offset:33792
    v_mfma_f32_16x16x32_bf16 v[84:87], v[152:155], v[164:167], v[84:87]
    v_mfma_f32_16x16x32_bf16 v[84:87], v[156:159], v[160:163], v[84:87]
    s_waitcnt lgkmcnt(0)
    v_mfma_f32_16x16x32_bf16 v[56:59], v[192:195], v[224:227], v[56:59]
    ds_read_b128 v[160:163], v121 offset:320
    s_lshl_b32 s39, s33, 12
    v_mfma_f32_16x16x32_bf16 v[60:63], v[192:195], v[228:231], v[60:63]
    ds_read_b64 v[128:129], v120 offset:3904
    v_mfma_f32_16x16x32_bf16 v[60:63], v[196:199], v[224:227], v[60:63]
    ds_read_b64 v[130:131], v120 offset:3912
    v_mul_u32_u24 v14, 2560, v0
    v_mfma_f32_16x16x32_bf16 v[64:67], v[192:195], v[232:235], v[64:67]
    ds_read_b128 v[164:167], v121 offset:832
    v_mfma_f32_16x16x32_bf16 v[64:67], v[196:199], v[228:231], v[64:67]
    ds_read_b64 v[132:133], v120 offset:3392
    v_mfma_f32_16x16x32_bf16 v[64:67], v[200:203], v[224:227], v[64:67]
    ds_read_b64 v[134:135], v120 offset:3400
    v_lshlrev_b32 v9, 4, v2
    v_mfma_f32_16x16x32_bf16 v[68:71], v[192:195], v[236:239], v[68:71]
    v_mfma_f32_16x16x32_bf16 v[68:71], v[196:199], v[232:235], v[68:71]
    ds_read_b128 v[168:171], v121 offset:1344
    s_lshl_b32 s31, s28, 2
    v_mfma_f32_16x16x32_bf16 v[68:71], v[200:203], v[228:231], v[68:71]
    ds_read_b64 v[136:137], v120 offset:2880
    v_mfma_f32_16x16x32_bf16 v[68:71], v[204:207], v[224:227], v[68:71]
    ds_read_b64 v[138:139], v120 offset:2888
    v_mfma_f32_16x16x32_bf16 v[72:75], v[192:195], v[240:243], v[72:75]
    ds_read_b128 v[172:175], v121 offset:1856
    s_add_u32 s31, s31, s30
    v_mfma_f32_16x16x32_bf16 v[72:75], v[196:199], v[236:239], v[72:75]
    ds_read_b64 v[140:141], v120 offset:2368
    v_mfma_f32_16x16x32_bf16 v[72:75], v[200:203], v[232:235], v[72:75]
    ds_read_b64 v[142:143], v120 offset:2376
    s_mul_i32 s32, s31, 331776
    v_mfma_f32_16x16x32_bf16 v[72:75], v[204:207], v[228:231], v[72:75]
    v_mfma_f32_16x16x32_bf16 v[72:75], v[208:211], v[224:227], v[72:75]
    ds_read_b128 v[176:179], v121 offset:2368
    v_mfma_f32_16x16x32_bf16 v[76:79], v[192:195], v[244:247], v[76:79]
    ds_read_b64 v[144:145], v120 offset:1856
    s_add_u32 s12, s22, s32
    s_addc_u32 s13, s23, 0
    s_and_b32 s13, s13, 0xffff
    s_mov_b32 s14, 331776
    s_mov_b32 s15, 0x20000
    v_mfma_f32_16x16x32_bf16 v[76:79], v[196:199], v[240:243], v[76:79]
    ds_read_b64 v[146:147], v120 offset:1864
    v_mfma_f32_16x16x32_bf16 v[76:79], v[200:203], v[236:239], v[76:79]
    ds_read_b128 v[180:183], v121 offset:2880
    s_add_u32 s16, s22, 10682368
    s_addc_u32 s17, s23, 0
    s_and_b32 s17, s17, 0xffff
    s_mov_b32 s18, 57344
    s_mov_b32 s19, 0x20000
    v_mfma_f32_16x16x32_bf16 v[76:79], v[204:207], v[232:235], v[76:79]
    ds_read_b64 v[148:149], v120 offset:1344
    v_mfma_f32_16x16x32_bf16 v[76:79], v[208:211], v[228:231], v[76:79]
    ds_read_b64 v[150:151], v120 offset:1352
    v_mfma_f32_16x16x32_bf16 v[76:79], v[212:215], v[224:227], v[76:79]
    s_add_u32 s8, s22, 10747904
    s_addc_u32 s9, s23, 0
    s_and_b32 s9, s9, 0xffff
    s_mov_b32 s10, 2359296
    s_mov_b32 s11, 0x20000
    v_mfma_f32_16x16x32_bf16 v[80:83], v[192:195], v[248:251], v[80:83]
    ds_read_b128 v[184:187], v121 offset:3392
    v_mfma_f32_16x16x32_bf16 v[80:83], v[196:199], v[244:247], v[80:83]
    ds_read_b64 v[152:153], v120 offset:832
    s_lshl_b32 s35, s28, 11
    v_mfma_f32_16x16x32_bf16 v[80:83], v[200:203], v[240:243], v[80:83]
    ds_read_b64 v[154:155], v120 offset:840
    v_mfma_f32_16x16x32_bf16 v[80:83], v[204:207], v[236:239], v[80:83]
    ds_read_b128 v[188:191], v121 offset:3904
    v_mfma_f32_16x16x32_bf16 v[80:83], v[208:211], v[232:235], v[80:83]
    ds_read_b64 v[156:157], v120 offset:320
    s_add_u32 s35, s35, 20480
    v_mfma_f32_16x16x32_bf16 v[80:83], v[212:215], v[228:231], v[80:83]
    ds_read_b64 v[158:159], v120 offset:328
    v_mfma_f32_16x16x32_bf16 v[80:83], v[216:219], v[224:227], v[80:83]
    v_min_u32 v3, 13, v2
    v_mfma_f32_16x16x32_bf16 v[84:87], v[192:195], v[252:255], v[84:87]
    v_mfma_f32_16x16x32_bf16 v[84:87], v[196:199], v[248:251], v[84:87]
    v_mfma_f32_16x16x32_bf16 v[84:87], v[200:203], v[244:247], v[84:87]
    v_lshlrev_b32 v3, 7, v3
    v_mfma_f32_16x16x32_bf16 v[84:87], v[204:207], v[240:243], v[84:87]
    v_mfma_f32_16x16x32_bf16 v[84:87], v[208:211], v[236:239], v[84:87]
    s_mov_b32 s40, 0
    v_mfma_f32_16x16x32_bf16 v[84:87], v[212:215], v[232:235], v[84:87]
    v_mfma_f32_16x16x32_bf16 v[84:87], v[216:219], v[228:231], v[84:87]
    v_mfma_f32_16x16x32_bf16 v[84:87], v[220:223], v[224:227], v[84:87]
    s_waitcnt lgkmcnt(0)
    v_mfma_f32_16x16x32_bf16 v[56:59], v[128:131], v[160:163], v[56:59]
    ds_read_b128 v[224:227], v121 offset:256
    v_lshrrev_b32 v7, 3, v2
    v_mfma_f32_16x16x32_bf16 v[60:63], v[128:131], v[164:167], v[60:63]
    ds_read_b64 v[192:193], v120 offset:3840
    v_mfma_f32_16x16x32_bf16 v[60:63], v[132:135], v[160:163], v[60:63]
    ds_read_b64 v[194:195], v120 offset:3848
    v_mul_u32_u24 v6, 4096, v7
    v_mfma_f32_16x16x32_bf16 v[64:67], v[128:131], v[168:171], v[64:67]
    ds_read_b128 v[228:231], v121 offset:768
    v_mfma_f32_16x16x32_bf16 v[64:67], v[132:135], v[164:167], v[64:67]
    ds_read_b64 v[196:197], v120 offset:3328
    v_bfe_u32 v7, v2, 1, 2
    v_mfma_f32_16x16x32_bf16 v[64:67], v[136:139], v[160:163], v[64:67]
    ds_read_b64 v[198:199], v120 offset:3336
    v_mfma_f32_16x16x32_bf16 v[68:71], v[128:131], v[172:175], v[68:71]
    v_bfe_u32 v8, v2, 4, 2
    v_mfma_f32_16x16x32_bf16 v[68:71], v[132:135], v[168:171], v[68:71]
    ds_read_b128 v[232:235], v121 offset:1280
    v_mfma_f32_16x16x32_bf16 v[68:71], v[136:139], v[164:167], v[68:71]
    ds_read_b64 v[200:201], v120 offset:2816
    v_xor_b32 v7, v7, v8
    v_mfma_f32_16x16x32_bf16 v[68:71], v[140:143], v[160:163], v[68:71]
    ds_read_b64 v[202:203], v120 offset:2824
    v_mfma_f32_16x16x32_bf16 v[72:75], v[128:131], v[176:179], v[72:75]
    ds_read_b128 v[236:239], v121 offset:1792
    v_lshl_add_u32 v6, v7, 5, v6
    v_mfma_f32_16x16x32_bf16 v[72:75], v[132:135], v[172:175], v[72:75]
    ds_read_b64 v[204:205], v120 offset:2304
    v_mfma_f32_16x16x32_bf16 v[72:75], v[136:139], v[168:171], v[72:75]
    ds_read_b64 v[206:207], v120 offset:2312
    v_and_b32 v7, 1, v2
    v_mfma_f32_16x16x32_bf16 v[72:75], v[140:143], v[164:167], v[72:75]
    v_mfma_f32_16x16x32_bf16 v[72:75], v[144:147], v[160:163], v[72:75]
    ds_read_b128 v[240:243], v121 offset:2304
    v_lshl_add_u32 v6, v7, 4, v6
    v_mfma_f32_16x16x32_bf16 v[76:79], v[128:131], v[180:183], v[76:79]
    ds_read_b64 v[208:209], v120 offset:1792
    v_mfma_f32_16x16x32_bf16 v[76:79], v[132:135], v[176:179], v[76:79]
    ds_read_b64 v[210:211], v120 offset:1800
    v_lshrrev_b32 v7, 2, v2
    v_mfma_f32_16x16x32_bf16 v[76:79], v[136:139], v[172:175], v[76:79]
    ds_read_b128 v[244:247], v121 offset:2816
    v_mfma_f32_16x16x32_bf16 v[76:79], v[140:143], v[168:171], v[76:79]
    ds_read_b64 v[212:213], v120 offset:1280
    v_lshlrev_b32 v4, 7, v7
    v_mfma_f32_16x16x32_bf16 v[76:79], v[144:147], v[164:167], v[76:79]
    ds_read_b64 v[214:215], v120 offset:1288
    v_mfma_f32_16x16x32_bf16 v[76:79], v[148:151], v[160:163], v[76:79]
    v_and_b32 v5, 3, v2
    v_mfma_f32_16x16x32_bf16 v[80:83], v[128:131], v[184:187], v[80:83]
    ds_read_b128 v[248:251], v121 offset:3328
    v_mfma_f32_16x16x32_bf16 v[80:83], v[132:135], v[180:183], v[80:83]
    ds_read_b64 v[216:217], v120 offset:768
    v_lshl_add_u32 v4, v5, 3, v4
    v_mfma_f32_16x16x32_bf16 v[80:83], v[136:139], v[176:179], v[80:83]
    ds_read_b64 v[218:219], v120 offset:776
    v_mfma_f32_16x16x32_bf16 v[80:83], v[140:143], v[172:175], v[80:83]
    ds_read_b128 v[252:255], v121 offset:3840
    v_bfe_u32 v5, v2, 3, 2
    v_mfma_f32_16x16x32_bf16 v[80:83], v[144:147], v[168:171], v[80:83]
    ds_read_b64 v[220:221], v120 offset:256
    v_mfma_f32_16x16x32_bf16 v[80:83], v[148:151], v[164:167], v[80:83]
    ds_read_b64 v[222:223], v120 offset:264
    s_xor_b32 s36, s30, 0
    v_mfma_f32_16x16x32_bf16 v[80:83], v[152:155], v[160:163], v[80:83]
    v_mfma_f32_16x16x32_bf16 v[84:87], v[128:131], v[188:191], v[84:87]
    v_xor_b32 v7, s36, v5
    v_mfma_f32_16x16x32_bf16 v[84:87], v[132:135], v[184:187], v[84:87]
    v_mfma_f32_16x16x32_bf16 v[84:87], v[136:139], v[180:183], v[84:87]
    v_lshl_add_u32 v10, v7, 5, v4
    v_mfma_f32_16x16x32_bf16 v[84:87], v[140:143], v[176:179], v[84:87]
    v_mfma_f32_16x16x32_bf16 v[84:87], v[144:147], v[172:175], v[84:87]
    s_xor_b32 s36, s30, 1
    v_mfma_f32_16x16x32_bf16 v[84:87], v[148:151], v[168:171], v[84:87]
    v_mfma_f32_16x16x32_bf16 v[84:87], v[152:155], v[164:167], v[84:87]
    v_mfma_f32_16x16x32_bf16 v[84:87], v[156:159], v[160:163], v[84:87]
    s_waitcnt lgkmcnt(0)
    s_barrier
    v_mfma_f32_16x16x32_bf16 v[56:59], v[192:195], v[224:227], v[56:59]
    ds_read_b128 v[160:163], v121 offset:192
    v_xor_b32 v7, s36, v5
    v_mfma_f32_16x16x32_bf16 v[60:63], v[192:195], v[228:231], v[60:63]
    ds_read_b64 v[128:129], v120 offset:3776
    v_mfma_f32_16x16x32_bf16 v[60:63], v[196:199], v[224:227], v[60:63]
    ds_read_b64 v[130:131], v120 offset:3784
    v_lshl_add_u32 v11, v7, 5, v4
    v_mfma_f32_16x16x32_bf16 v[64:67], v[192:195], v[232:235], v[64:67]
    ds_read_b128 v[164:167], v121 offset:704
    v_mfma_f32_16x16x32_bf16 v[64:67], v[196:199], v[228:231], v[64:67]
    ds_read_b64 v[132:133], v120 offset:3264
    s_xor_b32 s36, s30, 2
    v_mfma_f32_16x16x32_bf16 v[64:67], v[200:203], v[224:227], v[64:67]
    ds_read_b64 v[134:135], v120 offset:3272
    v_mfma_f32_16x16x32_bf16 v[68:71], v[192:195], v[236:239], v[68:71]
    v_xor_b32 v7, s36, v5
    v_mfma_f32_16x16x32_bf16 v[68:71], v[196:199], v[232:235], v[68:71]
    ds_read_b128 v[168:171], v121 offset:1216
    v_mfma_f32_16x16x32_bf16 v[68:71], v[200:203], v[228:231], v[68:71]
    ds_read_b64 v[136:137], v120 offset:2752
    v_lshl_add_u32 v12, v7, 5, v4
    v_mfma_f32_16x16x32_bf16 v[68:71], v[204:207], v[224:227], v[68:71]
    ds_read_b64 v[138:139], v120 offset:2760
    v_mfma_f32_16x16x32_bf16 v[72:75], v[192:195], v[240:243], v[72:75]
    ds_read_b128 v[172:175], v121 offset:1728
    s_xor_b32 s36, s30, 3
    v_mfma_f32_16x16x32_bf16 v[72:75], v[196:199], v[236:239], v[72:75]
    ds_read_b64 v[140:141], v120 offset:2240
    v_mfma_f32_16x16x32_bf16 v[72:75], v[200:203], v[232:235], v[72:75]
    ds_read_b64 v[142:143], v120 offset:2248
    v_xor_b32 v7, s36, v5
    v_mfma_f32_16x16x32_bf16 v[72:75], v[204:207], v[228:231], v[72:75]
    v_mfma_f32_16x16x32_bf16 v[72:75], v[208:211], v[224:227], v[72:75]
    ds_read_b128 v[176:179], v121 offset:2240
    v_lshl_add_u32 v13, v7, 5, v4
    v_mfma_f32_16x16x32_bf16 v[76:79], v[192:195], v[244:247], v[76:79]
    ds_read_b64 v[144:145], v120 offset:1728
    v_mfma_f32_16x16x32_bf16 v[76:79], v[196:199], v[240:243], v[76:79]
    ds_read_b64 v[146:147], v120 offset:1736
    v_min_u32 v4, 35, v2
    v_mfma_f32_16x16x32_bf16 v[76:79], v[200:203], v[236:239], v[76:79]
    ds_read_b128 v[180:183], v121 offset:2752
    v_mfma_f32_16x16x32_bf16 v[76:79], v[204:207], v[232:235], v[76:79]
    ds_read_b64 v[148:149], v120 offset:1216
    v_lshlrev_b32 v4, 4, v4
    v_mfma_f32_16x16x32_bf16 v[76:79], v[208:211], v[228:231], v[76:79]
    ds_read_b64 v[150:151], v120 offset:1224
    v_mfma_f32_16x16x32_bf16 v[76:79], v[212:215], v[224:227], v[76:79]
    v_lshrrev_b32 v7, 3, v2
    v_mfma_f32_16x16x32_bf16 v[80:83], v[192:195], v[248:251], v[80:83]
    ds_read_b128 v[184:187], v121 offset:3264
    v_mfma_f32_16x16x32_bf16 v[80:83], v[196:199], v[244:247], v[80:83]
    ds_read_b64 v[152:153], v120 offset:704
    v_mul_u32_u24 v33, 5120, v7
    v_mfma_f32_16x16x32_bf16 v[80:83], v[200:203], v[240:243], v[80:83]
    ds_read_b64 v[154:155], v120 offset:712
    v_mfma_f32_16x16x32_bf16 v[80:83], v[204:207], v[236:239], v[80:83]
    ds_read_b128 v[188:191], v121 offset:3776
    v_add_u32 v33, v33, v6
    v_mfma_f32_16x16x32_bf16 v[80:83], v[208:211], v[232:235], v[80:83]
    ds_read_b64 v[156:157], v120 offset:192
    v_mfma_f32_16x16x32_bf16 v[80:83], v[212:215], v[228:231], v[80:83]
    ds_read_b64 v[158:159], v120 offset:200
    v_mul_u32_u24 v32, 2944, v7
    v_mfma_f32_16x16x32_bf16 v[80:83], v[216:219], v[224:227], v[80:83]
    v_mfma_f32_16x16x32_bf16 v[84:87], v[192:195], v[252:255], v[84:87]
    v_sub_u32 v32, v6, v32
    v_mfma_f32_16x16x32_bf16 v[84:87], v[196:199], v[248:251], v[84:87]
    v_mfma_f32_16x16x32_bf16 v[84:87], v[200:203], v[244:247], v[84:87]
    v_add_u32 v46, 73728, v10
    v_mfma_f32_16x16x32_bf16 v[84:87], v[204:207], v[240:243], v[84:87]
    v_mfma_f32_16x16x32_bf16 v[84:87], v[208:211], v[236:239], v[84:87]
    v_add_u32 v47, 110592, v10
    v_mfma_f32_16x16x32_bf16 v[84:87], v[212:215], v[232:235], v[84:87]
    v_mfma_f32_16x16x32_bf16 v[84:87], v[216:219], v[228:231], v[84:87]
    v_mfma_f32_16x16x32_bf16 v[84:87], v[220:223], v[224:227], v[84:87]
    s_waitcnt lgkmcnt(0)
    v_mfma_f32_16x16x32_bf16 v[56:59], v[128:131], v[160:163], v[56:59]
    ds_read_b128 v[224:227], v121 offset:128
    s_lshl_b32 s37, s29, 16
    s_add_u32 s37, s37, 13631488
    v_mfma_f32_16x16x32_bf16 v[60:63], v[128:131], v[164:167], v[60:63]
    ds_read_b64 v[192:193], v120 offset:3712
    v_mfma_f32_16x16x32_bf16 v[60:63], v[132:135], v[160:163], v[60:63]
    ds_read_b64 v[194:195], v120 offset:3720
    v_mfma_f32_16x16x32_bf16 v[64:67], v[128:131], v[168:171], v[64:67]
    ds_read_b128 v[228:231], v121 offset:640
    s_add_u32 s4, s22, s37
    s_addc_u32 s5, s23, 0
    s_and_b32 s5, s5, 0xffff
    s_mov_b32 s6, 14745600
    s_mov_b32 s7, 0x20000
    v_mfma_f32_16x16x32_bf16 v[64:67], v[132:135], v[164:167], v[64:67]
    ds_read_b64 v[196:197], v120 offset:3200
    v_mfma_f32_16x16x32_bf16 v[64:67], v[136:139], v[160:163], v[64:67]
    ds_read_b64 v[198:199], v120 offset:3208
    v_mfma_f32_16x16x32_bf16 v[68:71], v[128:131], v[172:175], v[68:71]
    v_mfma_f32_16x16x32_bf16 v[68:71], v[132:135], v[168:171], v[68:71]
    ds_read_b128 v[232:235], v121 offset:1152
    v_mov_b32 v36, -1
    v_mfma_f32_16x16x32_bf16 v[68:71], v[136:139], v[164:167], v[68:71]
    ds_read_b64 v[200:201], v120 offset:2688
    v_mfma_f32_16x16x32_bf16 v[68:71], v[140:143], v[160:163], v[68:71]
    ds_read_b64 v[202:203], v120 offset:2696
    v_mfma_f32_16x16x32_bf16 v[72:75], v[128:131], v[176:179], v[72:75]
    ds_read_b128 v[236:239], v121 offset:1664
    v_mfma_f32_16x16x32_bf16 v[72:75], v[132:135], v[172:175], v[72:75]
    ds_read_b64 v[204:205], v120 offset:2176
    v_mov_b32 v37, -1
    v_mfma_f32_16x16x32_bf16 v[72:75], v[136:139], v[168:171], v[72:75]
    ds_read_b64 v[206:207], v120 offset:2184
    v_mfma_f32_16x16x32_bf16 v[72:75], v[140:143], v[164:167], v[72:75]
    v_mfma_f32_16x16x32_bf16 v[72:75], v[144:147], v[160:163], v[72:75]
    ds_read_b128 v[240:243], v121 offset:2176
    v_mfma_f32_16x16x32_bf16 v[76:79], v[128:131], v[180:183], v[76:79]
    ds_read_b64 v[208:209], v120 offset:1664
    v_mov_b32 v38, -1
    v_mfma_f32_16x16x32_bf16 v[76:79], v[132:135], v[176:179], v[76:79]
    ds_read_b64 v[210:211], v120 offset:1672
    v_mfma_f32_16x16x32_bf16 v[76:79], v[136:139], v[172:175], v[76:79]
    ds_read_b128 v[244:247], v121 offset:2688
    v_mfma_f32_16x16x32_bf16 v[76:79], v[140:143], v[168:171], v[76:79]
    ds_read_b64 v[212:213], v120 offset:1152
    v_mfma_f32_16x16x32_bf16 v[76:79], v[144:147], v[164:167], v[76:79]
    ds_read_b64 v[214:215], v120 offset:1160
    v_mov_b32 v39, -1
    v_mfma_f32_16x16x32_bf16 v[76:79], v[148:151], v[160:163], v[76:79]
    v_mfma_f32_16x16x32_bf16 v[80:83], v[128:131], v[184:187], v[80:83]
    ds_read_b128 v[248:251], v121 offset:3200
    v_mfma_f32_16x16x32_bf16 v[80:83], v[132:135], v[180:183], v[80:83]
    ds_read_b64 v[216:217], v120 offset:640
    v_mfma_f32_16x16x32_bf16 v[80:83], v[136:139], v[176:179], v[80:83]
    ds_read_b64 v[218:219], v120 offset:648
    s_lshl_b32 s37, s31, 11
    s_add_u32 s37, s37, 14680064
    v_mfma_f32_16x16x32_bf16 v[80:83], v[140:143], v[172:175], v[80:83]
    ds_read_b128 v[252:255], v121 offset:3712
    v_mfma_f32_16x16x32_bf16 v[80:83], v[144:147], v[168:171], v[80:83]
    ds_read_b64 v[220:221], v120 offset:128
    v_mfma_f32_16x16x32_bf16 v[80:83], v[148:151], v[164:167], v[80:83]
    ds_read_b64 v[222:223], v120 offset:136
    v_mfma_f32_16x16x32_bf16 v[80:83], v[152:155], v[160:163], v[80:83]
    buffer_store_dwordx4 v[36:39], v9, s[4:7], s37 offen offset:0 sc1
    v_mfma_f32_16x16x32_bf16 v[84:87], v[128:131], v[188:191], v[84:87]
    v_mfma_f32_16x16x32_bf16 v[84:87], v[132:135], v[184:187], v[84:87]
    v_mfma_f32_16x16x32_bf16 v[84:87], v[136:139], v[180:183], v[84:87]
    v_mfma_f32_16x16x32_bf16 v[84:87], v[140:143], v[176:179], v[84:87]
    buffer_store_dwordx4 v[36:39], v9, s[4:7], s37 offen offset:1024 sc1
    v_mfma_f32_16x16x32_bf16 v[84:87], v[144:147], v[172:175], v[84:87]
    v_mfma_f32_16x16x32_bf16 v[84:87], v[148:151], v[168:171], v[84:87]
    v_mfma_f32_16x16x32_bf16 v[84:87], v[152:155], v[164:167], v[84:87]
    v_mfma_f32_16x16x32_bf16 v[84:87], v[156:159], v[160:163], v[84:87]
    s_waitcnt lgkmcnt(0)
    v_mfma_f32_16x16x32_bf16 v[56:59], v[192:195], v[224:227], v[56:59]
    ds_read_b128 v[160:163], v121 offset:64
    v_mfma_f32_16x16x32_bf16 v[60:63], v[192:195], v[228:231], v[60:63]
    ds_read_b64 v[128:129], v120 offset:3648
    v_mfma_f32_16x16x32_bf16 v[60:63], v[196:199], v[224:227], v[60:63]
    ds_read_b64 v[130:131], v120 offset:3656
    v_mfma_f32_16x16x32_bf16 v[64:67], v[192:195], v[232:235], v[64:67]
    ds_read_b128 v[164:167], v121 offset:576
    v_mfma_f32_16x16x32_bf16 v[64:67], v[196:199], v[228:231], v[64:67]
    ds_read_b64 v[132:133], v120 offset:3136
    v_mfma_f32_16x16x32_bf16 v[64:67], v[200:203], v[224:227], v[64:67]
    ds_read_b64 v[134:135], v120 offset:3144
    v_mfma_f32_16x16x32_bf16 v[68:71], v[192:195], v[236:239], v[68:71]
    v_mfma_f32_16x16x32_bf16 v[68:71], v[196:199], v[232:235], v[68:71]
    ds_read_b128 v[168:171], v121 offset:1088
    v_mfma_f32_16x16x32_bf16 v[68:71], v[200:203], v[228:231], v[68:71]
    ds_read_b64 v[136:137], v120 offset:2624
    v_mfma_f32_16x16x32_bf16 v[68:71], v[204:207], v[224:227], v[68:71]
    ds_read_b64 v[138:139], v120 offset:2632
    v_mfma_f32_16x16x32_bf16 v[72:75], v[192:195], v[240:243], v[72:75]
    ds_read_b128 v[172:175], v121 offset:1600
    v_mfma_f32_16x16x32_bf16 v[72:75], v[196:199], v[236:239], v[72:75]
    ds_read_b64 v[140:141], v120 offset:2112
    v_mfma_f32_16x16x32_bf16 v[72:75], v[200:203], v[232:235], v[72:75]
    ds_read_b64 v[142:143], v120 offset:2120
    v_mfma_f32_16x16x32_bf16 v[72:75], v[204:207], v[228:231], v[72:75]
    v_mfma_f32_16x16x32_bf16 v[72:75], v[208:211], v[224:227], v[72:75]
    ds_read_b128 v[176:179], v121 offset:2112
    v_mfma_f32_16x16x32_bf16 v[76:79], v[192:195], v[244:247], v[76:79]
    ds_read_b64 v[144:145], v120 offset:1600
    v_mfma_f32_16x16x32_bf16 v[76:79], v[196:199], v[240:243], v[76:79]
    ds_read_b64 v[146:147], v120 offset:1608
    v_mfma_f32_16x16x32_bf16 v[76:79], v[200:203], v[236:239], v[76:79]
    ds_read_b128 v[180:183], v121 offset:2624
    v_mfma_f32_16x16x32_bf16 v[76:79], v[204:207], v[232:235], v[76:79]
    ds_read_b64 v[148:149], v120 offset:1088
    v_mfma_f32_16x16x32_bf16 v[76:79], v[208:211], v[228:231], v[76:79]
    ds_read_b64 v[150:151], v120 offset:1096
    v_mfma_f32_16x16x32_bf16 v[76:79], v[212:215], v[224:227], v[76:79]
    v_mfma_f32_16x16x32_bf16 v[80:83], v[192:195], v[248:251], v[80:83]
    ds_read_b128 v[184:187], v121 offset:3136
    v_mfma_f32_16x16x32_bf16 v[80:83], v[196:199], v[244:247], v[80:83]
    ds_read_b64 v[152:153], v120 offset:576
    v_mfma_f32_16x16x32_bf16 v[80:83], v[200:203], v[240:243], v[80:83]
    ds_read_b64 v[154:155], v120 offset:584
    v_mfma_f32_16x16x32_bf16 v[80:83], v[204:207], v[236:239], v[80:83]
    ds_read_b128 v[188:191], v121 offset:3648
    v_mfma_f32_16x16x32_bf16 v[80:83], v[208:211], v[232:235], v[80:83]
    ds_read_b64 v[156:157], v120 offset:64
    v_mfma_f32_16x16x32_bf16 v[80:83], v[212:215], v[228:231], v[80:83]
    ds_read_b64 v[158:159], v120 offset:72
    v_mfma_f32_16x16x32_bf16 v[80:83], v[216:219], v[224:227], v[80:83]
    v_mfma_f32_16x16x32_bf16 v[84:87], v[192:195], v[252:255], v[84:87]
    v_mfma_f32_16x16x32_bf16 v[84:87], v[196:199], v[248:251], v[84:87]
    v_mfma_f32_16x16x32_bf16 v[84:87], v[200:203], v[244:247], v[84:87]
    v_mfma_f32_16x16x32_bf16 v[84:87], v[204:207], v[240:243], v[84:87]
    v_mfma_f32_16x16x32_bf16 v[84:87], v[208:211], v[236:239], v[84:87]
    v_mfma_f32_16x16x32_bf16 v[84:87], v[212:215], v[232:235], v[84:87]
    v_mfma_f32_16x16x32_bf16 v[84:87], v[216:219], v[228:231], v[84:87]
    v_mfma_f32_16x16x32_bf16 v[84:87], v[220:223], v[224:227], v[84:87]
    s_waitcnt lgkmcnt(0)
    v_mfma_f32_16x16x32_bf16 v[56:59], v[128:131], v[160:163], v[56:59]
    ds_read_b128 v[224:227], v121 offset:0
    v_mfma_f32_16x16x32_bf16 v[60:63], v[128:131], v[164:167], v[60:63]
    ds_read_b64 v[192:193], v120 offset:3584
    v_mfma_f32_16x16x32_bf16 v[60:63], v[132:135], v[160:163], v[60:63]
    ds_read_b64 v[194:195], v120 offset:3592
    v_mfma_f32_16x16x32_bf16 v[64:67], v[128:131], v[168:171], v[64:67]
    ds_read_b128 v[228:231], v121 offset:512
    v_mfma_f32_16x16x32_bf16 v[64:67], v[132:135], v[164:167], v[64:67]
    ds_read_b64 v[196:197], v120 offset:3072
    v_mfma_f32_16x16x32_bf16 v[64:67], v[136:139], v[160:163], v[64:67]
    ds_read_b64 v[198:199], v120 offset:3080
    v_mfma_f32_16x16x32_bf16 v[68:71], v[128:131], v[172:175], v[68:71]
    v_mfma_f32_16x16x32_bf16 v[68:71], v[132:135], v[168:171], v[68:71]
    ds_read_b128 v[232:235], v121 offset:1024
    v_mfma_f32_16x16x32_bf16 v[68:71], v[136:139], v[164:167], v[68:71]
    ds_read_b64 v[200:201], v120 offset:2560
    v_mfma_f32_16x16x32_bf16 v[68:71], v[140:143], v[160:163], v[68:71]
    ds_read_b64 v[202:203], v120 offset:2568
    v_mfma_f32_16x16x32_bf16 v[72:75], v[128:131], v[176:179], v[72:75]
    ds_read_b128 v[236:239], v121 offset:1536
    v_mfma_f32_16x16x32_bf16 v[72:75], v[132:135], v[172:175], v[72:75]
    ds_read_b64 v[204:205], v120 offset:2048
    v_mfma_f32_16x16x32_bf16 v[72:75], v[136:139], v[168:171], v[72:75]
    ds_read_b64 v[206:207], v120 offset:2056
    v_mfma_f32_16x16x32_bf16 v[72:75], v[140:143], v[164:167], v[72:75]
    v_mfma_f32_16x16x32_bf16 v[72:75], v[144:147], v[160:163], v[72:75]
    ds_read_b128 v[240:243], v121 offset:2048
    v_mfma_f32_16x16x32_bf16 v[76:79], v[128:131], v[180:183], v[76:79]
    ds_read_b64 v[208:209], v120 offset:1536
    v_mfma_f32_16x16x32_bf16 v[76:79], v[132:135], v[176:179], v[76:79]
    ds_read_b64 v[210:211], v120 offset:1544
    v_mfma_f32_16x16x32_bf16 v[76:79], v[136:139], v[172:175], v[76:79]
    ds_read_b128 v[244:247], v121 offset:2560
    v_mfma_f32_16x16x32_bf16 v[76:79], v[140:143], v[168:171], v[76:79]
    ds_read_b64 v[212:213], v120 offset:1024
    v_mfma_f32_16x16x32_bf16 v[76:79], v[144:147], v[164:167], v[76:79]
    ds_read_b64 v[214:215], v120 offset:1032
    v_mfma_f32_16x16x32_bf16 v[76:79], v[148:151], v[160:163], v[76:79]
    v_mfma_f32_16x16x32_bf16 v[80:83], v[128:131], v[184:187], v[80:83]
    ds_read_b128 v[248:251], v121 offset:3072
    v_mfma_f32_16x16x32_bf16 v[80:83], v[132:135], v[180:183], v[80:83]
    ds_read_b64 v[216:217], v120 offset:512
    v_mfma_f32_16x16x32_bf16 v[80:83], v[136:139], v[176:179], v[80:83]
    ds_read_b64 v[218:219], v120 offset:520
    v_mfma_f32_16x16x32_bf16 v[80:83], v[140:143], v[172:175], v[80:83]
    ds_read_b128 v[252:255], v121 offset:3584
    v_mfma_f32_16x16x32_bf16 v[80:83], v[144:147], v[168:171], v[80:83]
    ds_read_b64 v[220:221], v120 offset:0
    v_mfma_f32_16x16x32_bf16 v[80:83], v[148:151], v[164:167], v[80:83]
    ds_read_b64 v[222:223], v120 offset:8
    v_mfma_f32_16x16x32_bf16 v[80:83], v[152:155], v[160:163], v[80:83]
    v_mfma_f32_16x16x32_bf16 v[84:87], v[128:131], v[188:191], v[84:87]
    v_mfma_f32_16x16x32_bf16 v[84:87], v[132:135], v[184:187], v[84:87]
    v_mfma_f32_16x16x32_bf16 v[84:87], v[136:139], v[180:183], v[84:87]
    v_mfma_f32_16x16x32_bf16 v[84:87], v[140:143], v[176:179], v[84:87]
    v_mfma_f32_16x16x32_bf16 v[84:87], v[144:147], v[172:175], v[84:87]
    v_mfma_f32_16x16x32_bf16 v[84:87], v[148:151], v[168:171], v[84:87]
    v_mfma_f32_16x16x32_bf16 v[84:87], v[152:155], v[164:167], v[84:87]
    v_mfma_f32_16x16x32_bf16 v[84:87], v[156:159], v[160:163], v[84:87]
    s_waitcnt lgkmcnt(0)
    ds_read_b128 v[160:163], v122 offset:0
    ds_read_b128 v[164:167], v122 offset:512
    ds_read_b128 v[168:171], v122 offset:1024
    ds_read_b128 v[172:175], v122 offset:1536
    ds_read_b128 v[176:179], v122 offset:2048
    ds_read_b128 v[180:183], v122 offset:2560
    ds_read_b128 v[184:187], v122 offset:3072
L_pg3:
    s_cbranch_execz L_wret0
    s_nop 0
    ds_read_b128 v[188:191], v122 offset:3584
    v_mfma_f32_16x16x32_bf16 v[84:87], v[192:195], v[252:255], v[84:87]
    v_mfma_f32_16x16x32_bf16 v[84:87], v[196:199], v[248:251], v[84:87]
    v_mfma_f32_16x16x32_bf16 v[84:87], v[200:203], v[244:247], v[84:87]
    v_mfma_f32_16x16x32_bf16 v[84:87], v[204:207], v[240:243], v[84:87]
    v_mfma_f32_16x16x32_bf16 v[84:87], v[208:211], v[236:239], v[84:87]
    v_mfma_f32_16x16x32_bf16 v[84:87], v[212:215], v[232:235], v[84:87]
    v_mfma_f32_16x16x32_bf16 v[84:87], v[216:219], v[228:231], v[84:87]
    v_mfma_f32_16x16x32_bf16 v[84:87], v[220:223], v[224:227], v[84:87]
    s_waitcnt lgkmcnt(0)
    v_mfma_f32_16x16x32_bf16 v[84:87], v[52:55], v[188:191], v[84:87]
    v_mfma_f32_16x16x32_bf16 v[80:83], v[192:195], v[248:251], v[80:83]
    v_mfma_f32_16x16x32_bf16 v[80:83], v[196:199], v[244:247], v[80:83]
    v_mfma_f32_16x16x32_bf16 v[80:83], v[200:203], v[240:243], v[80:83]
    v_mfma_f32_16x16x32_bf16 v[80:83], v[204:207], v[236:239], v[80:83]
    v_mfma_f32_16x16x32_bf16 v[80:83], v[208:211], v[232:235], v[80:83]
    v_mfma_f32_16x16x32_bf16 v[80:83], v[212:215], v[228:231], v[80:83]
    v_mfma_f32_16x16x32_bf16 v[80:83], v[216:219], v[224:227], v[80:83]
    v_mfma_f32_16x16x32_bf16 v[80:83], v[52:55], v[184:187], v[80:83]
    v_mfma_f32_16x16x32_bf16 v[76:79], v[192:195], v[244:247], v[76:79]
    v_mfma_f32_16x16x32_bf16 v[76:79], v[196:199], v[240:243], v[76:79]
    v_mfma_f32_16x16x32_bf16 v[76:79], v[200:203], v[236:239], v[76:79]
    v_mfma_f32_16x16x32_bf16 v[76:79], v[204:207], v[232:235], v[76:79]
    v_mfma_f32_16x16x32_bf16 v[76:79], v[208:211], v[228:231], v[76:79]
    v_mfma_f32_16x16x32_bf16 v[76:79], v[212:215], v[224:227], v[76:79]
    v_mfma_f32_16x16x32_bf16 v[76:79], v[52:55], v[180:183], v[76:79]
    v_mfma_f32_16x16x32_bf16 v[72:75], v[192:195], v[240:243], v[72:75]
    v_mfma_f32_16x16x32_bf16 v[72:75], v[196:199], v[236:239], v[72:75]
    v_cvt_pk_bf16_f32 v30, v84, v85
    v_mfma_f32_16x16x32_bf16 v[72:75], v[200:203], v[232:235], v[72:75]
    v_cvt_pk_bf16_f32 v31, v86, v87
    v_mfma_f32_16x16x32_bf16 v[72:75], v[204:207], v[228:231], v[72:75]
    v_cvt_pk_bf16_f32 v28, v80, v81
    v_mfma_f32_16x16x32_bf16 v[72:75], v[208:211], v[224:227], v[72:75]
    v_cvt_pk_bf16_f32 v29, v82, v83
    v_mfma_f32_16x16x32_bf16 v[72:75], v[52:55], v[176:179], v[72:75]
    v_mfma_f32_16x16x32_bf16 v[68:71], v[192:195], v[236:239], v[68:71]
    v_mfma_f32_16x16x32_bf16 v[68:71], v[196:199], v[232:235], v[68:71]
    v_permlane16_swap_b32 v28, v30
    v_mfma_f32_16x16x32_bf16 v[68:71], v[200:203], v[228:231], v[68:71]
    v_permlane16_swap_b32 v29, v31
    v_mfma_f32_16x16x32_bf16 v[68:71], v[204:207], v[224:227], v[68:71]
    buffer_store_dwordx4 v[28:31], v123, s[8:11], s39 offen offset:3072 sc1
    v_mfma_f32_16x16x32_bf16 v[68:71], v[52:55], v[172:175], v[68:71]
    v_mfma_f32_16x16x32_bf16 v[64:67], v[192:195], v[232:235], v[64:67]
    v_mfma_f32_16x16x32_bf16 v[64:67], v[196:199], v[228:231], v[64:67]
    v_mfma_f32_16x16x32_bf16 v[64:67], v[200:203], v[224:227], v[64:67]
    v_mfma_f32_16x16x32_bf16 v[64:67], v[52:55], v[168:171], v[64:67]
    v_cvt_pk_bf16_f32 v26, v76, v77
    v_cvt_pk_bf16_f32 v27, v78, v79
    v_cvt_pk_bf16_f32 v24, v72, v73
    v_cvt_pk_bf16_f32 v25, v74, v75
    v_mfma_f32_16x16x32_bf16 v[60:63], v[192:195], v[228:231], v[60:63]
    v_mfma_f32_16x16x32_bf16 v[60:63], v[196:199], v[224:227], v[60:63]
    v_mfma_f32_16x16x32_bf16 v[60:63], v[52:55], v[164:167], v[60:63]
    v_permlane16_swap_b32 v24, v26
    v_permlane16_swap_b32 v25, v27
    buffer_store_dwordx4 v[24:27], v123, s[8:11], s39 offen offset:2048 sc1
    v_mfma_f32_16x16x32_bf16 v[56:59], v[192:195], v[224:227], v[56:59]
    v_mfma_f32_16x16x32_bf16 v[56:59], v[52:55], v[160:163], v[56:59]
    v_cvt_pk_bf16_f32 v22, v68, v69
    v_cvt_pk_bf16_f32 v23, v70, v71
    v_cvt_pk_bf16_f32 v20, v64, v65
    v_cvt_pk_bf16_f32 v21, v66, v67
    s_nop 1
    v_permlane16_swap_b32 v20, v22
    v_permlane16_swap_b32 v21, v23
    buffer_store_dwordx4 v[20:23], v123, s[8:11], s39 offen offset:1024 sc1
    v_cvt_pk_bf16_f32 v18, v60, v61
    v_cvt_pk_bf16_f32 v19, v62, v63
    v_cvt_pk_bf16_f32 v16, v56, v57
    v_cvt_pk_bf16_f32 v17, v58, v59
    s_nop 1
    v_permlane16_swap_b32 v16, v18
    v_permlane16_swap_b32 v17, v19
    buffer_store_dwordx4 v[16:19], v123, s[8:11], s39 offen offset:0 sc1
    v_lshrrev_b32 v15, 3, v0
    v_lshl_add_u32 v14, v15, 16, v14
    s_mul_i32 s36, s28, 2560
    s_add_u32 s36, s36, 2304
    s_sub_u32 s36, s36, s61
    s_cmp_eq_u32 s29, 0
    s_cselect_b32 s36, s36, 0x10000
    s_cmp_eq_u32 s30, 0
    s_cselect_b32 s36, s36, 0x10000
    v_writelane_b32 v14, s36, 8
L_join:
    s_mov_b64 exec, 0
    s_cmp_eq_u32 s30, 0
    s_cbranch_scc1 L_pg4
    s_cmp_eq_u32 s30, 1
    s_cbranch_scc1 L_pg5
    s_cmp_eq_u32 s30, 2
    s_cbranch_scc1 L_pg6
    s_branch L_pg7
L_wret1:
    s_mov_b64 exec, -1
    s_waitcnt vmcnt(0)
    v_mov_b32 v15, s58
    s_barrier
    buffer_store_dword v15, v14, s[16:19], s61 offen sc1
    s_mov_b32 s48, s24
    s_and_b32 s49, s25, 0xffff
    s_mov_b32 s50, 5308416
    s_mov_b32 s51, 0x20000
    s_add_u32 s43, s30, 16
    s_mul_i32 s43, s43, 73728
    s_mul_i32 s34, s28, 1152
    s_add_u32 s43, s43, s34
    s_lshl_b32 s34, s30, 10
    s_add_u32 m0, s34, 73728
    s_nop 0
    buffer_load_dwordx4 v33, s[48:51], s43 offen lds
    s_add_u32 s43, s43, 128
    s_add_u32 m0, s34, 77824
    s_nop 0
    buffer_load_dwordx4 v33, s[48:51], s43 offen lds
    s_add_u32 s43, s43, 128
    s_add_u32 m0, s34, 81920
    s_nop 0
    buffer_load_dwordx4 v33, s[48:51], s43 offen lds
    s_add_u32 s43, s43, 128
    s_add_u32 m0, s34, 86016
    s_nop 0
    buffer_load_dwordx4 v33, s[48:51], s43 offen lds
    s_add_u32 s43, s43, 128
    s_add_u32 m0, s34, 90112
    s_nop 0
    buffer_load_dwordx4 v33, s[48:51], s43 offen lds
    s_add_u32 s43, s43, 128
    s_add_u32 m0, s34, 94208
    s_nop 0
    buffer_load_dwordx4 v33, s[48:51], s43 offen lds
    s_add_u32 s43, s43, 128
    s_add_u32 m0, s34, 98304
    s_nop 0
    buffer_load_dwordx4 v33, s[48:51], s43 offen lds
    s_add_u32 s43, s43, 128
    s_add_u32 m0, s34, 102400
    s_nop 0
    buffer_load_dwordx4 v33, s[48:51], s43 offen lds
    s_add_u32 s43, s43, 128
    s_add_u32 m0, s34, 106496
    s_nop 0
    buffer_load_dwordx4 v33, s[48:51], s43 offen lds
    s_add_u32 s43, s43, 293888
    buffer_load_dword v7, v3, s[16:19], s35 offen sc1
    s_add_u32 m0, s34, 110592
    s_nop 0
    buffer_load_dwordx4 v33, s[48:51], s43 offen lds
    s_add_u32 s43, s43, 128
    s_add_u32 m0, s34, 114688
    s_nop 0
    buffer_load_dwordx4 v33, s[48:51], s43 offen lds
    s_add_u32 s43, s43, 128
    s_add_u32 m0, s34, 118784
    s_nop 0
    buffer_load_dwordx4 v33, s[48:51], s43 offen lds
    s_add_u32 s43, s43, 128
    s_add_u32 m0, s34, 122880
    s_nop 0
    buffer_load_dwordx4 v33, s[48:51], s43 offen lds
    s_add_u32 s43, s43, 128
    s_add_u32 m0, s34, 126976
    s_nop 0
    buffer_load_dwordx4 v33, s[48:51], s43 offen lds
    s_add_u32 s43, s43, 128
    s_add_u32 m0, s34, 131072
    s_nop 0
    buffer_load_dwordx4 v33, s[48:51], s43 offen lds
    s_add_u32 s43, s43, 128
    s_add_u32 m0, s34, 135168
    s_nop 0
    buffer_load_dwordx4 v33, s[48:51], s43 offen lds
    s_add_u32 s43, s43, 128
    s_add_u32 m0, s34, 139264
    s_nop 0
    buffer_load_dwordx4 v33, s[48:51], s43 offen lds
    s_add_u32 s43, s43, 128
    s_add_u32 m0, s34, 143360
    s_nop 0
    buffer_load_dwordx4 v33, s[48:51], s43 offen lds
    s_add_u32 s43, s43, 128
    s_mov_b32 s41, 0x40000
    s_waitcnt vmcnt(9)
    v_cmp_ne_u32 vcc, s58, v7
    s_cbranch_vccz L_apoll_ok
L_apoll:
    buffer_load_dword v7, v3, s[16:19], s35 offen sc1
    s_sub_u32 s41, s41, 1
    s_cmp_eq_u32 s41, 0
    s_cbranch_scc1 L_apoll_ok
    s_waitcnt vmcnt(0)
    v_cmp_ne_u32 vcc, s58, v7
    s_cbranch_vccz L_apoll_ok
    s_sleep 2
    s_branch L_apoll
L_apoll_ok:
    s_cmp_lg_u32 s29, 31
    s_cbranch_scc1 L_c1_a
    v_min_u32 v8, 35, v2
    v_lshlrev_b32 v8, 4, v8
    s_mul_i32 s37, s31, 10368
    s_add_u32 s37, s37, 13238272
    s_add_u32 s48, s22, s37
    s_addc_u32 s49, s23, 0
    s_and_b32 s49, s49, 0xffff
    s_mov_b32 s50, 10368
    s_mov_b32 s51, 0x20000
    s_movk_i32 s36, 4032
    s_movk_i32 s37, 8064
    buffer_load_dwordx4 v[128:131], v8, s[48:51], 0 offen offset:0 sc1
    buffer_load_dwordx4 v[132:135], v8, s[48:51], 0 offen offset:576 sc1
    buffer_load_dwordx4 v[136:139], v8, s[48:51], 0 offen offset:1152 sc1
    buffer_load_dwordx4 v[140:143], v8, s[48:51], 0 offen offset:1728 sc1
    buffer_load_dwordx4 v[144:147], v8, s[48:51], 0 offen offset:2304 sc1
    buffer_load_dwordx4 v[148:151], v8, s[48:51], 0 offen offset:2880 sc1
    buffer_load_dwordx4 v[152:155], v8, s[48:51], 0 offen offset:3456 sc1
    buffer_load_dwordx4 v[156:159], v8, s[48:51], s36 offen offset:0 sc1
    buffer_load_dwordx4 v[160:163], v8, s[48:51], s36 offen offset:576 sc1
    buffer_load_dwordx4 v[164:167], v8, s[48:51], s36 offen offset:1152 sc1
    buffer_load_dwordx4 v[168:171], v8, s[48:51], s36 offen offset:1728 sc1
    buffer_load_dwordx4 v[172:175], v8, s[48:51], s36 offen offset:2304 sc1
    buffer_load_dwordx4 v[176:179], v8, s[48:51], s36 offen offset:2880 sc1
    buffer_load_dwordx4 v[180:183], v8, s[48:51], s36 offen offset:3456 sc1
    buffer_load_dwordx4 v[184:187], v8, s[48:51], s37 offen offset:0 sc1
    buffer_load_dwordx4 v[188:191], v8, s[48:51], s37 offen offset:576 sc1
    buffer_load_dwordx4 v[192:195], v8, s[48:51], s37 offen offset:1152 sc1
    buffer_load_dwordx4 v[196:199], v8, s[48:51], s37 offen offset:1728 sc1
L_c1_a:
    buffer_load_dwordx4 a[72:75], v9, s[12:15], s40 offen offset:0 sc1
    buffer_load_dwordx4 a[76:79], v9, s[12:15], s40 offen offset:1024 sc1
    buffer_load_dwordx4 a[80:83], v9, s[12:15], s40 offen offset:2048 sc1
    buffer_load_dwordx4 a[84:87], v9, s[12:15], s40 offen offset:3072 sc1
    s_add_u32 s40, s40, 4096
    buffer_load_dwordx4 a[88:91], v9, s[12:15], s40 offen offset:0 sc1
    buffer_load_dwordx4 a[92:95], v9, s[12:15], s40 offen offset:1024 sc1
    buffer_load_dwordx4 a[96:99], v9, s[12:15], s40 offen offset:2048 sc1
    buffer_load_dwordx4 a[100:103], v9, s[12:15], s40 offen offset:3072 sc1
    s_add_u32 s40, s40, 4096
    buffer_load_dwordx4 a[104:107], v9, s[12:15], s40 offen offset:0 sc1
    buffer_load_dwordx4 a[108:111], v9, s[12:15], s40 offen offset:1024 sc1
    buffer_load_dwordx4 a[112:115], v9, s[12:15], s40 offen offset:2048 sc1
    buffer_load_dwordx4 a[116:119], v9, s[12:15], s40 offen offset:3072 sc1
    s_add_u32 s40, s40, 4096
    buffer_load_dwordx4 a[120:123], v9, s[12:15], s40 offen offset:0 sc1
    buffer_load_dwordx4 a[124:127], v9, s[12:15], s40 offen offset:1024 sc1
    s_add_u32 s48, s22, 10616832
    s_addc_u32 s49, s23, 0
    s_and_b32 s49, s49, 0xffff
    s_mov_b32 s50, 18432
    s_mov_b32 s51, 0x20000
    s_cmp_lg_u32 s29, 31
    s_cbranch_scc1 L_c1_b
    s_mul_i32 s36, s31, 576
    s_waitcnt vmcnt(14)
    v_pk_add_f32 v[128:129], v[128:129], v[132:133]
    v_pk_add_f32 v[130:131], v[130:131], v[134:135]
    v_pk_add_f32 v[128:129], v[128:129], v[136:137]
    v_pk_add_f32 v[130:131], v[130:131], v[138:139]
    v_pk_add_f32 v[128:129], v[128:129], v[140:141]
    v_pk_add_f32 v[130:131], v[130:131], v[142:143]
    v_pk_add_f32 v[128:129], v[128:129], v[144:145]
    v_pk_add_f32 v[130:131], v[130:131], v[146:147]
    v_pk_add_f32 v[128:129], v[128:129], v[148:149]
    v_pk_add_f32 v[130:131], v[130:131], v[150:151]
    v_pk_add_f32 v[128:129], v[128:129], v[152:153]
    v_pk_add_f32 v[130:131], v[130:131], v[154:155]
    v_pk_add_f32 v[128:129], v[128:129], v[156:157]
    v_pk_add_f32 v[130:131], v[130:131], v[158:159]
    v_pk_add_f32 v[128:129], v[128:129], v[160:161]
    v_pk_add_f32 v[130:131], v[130:131], v[162:163]
    v_pk_add_f32 v[128:129], v[128:129], v[164:165]
    v_pk_add_f32 v[130:131], v[130:131], v[166:167]
    v_pk_add_f32 v[128:129], v[128:129], v[168:169]
    v_pk_add_f32 v[130:131], v[130:131], v[170:171]
    v_pk_add_f32 v[128:129], v[128:129], v[172:173]
    v_pk_add_f32 v[130:131], v[130:131], v[174:175]
    v_pk_add_f32 v[128:129], v[128:129], v[176:177]
    v_pk_add_f32 v[130:131], v[130:131], v[178:179]
    v_pk_add_f32 v[128:129], v[128:129], v[180:181]
    v_pk_add_f32 v[130:131], v[130:131], v[182:183]
    v_pk_add_f32 v[128:129], v[128:129], v[184:185]
    v_pk_add_f32 v[130:131], v[130:131], v[186:187]
    v_pk_add_f32 v[128:129], v[128:129], v[188:189]
    v_pk_add_f32 v[130:131], v[130:131], v[190:191]
    v_pk_add_f32 v[128:129], v[128:129], v[192:193]
    v_pk_add_f32 v[130:131], v[130:131], v[194:195]
    v_pk_add_f32 v[128:129], v[128:129], v[196:197]
    v_pk_add_f32 v[130:131], v[130:131], v[198:199]
    buffer_store_dwordx4 v[128:131], v8, s[48:51], s36 offen sc1
L_c1_b:
    s_mov_b32 s52, s26
    s_and_b32 s53, s27, 0xffff
    s_mov_b32 s54, 5308416
    s_mov_b32 s55, 0x20000
    s_lshl_b32 s38, s30, 10
    s_add_u32 s38, s38, 73728
    s_mul_i32 s43, s28, 72
    s_add_u32 s43, s43, s30
    s_add_u32 s43, s43, 64
    s_mul_i32 s43, s43, 9216
    s_mov_b32 s61, s35
    s_lshl_b32 s33, s29, 7
    s_lshl_b32 s34, s30, 15
    s_add_u32 s33, s33, s34
    s_lshl_b32 s34, s30, 10
    s_mul_i32 s35, s30, 576
    s_mul_i32 s36, s28, 2560
    s_add_u32 s35, s35, s36
    s_cmp_lt_u32 s29, 18
    s_cbranch_scc1 L_gpoll_ok
    v_mov_b32 v5, 2304
    s_mov_b32 s41, 0x40000
L_gpoll:
    buffer_load_dword v7, v5, s[16:19], s36 offen sc1
    s_sub_u32 s41, s41, 1
    s_cmp_eq_u32 s41, 0
    s_cbranch_scc1 L_gpoll_ok
    s_waitcnt vmcnt(0)
    v_cmp_ne_u32 vcc, s58, v7
    s_cbranch_vccz L_gpoll_ok
    s_sleep 2
    s_branch L_gpoll
L_gpoll_ok:
    s_mov_b32 s41, 0x40000
L_hpoll:
    buffer_load_dword v7, v4, s[16:19], s35 offen sc1
    s_sub_u32 s41, s41, 1
    s_cmp_eq_u32 s41, 0
    s_cbranch_scc1 L_hpoll_ok
    s_waitcnt vmcnt(0)
    v_cmp_ne_u32 vcc, s58, v7
    s_cbranch_vccz L_hpoll_ok
    s_sleep 2
    s_branch L_hpoll
L_hpoll_ok:
    s_mov_b32 m0, s34
    s_add_u32 s34, s34, 4096
    buffer_load_dwordx4 v6, s[8:11], s33 offen sc1 lds
    s_add_u32 s33, s33, 131072
    s_mov_b32 m0, s34
    s_add_u32 s34, s34, 4096
    buffer_load_dwordx4 v6, s[8:11], s33 offen sc1 lds
    s_add_u32 s33, s33, 131072
    s_mov_b32 m0, s34
    s_add_u32 s34, s34, 4096
    buffer_load_dwordx4 v6, s[8:11], s33 offen sc1 lds
    s_add_u32 s33, s33, 131072
    s_mov_b32 m0, s34
    s_add_u32 s34, s34, 4096
    buffer_load_dwordx4 v6, s[8:11], s33 offen sc1 lds
    s_add_u32 s33, s33, 131072
    buffer_load_dwordx4 a[128:131], v9, s[12:15], s40 offen offset:2048 sc1
    buffer_load_dwordx4 a[132:135], v9, s[12:15], s40 offen offset:3072 sc1
    s_add_u32 s40, s40, 4096
    buffer_load_dwordx4 a[136:139], v9, s[12:15], s40 offen offset:0 sc1
    buffer_load_dwordx4 a[140:143], v9, s[12:15], s40 offen offset:1024 sc1
    buffer_load_dwordx4 a[144:147], v9, s[12:15], s40 offen offset:2048 sc1
    buffer_load_dwordx4 a[148:151], v9, s[12:15], s40 offen offset:3072 sc1
    s_add_u32 s40, s40, 4096
    buffer_load_dwordx4 a[152:155], v9, s[12:15], s40 offen offset:0 sc1
    buffer_load_dwordx4 a[156:159], v9, s[12:15], s40 offen offset:1024 sc1
    buffer_load_dwordx4 a[160:163], v9, s[12:15], s40 offen offset:2048 sc1
    buffer_load_dwordx4 a[164:167], v9, s[12:15], s40 offen offset:3072 sc1
    s_add_u32 s40, s40, 4096
    buffer_load_dwordx4 a[168:171], v9, s[12:15], s40 offen offset:0 sc1
    buffer_load_dwordx4 a[172:175], v9, s[12:15], s40 offen offset:1024 sc1
    s_lshl_b32 s37, s29, 12
    s_add_u32 s37, s37, 13107200
    s_add_u32 s24, s22, s37
    s_addc_u32 s25, s23, 0
    s_and_b32 s25, s25, 0xffff
    s_mov_b32 s26, 4096
    s_mov_b32 s27, 0x20000
    s_mov_b32 s44, s62
    s_and_b32 s45, s63, 0xffff
    s_mov_b32 s46, 2359296
    s_mov_b32 s47, 0x20000
    s_lshl_b32 s36, s30, 10
    s_add_u32 s36, s36, 156672
    s_lshl_b32 s37, s30, 4
    s_add_u32 s61, s61, s37
    s_add_u32 s61, s61, 1792
    v_mov_b32 v3, 0
    s_cmp_lg_u32 s29, 31
    s_cbranch_scc1 L_c1_c
    v_lshlrev_b32 v14, 16, v2
    buffer_store_dword v15, v14, s[16:19], s61 offen sc1
L_c1_c:
    v_mov_b32 v14, 0
    v_mov_b32 v15, 0
    v_mov_b32 v16, 0
    v_mov_b32 v17, 0
    s_waitcnt vmcnt(12)
    s_barrier
    ds_read_b64_tr_b16 v[48:49], v10 offset:0
    ds_read_b64_tr_b16 v[50:51], v10 offset:2048
    ds_read_b64_tr_b16 v[64:65], v10 offset:4096
    ds_read_b64_tr_b16 v[66:67], v10 offset:6144
    ds_read_b64_tr_b16 v[52:53], v11 offset:0
    ds_read_b64_tr_b16 v[54:55], v11 offset:2048
    ds_read_b64_tr_b16 v[68:69], v11 offset:4096
    ds_read_b64_tr_b16 v[70:71], v11 offset:6144
    ds_read_b64_tr_b16 v[56:57], v12 offset:0
    ds_read_b64_tr_b16 v[58:59], v12 offset:2048
    ds_read_b64_tr_b16 v[72:73], v12 offset:4096
    ds_read_b64_tr_b16 v[74:75], v12 offset:6144
    ds_read_b64_tr_b16 v[60:61], v13 offset:0
    ds_read_b64_tr_b16 v[62:63], v13 offset:2048
    ds_read_b64_tr_b16 v[76:77], v13 offset:4096
    ds_read_b64_tr_b16 v[78:79], v13 offset:6144
    s_or_b32 s35, s2, s30
    s_cbranch_scc1 L_no_bump
    v_mov_b32 v18, 0
    v_mov_b32 v19, s58
    s_mov_b64 exec, 1
    global_store_dword v18, v19, s[56:57] sc1
    s_mov_b64 exec, -1
L_no_bump:
    s_waitcnt lgkmcnt(0)
    v_mfma_f32_16x16x32_bf16 v[112:115], a[72:75], v[48:51], 0
    v_mfma_f32_16x16x32_bf16 v[112:115], a[76:79], v[64:67], v[112:115]
    s_mov_b32 m0, s34
    s_add_u32 s34, s34, 4096
    buffer_load_dwordx4 v6, s[8:11], s33 offen sc1 lds
    s_add_u32 s33, s33, 131072
    v_mfma_f32_16x16x32_bf16 v[116:119], a[72:75], v[52:55], 0
    v_mfma_f32_16x16x32_bf16 v[116:119], a[76:79], v[68:71], v[116:119]
    v_mfma_f32_16x16x32_bf16 v[120:123], a[72:75], v[56:59], 0
    v_mfma_f32_16x16x32_bf16 v[120:123], a[76:79], v[72:75], v[120:123]
    v_mfma_f32_16x16x32_bf16 v[124:127], a[72:75], v[60:63], 0
    ds_read_b64_tr_b16 v[80:81], v10 offset:8192
    v_mfma_f32_16x16x32_bf16 v[124:127], a[76:79], v[76:79], v[124:127]
    v_mfma_f32_16x16x32_bf16 v[140:143], a[80:83], v[60:63], 0
    ds_read_b64_tr_b16 v[82:83], v10 offset:10240
    v_mfma_f32_16x16x32_bf16 v[140:143], a[84:87], v[76:79], v[140:143]
    buffer_load_dwordx4 a[176:179], v9, s[12:15], s40 offen offset:2048 sc1
    v_mfma_f32_16x16x32_bf16 v[136:139], a[80:83], v[56:59], 0
    ds_read_b64_tr_b16 v[96:97], v10 offset:12288
    v_lshlrev_b32 v18, 16, v48
    v_mfma_f32_16x16x32_bf16 v[136:139], a[84:87], v[72:75], v[136:139]
    v_and_b32 v19, 0xffff0000, v48
    v_mfma_f32_16x16x32_bf16 v[132:135], a[80:83], v[52:55], 0
    buffer_load_dwordx4 a[180:183], v9, s[12:15], s40 offen offset:3072 sc1
    ds_read_b64_tr_b16 v[98:99], v10 offset:14336
    v_mfma_f32_16x16x32_bf16 v[132:135], a[84:87], v[68:71], v[132:135]
    v_add_f32 v14, v14, v18
    v_add_f32 v15, v15, v19
    v_mfma_f32_16x16x32_bf16 v[128:131], a[80:83], v[48:51], 0
    ds_read_b64_tr_b16 v[84:85], v11 offset:8192
    v_mfma_f32_16x16x32_bf16 v[128:131], a[84:87], v[64:67], v[128:131]
    s_add_u32 s40, s40, 4096
    buffer_load_dwordx4 a[184:187], v9, s[12:15], s40 offen offset:0 sc1
    v_fmac_f32 v16, v18, v18
    v_mfma_f32_16x16x32_bf16 v[144:147], a[88:91], v[48:51], 0
    ds_read_b64_tr_b16 v[86:87], v11 offset:10240
    v_fmac_f32 v17, v19, v19
    v_mfma_f32_16x16x32_bf16 v[144:147], a[92:95], v[64:67], v[144:147]
    v_lshlrev_b32 v18, 16, v49
    v_mfma_f32_16x16x32_bf16 v[148:151], a[88:91], v[52:55], 0
    s_mov_b32 m0, s34
    s_add_u32 s34, s34, 4096
    ds_read_b64_tr_b16 v[100:101], v11 offset:12288
    v_mfma_f32_16x16x32_bf16 v[148:151], a[92:95], v[68:71], v[148:151]
    v_and_b32 v19, 0xffff0000, v49
    buffer_load_dwordx4 v6, s[8:11], s33 offen sc1 lds
    s_add_u32 s33, s33, 131072
    v_mfma_f32_16x16x32_bf16 v[152:155], a[88:91], v[56:59], 0
    ds_read_b64_tr_b16 v[102:103], v11 offset:14336
    v_add_f32 v14, v14, v18
    v_mfma_f32_16x16x32_bf16 v[152:155], a[92:95], v[72:75], v[152:155]
    ds_read_b64_tr_b16 a[0:1], v46 offset:0
    v_add_f32 v15, v15, v19
    v_mfma_f32_16x16x32_bf16 v[156:159], a[88:91], v[60:63], 0
    v_fmac_f32 v16, v18, v18
    ds_read_b64_tr_b16 a[2:3], v46 offset:2048
    v_mfma_f32_16x16x32_bf16 v[156:159], a[92:95], v[76:79], v[156:159]
    ds_read_b64_tr_b16 v[88:89], v12 offset:8192
    v_fmac_f32 v17, v19, v19
    v_mfma_f32_16x16x32_bf16 v[172:175], a[96:99], v[60:63], 0
    v_mfma_f32_16x16x32_bf16 v[172:175], a[100:103], v[76:79], v[172:175]
    ds_read_b64_tr_b16 v[90:91], v12 offset:10240
    v_lshlrev_b32 v18, 16, v50
    v_mfma_f32_16x16x32_bf16 v[168:171], a[96:99], v[56:59], 0
    ds_read_b64_tr_b16 a[4:5], v46 offset:4096
    v_and_b32 v19, 0xffff0000, v50
    v_mfma_f32_16x16x32_bf16 v[168:171], a[100:103], v[72:75], v[168:171]
    buffer_load_dwordx4 a[188:191], v9, s[12:15], s40 offen offset:1024 sc1
    ds_read_b64_tr_b16 v[104:105], v12 offset:12288
    v_mfma_f32_16x16x32_bf16 v[164:167], a[96:99], v[52:55], 0
    v_add_f32 v14, v14, v18
    ds_read_b64_tr_b16 a[6:7], v46 offset:6144
    v_mfma_f32_16x16x32_bf16 v[164:167], a[100:103], v[68:71], v[164:167]
    v_add_f32 v15, v15, v19
    ds_read_b64_tr_b16 v[106:107], v12 offset:14336
    v_mfma_f32_16x16x32_bf16 v[160:163], a[96:99], v[48:51], 0
    buffer_load_dwordx4 a[192:195], v9, s[12:15], s40 offen offset:2048 sc1
    v_fmac_f32 v16, v18, v18
    v_mfma_f32_16x16x32_bf16 v[160:163], a[100:103], v[64:67], v[160:163]
    ds_read_b64_tr_b16 a[8:9], v46 offset:8192
    ds_read_b64_tr_b16 v[92:93], v13 offset:8192
    v_mfma_f32_16x16x32_bf16 v[176:179], a[104:107], v[48:51], 0
    v_fmac_f32 v17, v19, v19
    v_lshlrev_b32 v18, 16, v51
    v_mfma_f32_16x16x32_bf16 v[176:179], a[108:111], v[64:67], v[176:179]
    ds_read_b64_tr_b16 a[10:11], v46 offset:10240
    ds_read_b64_tr_b16 v[94:95], v13 offset:10240
    v_mfma_f32_16x16x32_bf16 v[180:183], a[104:107], v[52:55], 0
    v_and_b32 v19, 0xffff0000, v51
    buffer_load_dwordx4 a[196:199], v9, s[12:15], s40 offen offset:3072 sc1
    v_mfma_f32_16x16x32_bf16 v[180:183], a[108:111], v[68:71], v[180:183]
    ds_read_b64_tr_b16 v[108:109], v13 offset:12288
    v_add_f32 v14, v14, v18
    v_mfma_f32_16x16x32_bf16 v[184:187], a[104:107], v[56:59], 0
    ds_read_b64_tr_b16 a[12:13], v46 offset:12288
    v_add_f32 v15, v15, v19
    v_mfma_f32_16x16x32_bf16 v[184:187], a[108:111], v[72:75], v[184:187]
    s_add_u32 s40, s40, 4096
    buffer_load_dwordx4 a[200:203], v9, s[12:15], s40 offen offset:0 sc1
    ds_read_b64_tr_b16 v[110:111], v13 offset:14336
    v_mfma_f32_16x16x32_bf16 v[188:191], a[104:107], v[60:63], 0
    v_fmac_f32 v16, v18, v18
    ds_read_b64_tr_b16 a[14:15], v46 offset:14336
    v_mfma_f32_16x16x32_bf16 v[188:191], a[108:111], v[76:79], v[188:191]
    v_fmac_f32 v17, v19, v19
    v_mfma_f32_16x16x32_bf16 v[204:207], a[112:115], v[60:63], 0
    v_lshlrev_b32 v18, 16, v64
    ds_read_b64_tr_b16 a[16:17], v46 offset:16384
    v_mfma_f32_16x16x32_bf16 v[204:207], a[116:119], v[76:79], v[204:207]
    buffer_load_dwordx4 a[204:207], v9, s[12:15], s40 offen offset:1024 sc1
    v_and_b32 v19, 0xffff0000, v64
    v_mfma_f32_16x16x32_bf16 v[200:203], a[112:115], v[56:59], 0
    v_add_f32 v14, v14, v18
    v_mfma_f32_16x16x32_bf16 v[200:203], a[116:119], v[72:75], v[200:203]
    v_add_f32 v15, v15, v19
    ds_read_b64_tr_b16 a[18:19], v46 offset:18432
    v_mfma_f32_16x16x32_bf16 v[196:199], a[112:115], v[52:55], 0
    buffer_load_dwordx4 a[208:211], v9, s[12:15], s40 offen offset:2048 sc1
    v_mfma_f32_16x16x32_bf16 v[196:199], a[116:119], v[68:71], v[196:199]
    v_fmac_f32 v16, v18, v18
    ds_read_b64_tr_b16 a[20:21], v46 offset:20480
    v_mfma_f32_16x16x32_bf16 v[192:195], a[112:115], v[48:51], 0
    v_fmac_f32 v17, v19, v19
    v_mfma_f32_16x16x32_bf16 v[192:195], a[116:119], v[64:67], v[192:195]
    buffer_load_dwordx4 a[212:215], v9, s[12:15], s40 offen offset:3072 sc1
    v_lshlrev_b32 v18, 16, v65
    v_mfma_f32_16x16x32_bf16 v[208:211], a[120:123], v[48:51], 0
    v_and_b32 v19, 0xffff0000, v65
    ds_read_b64_tr_b16 a[22:23], v46 offset:22528
    v_mfma_f32_16x16x32_bf16 v[208:211], a[124:127], v[64:67], v[208:211]
    v_mfma_f32_16x16x32_bf16 v[212:215], a[120:123], v[52:55], 0
    v_add_f32 v14, v14, v18
    ds_read_b64_tr_b16 a[24:25], v46 offset:24576
    v_mfma_f32_16x16x32_bf16 v[212:215], a[124:127], v[68:71], v[212:215]
    s_add_u32 s40, s40, 20480
    buffer_load_dwordx4 a[216:219], v9, s[12:15], s40 offen offset:2048 sc1
    v_add_f32 v15, v15, v19
    v_mfma_f32_16x16x32_bf16 v[216:219], a[120:123], v[56:59], 0
    v_fmac_f32 v16, v18, v18
    v_mfma_f32_16x16x32_bf16 v[216:219], a[124:127], v[72:75], v[216:219]
    v_fmac_f32 v17, v19, v19
    ds_read_b64_tr_b16 a[26:27], v46 offset:26624
    v_mfma_f32_16x16x32_bf16 v[220:223], a[120:123], v[60:63], 0
    buffer_load_dwordx4 a[220:223], v9, s[12:15], s40 offen offset:3072 sc1
    v_mfma_f32_16x16x32_bf16 v[220:223], a[124:127], v[76:79], v[220:223]
    v_lshlrev_b32 v18, 16, v66
    s_waitcnt vmcnt(24)
    v_mfma_f32_16x16x32_bf16 v[236:239], a[128:131], v[60:63], 0
    ds_read_b64_tr_b16 a[28:29], v46 offset:28672
    v_and_b32 v19, 0xffff0000, v66
    v_mfma_f32_16x16x32_bf16 v[236:239], a[132:135], v[76:79], v[236:239]
    v_add_f32 v14, v14, v18
    v_mfma_f32_16x16x32_bf16 v[232:235], a[128:131], v[56:59], 0
    s_add_u32 s40, s40, 4096
    buffer_load_dwordx4 a[224:227], v9, s[12:15], s40 offen offset:0 sc1
    v_add_f32 v15, v15, v19
    v_mfma_f32_16x16x32_bf16 v[232:235], a[132:135], v[72:75], v[232:235]
    ds_read_b64_tr_b16 a[30:31], v46 offset:30720
    v_mfma_f32_16x16x32_bf16 v[228:231], a[128:131], v[52:55], 0
    v_fmac_f32 v16, v18, v18
    ds_read_b64_tr_b16 a[32:33], v46 offset:32768
    v_mfma_f32_16x16x32_bf16 v[228:231], a[132:135], v[68:71], v[228:231]
    buffer_load_dwordx4 a[228:231], v9, s[12:15], s40 offen offset:1024 sc1
    v_fmac_f32 v17, v19, v19
    v_mfma_f32_16x16x32_bf16 v[224:227], a[128:131], v[48:51], 0
    v_lshlrev_b32 v18, 16, v67
    v_mfma_f32_16x16x32_bf16 v[224:227], a[132:135], v[64:67], v[224:227]
    v_and_b32 v19, 0xffff0000, v67
    s_waitcnt vmcnt(24)
    v_mfma_f32_16x16x32_bf16 v[240:243], a[136:139], v[48:51], 0
    ds_read_b64_tr_b16 a[34:35], v46 offset:34816
    v_mfma_f32_16x16x32_bf16 v[240:243], a[140:143], v[64:67], v[240:243]
    buffer_load_dwordx4 a[232:235], v9, s[12:15], s40 offen offset:2048 sc1
    v_add_f32 v14, v14, v18
    v_mfma_f32_16x16x32_bf16 v[244:247], a[136:139], v[52:55], 0
    v_add_f32 v15, v15, v19
    v_mfma_f32_16x16x32_bf16 v[244:247], a[140:143], v[68:71], v[244:247]
    v_fmac_f32 v16, v18, v18
    v_mfma_f32_16x16x32_bf16 v[248:251], a[136:139], v[56:59], 0
    buffer_load_dwordx4 a[236:239], v9, s[12:15], s40 offen offset:3072 sc1
    v_fmac_f32 v17, v19, v19
    v_mfma_f32_16x16x32_bf16 v[248:251], a[140:143], v[72:75], v[248:251]
    v_mfma_f32_16x16x32_bf16 v[252:255], a[136:139], v[60:63], 0
    v_mfma_f32_16x16x32_bf16 v[252:255], a[140:143], v[76:79], v[252:255]
    s_waitcnt lgkmcnt(0)
    s_waitcnt vmcnt(24)
    s_waitcnt vmcnt(13)
    s_barrier
    v_mfma_f32_16x16x32_bf16 v[112:115], a[144:147], v[80:83], v[112:115]
    v_mfma_f32_16x16x32_bf16 v[112:115], a[148:151], v[96:99], v[112:115]
L_pg4:
    s_cbranch_execz L_pg8
    s_nop 0
    s_mov_b32 m0, s34
    s_add_u32 s34, s34, 4096
    buffer_load_dwordx4 v6, s[8:11], s33 offen sc1 lds
    s_add_u32 s33, s33, 131072
    v_mfma_f32_16x16x32_bf16 v[116:119], a[144:147], v[84:87], v[116:119]
    v_mfma_f32_16x16x32_bf16 v[116:119], a[148:151], v[100:103], v[116:119]
    v_mfma_f32_16x16x32_bf16 v[120:123], a[144:147], v[88:91], v[120:123]
    v_mfma_f32_16x16x32_bf16 v[120:123], a[148:151], v[104:107], v[120:123]
    v_mfma_f32_16x16x32_bf16 v[124:127], a[144:147], v[92:95], v[124:127]
    ds_read_b64_tr_b16 v[48:49], v10 offset:16384
    v_mfma_f32_16x16x32_bf16 v[124:127], a[148:151], v[108:111], v[124:127]
    v_mfma_f32_16x16x32_bf16 v[140:143], a[152:155], v[92:95], v[140:143]
    ds_read_b64_tr_b16 v[50:51], v10 offset:18432
    v_mfma_f32_16x16x32_bf16 v[140:143], a[156:159], v[108:111], v[140:143]
    s_add_u32 s40, s40, 4096
    buffer_load_dwordx4 a[240:243], v9, s[12:15], s40 offen offset:0 sc1
    v_mfma_f32_16x16x32_bf16 v[136:139], a[152:155], v[88:91], v[136:139]
    ds_read_b64_tr_b16 v[64:65], v10 offset:20480
    v_lshlrev_b32 v18, 16, v80
    v_mfma_f32_16x16x32_bf16 v[136:139], a[156:159], v[104:107], v[136:139]
    v_and_b32 v19, 0xffff0000, v80
    v_mfma_f32_16x16x32_bf16 v[132:135], a[152:155], v[84:87], v[132:135]
    buffer_load_dwordx4 a[244:247], v9, s[12:15], s40 offen offset:1024 sc1
    ds_read_b64_tr_b16 v[66:67], v10 offset:22528
    v_mfma_f32_16x16x32_bf16 v[132:135], a[156:159], v[100:103], v[132:135]
    v_add_f32 v14, v14, v18
    v_add_f32 v15, v15, v19
    v_mfma_f32_16x16x32_bf16 v[128:131], a[152:155], v[80:83], v[128:131]
    ds_read_b64_tr_b16 v[52:53], v11 offset:16384
    v_mfma_f32_16x16x32_bf16 v[128:131], a[156:159], v[96:99], v[128:131]
    buffer_load_dwordx4 a[248:251], v9, s[12:15], s40 offen offset:2048 sc1
    v_mfma_f32_16x16x32_bf16 v[144:147], a[160:163], v[80:83], v[144:147]
    v_fmac_f32 v16, v18, v18
    ds_read_b64_tr_b16 v[54:55], v11 offset:18432
    v_mfma_f32_16x16x32_bf16 v[144:147], a[164:167], v[96:99], v[144:147]
    v_fmac_f32 v17, v19, v19
    v_lshlrev_b32 v18, 16, v81
    v_mfma_f32_16x16x32_bf16 v[148:151], a[160:163], v[84:87], v[148:151]
    s_mov_b32 m0, s34
    s_add_u32 s34, s34, 4096
    ds_read_b64_tr_b16 v[68:69], v11 offset:20480
    v_mfma_f32_16x16x32_bf16 v[148:151], a[164:167], v[100:103], v[148:151]
    v_and_b32 v19, 0xffff0000, v81
    buffer_load_dwordx4 v6, s[8:11], s33 offen sc1 lds
    s_add_u32 s33, s33, 131072
    v_mfma_f32_16x16x32_bf16 v[152:155], a[160:163], v[88:91], v[152:155]
    ds_read_b64_tr_b16 v[70:71], v11 offset:22528
    v_add_f32 v14, v14, v18
    v_mfma_f32_16x16x32_bf16 v[152:155], a[164:167], v[104:107], v[152:155]
    ds_read_b64_tr_b16 a[36:37], v47 offset:0
    v_add_f32 v15, v15, v19
    v_mfma_f32_16x16x32_bf16 v[156:159], a[160:163], v[92:95], v[156:159]
    v_fmac_f32 v16, v18, v18
    ds_read_b64_tr_b16 a[38:39], v47 offset:2048
    v_mfma_f32_16x16x32_bf16 v[156:159], a[164:167], v[108:111], v[156:159]
    ds_read_b64_tr_b16 v[56:57], v12 offset:16384
    v_mfma_f32_16x16x32_bf16 v[172:175], a[168:171], v[92:95], v[172:175]
    v_fmac_f32 v17, v19, v19
    v_mfma_f32_16x16x32_bf16 v[172:175], a[172:175], v[108:111], v[172:175]
    ds_read_b64_tr_b16 v[58:59], v12 offset:18432
    v_lshlrev_b32 v18, 16, v82
    v_mfma_f32_16x16x32_bf16 v[168:171], a[168:171], v[88:91], v[168:171]
    ds_read_b64_tr_b16 a[40:41], v47 offset:4096
    v_and_b32 v19, 0xffff0000, v82
    v_mfma_f32_16x16x32_bf16 v[168:171], a[172:175], v[104:107], v[168:171]
    buffer_load_dwordx4 a[252:255], v9, s[12:15], s40 offen offset:3072 sc1
    ds_read_b64_tr_b16 v[72:73], v12 offset:20480
    v_mfma_f32_16x16x32_bf16 v[164:167], a[168:171], v[84:87], v[164:167]
    v_add_f32 v14, v14, v18
    ds_read_b64_tr_b16 a[42:43], v47 offset:6144
    v_mfma_f32_16x16x32_bf16 v[164:167], a[172:175], v[100:103], v[164:167]
    v_add_f32 v15, v15, v19
    ds_read_b64_tr_b16 v[74:75], v12 offset:22528
    v_mfma_f32_16x16x32_bf16 v[160:163], a[168:171], v[80:83], v[160:163]
    s_add_u32 s40, s40, 4096
    buffer_load_dwordx4 a[72:75], v9, s[12:15], s40 offen offset:0 sc1
    v_fmac_f32 v16, v18, v18
    v_mfma_f32_16x16x32_bf16 v[160:163], a[172:175], v[96:99], v[160:163]
    ds_read_b64_tr_b16 a[44:45], v47 offset:8192
    v_mfma_f32_16x16x32_bf16 v[176:179], a[176:179], v[80:83], v[176:179]
    ds_read_b64_tr_b16 v[60:61], v13 offset:16384
    v_fmac_f32 v17, v19, v19
    v_mfma_f32_16x16x32_bf16 v[176:179], a[180:183], v[96:99], v[176:179]
    v_lshlrev_b32 v18, 16, v83
    ds_read_b64_tr_b16 a[46:47], v47 offset:10240
    v_mfma_f32_16x16x32_bf16 v[180:183], a[176:179], v[84:87], v[180:183]
    ds_read_b64_tr_b16 v[62:63], v13 offset:18432
    v_and_b32 v19, 0xffff0000, v83
    v_mfma_f32_16x16x32_bf16 v[180:183], a[180:183], v[100:103], v[180:183]
    buffer_load_dwordx4 a[76:79], v9, s[12:15], s40 offen offset:1024 sc1
    ds_read_b64_tr_b16 v[76:77], v13 offset:20480
    v_mfma_f32_16x16x32_bf16 v[184:187], a[176:179], v[88:91], v[184:187]
    v_add_f32 v14, v14, v18
    ds_read_b64_tr_b16 a[48:49], v47 offset:12288
    v_mfma_f32_16x16x32_bf16 v[184:187], a[180:183], v[104:107], v[184:187]
    v_add_f32 v15, v15, v19
    buffer_load_dwordx4 a[80:83], v9, s[12:15], s40 offen offset:2048 sc1
    v_mfma_f32_16x16x32_bf16 v[188:191], a[176:179], v[92:95], v[188:191]
    ds_read_b64_tr_b16 v[78:79], v13 offset:22528
    v_fmac_f32 v16, v18, v18
    v_mfma_f32_16x16x32_bf16 v[188:191], a[180:183], v[108:111], v[188:191]
    ds_read_b64_tr_b16 a[50:51], v47 offset:14336
    s_waitcnt vmcnt(21)
    v_mfma_f32_16x16x32_bf16 v[204:207], a[184:187], v[92:95], v[204:207]
    v_fmac_f32 v17, v19, v19
    v_lshlrev_b32 v18, 16, v96
    v_mfma_f32_16x16x32_bf16 v[204:207], a[188:191], v[108:111], v[204:207]
    ds_read_b64_tr_b16 a[52:53], v47 offset:16384
    buffer_load_dwordx4 a[84:87], v9, s[12:15], s40 offen offset:3072 sc1
    v_mfma_f32_16x16x32_bf16 v[200:203], a[184:187], v[88:91], v[200:203]
    v_and_b32 v19, 0xffff0000, v96
    v_add_f32 v14, v14, v18
    v_mfma_f32_16x16x32_bf16 v[200:203], a[188:191], v[104:107], v[200:203]
    v_add_f32 v15, v15, v19
    ds_read_b64_tr_b16 a[54:55], v47 offset:18432
    v_mfma_f32_16x16x32_bf16 v[196:199], a[184:187], v[84:87], v[196:199]
    s_add_u32 s40, s40, 4096
    buffer_load_dwordx4 a[88:91], v9, s[12:15], s40 offen offset:0 sc1
    v_mfma_f32_16x16x32_bf16 v[196:199], a[188:191], v[100:103], v[196:199]
    v_fmac_f32 v16, v18, v18
    ds_read_b64_tr_b16 a[56:57], v47 offset:20480
    v_mfma_f32_16x16x32_bf16 v[192:195], a[184:187], v[80:83], v[192:195]
    v_fmac_f32 v17, v19, v19
    v_mfma_f32_16x16x32_bf16 v[192:195], a[188:191], v[96:99], v[192:195]
    buffer_load_dwordx4 a[92:95], v9, s[12:15], s40 offen offset:1024 sc1
    s_waitcnt vmcnt(22)
    v_mfma_f32_16x16x32_bf16 v[208:211], a[192:195], v[80:83], v[208:211]
    v_lshlrev_b32 v18, 16, v97
    v_and_b32 v19, 0xffff0000, v97
    v_mfma_f32_16x16x32_bf16 v[208:211], a[196:199], v[96:99], v[208:211]
    ds_read_b64_tr_b16 a[58:59], v47 offset:22528
    v_mfma_f32_16x16x32_bf16 v[212:215], a[192:195], v[84:87], v[212:215]
    v_add_f32 v14, v14, v18
    ds_read_b64_tr_b16 a[60:61], v47 offset:24576
    v_mfma_f32_16x16x32_bf16 v[212:215], a[196:199], v[100:103], v[212:215]
    buffer_load_dwordx4 a[96:99], v9, s[12:15], s40 offen offset:2048 sc1
    v_add_f32 v15, v15, v19
    v_mfma_f32_16x16x32_bf16 v[216:219], a[192:195], v[88:91], v[216:219]
    v_fmac_f32 v16, v18, v18
    v_mfma_f32_16x16x32_bf16 v[216:219], a[196:199], v[104:107], v[216:219]
    v_fmac_f32 v17, v19, v19
    ds_read_b64_tr_b16 a[62:63], v47 offset:26624
    v_mfma_f32_16x16x32_bf16 v[220:223], a[192:195], v[92:95], v[220:223]
    buffer_load_dwordx4 a[100:103], v9, s[12:15], s40 offen offset:3072 sc1
    v_mfma_f32_16x16x32_bf16 v[220:223], a[196:199], v[108:111], v[220:223]
    v_lshlrev_b32 v18, 16, v98
    s_waitcnt vmcnt(22)
    v_mfma_f32_16x16x32_bf16 v[236:239], a[200:203], v[92:95], v[236:239]
    ds_read_b64_tr_b16 a[64:65], v47 offset:28672
    v_and_b32 v19, 0xffff0000, v98
    v_mfma_f32_16x16x32_bf16 v[236:239], a[204:207], v[108:111], v[236:239]
    v_add_f32 v14, v14, v18
    v_mfma_f32_16x16x32_bf16 v[232:235], a[200:203], v[88:91], v[232:235]
    s_add_u32 s40, s40, 4096
    buffer_load_dwordx4 a[104:107], v9, s[12:15], s40 offen offset:0 sc1
    v_add_f32 v15, v15, v19
    v_mfma_f32_16x16x32_bf16 v[232:235], a[204:207], v[104:107], v[232:235]
    ds_read_b64_tr_b16 a[66:67], v47 offset:30720
    v_mfma_f32_16x16x32_bf16 v[228:231], a[200:203], v[84:87], v[228:231]
    v_fmac_f32 v16, v18, v18
    ds_read_b64_tr_b16 a[68:69], v47 offset:32768
    v_mfma_f32_16x16x32_bf16 v[228:231], a[204:207], v[100:103], v[228:231]
    buffer_load_dwordx4 a[108:111], v9, s[12:15], s40 offen offset:1024 sc1
    v_fmac_f32 v17, v19, v19
    v_mfma_f32_16x16x32_bf16 v[224:227], a[200:203], v[80:83], v[224:227]
    v_lshlrev_b32 v18, 16, v99
    v_mfma_f32_16x16x32_bf16 v[224:227], a[204:207], v[96:99], v[224:227]
    v_and_b32 v19, 0xffff0000, v99
    s_waitcnt vmcnt(22)
    v_mfma_f32_16x16x32_bf16 v[240:243], a[208:211], v[80:83], v[240:243]
    ds_read_b64_tr_b16 a[70:71], v47 offset:34816
    v_mfma_f32_16x16x32_bf16 v[240:243], a[212:215], v[96:99], v[240:243]
    buffer_load_dwordx4 a[112:115], v9, s[12:15], s40 offen offset:2048 sc1
    v_add_f32 v14, v14, v18
    v_mfma_f32_16x16x32_bf16 v[244:247], a[208:211], v[84:87], v[244:247]
    v_add_f32 v15, v15, v19
    v_mfma_f32_16x16x32_bf16 v[244:247], a[212:215], v[100:103], v[244:247]
    v_fmac_f32 v16, v18, v18
    v_mfma_f32_16x16x32_bf16 v[248:251], a[208:211], v[88:91], v[248:251]
    buffer_load_dwordx4 a[116:119], v9, s[12:15], s40 offen offset:3072 sc1
    v_fmac_f32 v17, v19, v19
    v_mfma_f32_16x16x32_bf16 v[248:251], a[212:215], v[104:107], v[248:251]
    v_mfma_f32_16x16x32_bf16 v[252:255], a[208:211], v[92:95], v[252:255]
    v_mfma_f32_16x16x32_bf16 v[252:255], a[212:215], v[108:111], v[252:255]
    s_waitcnt lgkmcnt(0)
    s_waitcnt vmcnt(13)
    s_barrier
    v_mfma_f32_16x16x32_bf16 v[112:115], a[0:3], v[48:51], v[112:115]
    v_mfma_f32_16x16x32_bf16 v[112:115], a[36:39], v[64:67], v[112:115]
    s_mov_b32 m0, s34
    s_add_u32 s34, s34, 4096
    buffer_load_dwordx4 v6, s[8:11], s33 offen sc1 lds
    s_add_u32 s33, s33, 131072
    v_mfma_f32_16x16x32_bf16 v[116:119], a[0:3], v[52:55], v[116:119]
    v_mfma_f32_16x16x32_bf16 v[116:119], a[36:39], v[68:71], v[116:119]
    v_mfma_f32_16x16x32_bf16 v[120:123], a[0:3], v[56:59], v[120:123]
    v_mfma_f32_16x16x32_bf16 v[120:123], a[36:39], v[72:75], v[120:123]
    v_mfma_f32_16x16x32_bf16 v[124:127], a[0:3], v[60:63], v[124:127]
    ds_read_b64_tr_b16 v[80:81], v10 offset:24576
    v_mfma_f32_16x16x32_bf16 v[124:127], a[36:39], v[76:79], v[124:127]
    ds_read_b64_tr_b16 v[82:83], v10 offset:26624
    v_mfma_f32_16x16x32_bf16 v[140:143], a[4:7], v[60:63], v[140:143]
    v_mfma_f32_16x16x32_bf16 v[140:143], a[40:43], v[76:79], v[140:143]
    s_add_u32 s40, s40, 4096
    buffer_load_dwordx4 a[120:123], v9, s[12:15], s40 offen offset:0 sc1
    ds_read_b64_tr_b16 v[96:97], v10 offset:28672
    v_mfma_f32_16x16x32_bf16 v[136:139], a[4:7], v[56:59], v[136:139]
    v_lshlrev_b32 v18, 16, v48
    v_mfma_f32_16x16x32_bf16 v[136:139], a[40:43], v[72:75], v[136:139]
    ds_read_b64_tr_b16 v[98:99], v10 offset:30720
    v_and_b32 v19, 0xffff0000, v48
    v_mfma_f32_16x16x32_bf16 v[132:135], a[4:7], v[52:55], v[132:135]
    buffer_load_dwordx4 a[124:127], v9, s[12:15], s40 offen offset:1024 sc1
    ds_read_b64_tr_b16 v[84:85], v11 offset:24576
    v_mfma_f32_16x16x32_bf16 v[132:135], a[40:43], v[68:71], v[132:135]
    v_add_f32 v14, v14, v18
    v_add_f32 v15, v15, v19
    v_mfma_f32_16x16x32_bf16 v[128:131], a[4:7], v[48:51], v[128:131]
    ds_read_b64_tr_b16 v[86:87], v11 offset:26624
    v_mfma_f32_16x16x32_bf16 v[128:131], a[40:43], v[64:67], v[128:131]
    buffer_load_dwordx4 a[128:131], v9, s[12:15], s40 offen offset:2048 sc1
    v_fmac_f32 v16, v18, v18
    v_mfma_f32_16x16x32_bf16 v[144:147], a[8:11], v[48:51], v[144:147]
    ds_read_b64_tr_b16 v[100:101], v11 offset:28672
    v_fmac_f32 v17, v19, v19
    v_mfma_f32_16x16x32_bf16 v[144:147], a[44:47], v[64:67], v[144:147]
    ds_read_b64_tr_b16 v[102:103], v11 offset:30720
    v_lshlrev_b32 v18, 16, v49
    v_mfma_f32_16x16x32_bf16 v[148:151], a[8:11], v[52:55], v[148:151]
    s_mov_b32 m0, s34
    s_add_u32 s34, s34, 4096
    v_and_b32 v19, 0xffff0000, v49
    v_mfma_f32_16x16x32_bf16 v[148:151], a[44:47], v[68:71], v[148:151]
    buffer_load_dwordx4 v6, s[8:11], s33 offen sc1 lds
    s_add_u32 s33, s33, 131072
    ds_read_b64_tr_b16 v[88:89], v12 offset:24576
    v_mfma_f32_16x16x32_bf16 v[152:155], a[8:11], v[56:59], v[152:155]
    v_add_f32 v14, v14, v18
    v_mfma_f32_16x16x32_bf16 v[152:155], a[44:47], v[72:75], v[152:155]
    ds_read_b64_tr_b16 v[90:91], v12 offset:26624
    v_add_f32 v15, v15, v19
    v_mfma_f32_16x16x32_bf16 v[156:159], a[8:11], v[60:63], v[156:159]
    v_fmac_f32 v16, v18, v18
    v_mfma_f32_16x16x32_bf16 v[156:159], a[44:47], v[76:79], v[156:159]
    ds_read_b64_tr_b16 v[104:105], v12 offset:28672
    v_fmac_f32 v17, v19, v19
    v_mfma_f32_16x16x32_bf16 v[172:175], a[12:15], v[60:63], v[172:175]
    ds_read_b64_tr_b16 v[106:107], v12 offset:30720
    v_mfma_f32_16x16x32_bf16 v[172:175], a[48:51], v[76:79], v[172:175]
    v_lshlrev_b32 v18, 16, v50
    v_mfma_f32_16x16x32_bf16 v[168:171], a[12:15], v[56:59], v[168:171]
    ds_read_b64_tr_b16 v[92:93], v13 offset:24576
    v_and_b32 v19, 0xffff0000, v50
    v_mfma_f32_16x16x32_bf16 v[168:171], a[48:51], v[72:75], v[168:171]
    buffer_load_dwordx4 a[132:135], v9, s[12:15], s40 offen offset:3072 sc1
    v_add_f32 v14, v14, v18
    v_mfma_f32_16x16x32_bf16 v[164:167], a[12:15], v[52:55], v[164:167]
    ds_read_b64_tr_b16 v[94:95], v13 offset:26624
    v_add_f32 v15, v15, v19
    v_mfma_f32_16x16x32_bf16 v[164:167], a[48:51], v[68:71], v[164:167]
    ds_read_b64_tr_b16 v[108:109], v13 offset:28672
    v_mfma_f32_16x16x32_bf16 v[160:163], a[12:15], v[48:51], v[160:163]
    s_add_u32 s40, s40, 4096
    buffer_load_dwordx4 a[136:139], v9, s[12:15], s40 offen offset:0 sc1
    v_fmac_f32 v16, v18, v18
    v_mfma_f32_16x16x32_bf16 v[160:163], a[48:51], v[64:67], v[160:163]
    ds_read_b64_tr_b16 v[110:111], v13 offset:30720
    v_fmac_f32 v17, v19, v19
    v_mfma_f32_16x16x32_bf16 v[176:179], a[16:19], v[48:51], v[176:179]
    v_lshlrev_b32 v18, 16, v51
    v_mfma_f32_16x16x32_bf16 v[176:179], a[52:55], v[64:67], v[176:179]
    v_add_u32 v10, 32768, v10
    v_and_b32 v19, 0xffff0000, v51
    v_mfma_f32_16x16x32_bf16 v[180:183], a[16:19], v[52:55], v[180:183]
    buffer_load_dwordx4 a[140:143], v9, s[12:15], s40 offen offset:1024 sc1
    v_add_u32 v11, 32768, v11
    v_mfma_f32_16x16x32_bf16 v[180:183], a[52:55], v[68:71], v[180:183]
    v_add_f32 v14, v14, v18
    v_mfma_f32_16x16x32_bf16 v[184:187], a[16:19], v[56:59], v[184:187]
    v_add_u32 v12, 32768, v12
    v_add_f32 v15, v15, v19
    v_mfma_f32_16x16x32_bf16 v[184:187], a[52:55], v[72:75], v[184:187]
    buffer_load_dwordx4 a[144:147], v9, s[12:15], s40 offen offset:2048 sc1
    v_fmac_f32 v16, v18, v18
    v_mfma_f32_16x16x32_bf16 v[188:191], a[16:19], v[60:63], v[188:191]
    v_add_u32 v13, 32768, v13
    v_fmac_f32 v17, v19, v19
    v_mfma_f32_16x16x32_bf16 v[188:191], a[52:55], v[76:79], v[188:191]
    v_mfma_f32_16x16x32_bf16 v[204:207], a[20:23], v[60:63], v[204:207]
    v_lshlrev_b32 v18, 16, v64
    v_mfma_f32_16x16x32_bf16 v[204:207], a[56:59], v[76:79], v[204:207]
    buffer_load_dwordx4 a[148:151], v9, s[12:15], s40 offen offset:3072 sc1
    v_and_b32 v19, 0xffff0000, v64
    v_mfma_f32_16x16x32_bf16 v[200:203], a[20:23], v[56:59], v[200:203]
    v_add_f32 v14, v14, v18
    v_mfma_f32_16x16x32_bf16 v[200:203], a[56:59], v[72:75], v[200:203]
    v_add_f32 v15, v15, v19
    v_mfma_f32_16x16x32_bf16 v[196:199], a[20:23], v[52:55], v[196:199]
    s_add_u32 s40, s40, 4096
    buffer_load_dwordx4 a[152:155], v9, s[12:15], s40 offen offset:0 sc1
    v_mfma_f32_16x16x32_bf16 v[196:199], a[56:59], v[68:71], v[196:199]
    v_fmac_f32 v16, v18, v18
    v_mfma_f32_16x16x32_bf16 v[192:195], a[20:23], v[48:51], v[192:195]
    v_fmac_f32 v17, v19, v19
    v_mfma_f32_16x16x32_bf16 v[192:195], a[56:59], v[64:67], v[192:195]
    buffer_load_dwordx4 a[156:159], v9, s[12:15], s40 offen offset:1024 sc1
    v_lshlrev_b32 v18, 16, v65
    v_mfma_f32_16x16x32_bf16 v[208:211], a[24:27], v[48:51], v[208:211]
    v_and_b32 v19, 0xffff0000, v65
    v_mfma_f32_16x16x32_bf16 v[208:211], a[60:63], v[64:67], v[208:211]
    v_mfma_f32_16x16x32_bf16 v[212:215], a[24:27], v[52:55], v[212:215]
    v_add_f32 v14, v14, v18
    v_mfma_f32_16x16x32_bf16 v[212:215], a[60:63], v[68:71], v[212:215]
    buffer_load_dwordx4 a[160:163], v9, s[12:15], s40 offen offset:2048 sc1
    v_add_f32 v15, v15, v19
    v_mfma_f32_16x16x32_bf16 v[216:219], a[24:27], v[56:59], v[216:219]
    v_fmac_f32 v16, v18, v18
    v_mfma_f32_16x16x32_bf16 v[216:219], a[60:63], v[72:75], v[216:219]
    v_fmac_f32 v17, v19, v19
    v_mfma_f32_16x16x32_bf16 v[220:223], a[24:27], v[60:63], v[220:223]
    buffer_load_dwordx4 a[164:167], v9, s[12:15], s40 offen offset:3072 sc1
    v_mfma_f32_16x16x32_bf16 v[220:223], a[60:63], v[76:79], v[220:223]
    v_lshlrev_b32 v18, 16, v66
    v_mfma_f32_16x16x32_bf16 v[236:239], a[28:31], v[60:63], v[236:239]
    v_and_b32 v19, 0xffff0000, v66
    v_mfma_f32_16x16x32_bf16 v[236:239], a[64:67], v[76:79], v[236:239]
    v_add_f32 v14, v14, v18
    v_mfma_f32_16x16x32_bf16 v[232:235], a[28:31], v[56:59], v[232:235]
    s_add_u32 s40, s40, 4096
    buffer_load_dwordx4 a[168:171], v9, s[12:15], s40 offen offset:0 sc1
    v_add_f32 v15, v15, v19
    v_mfma_f32_16x16x32_bf16 v[232:235], a[64:67], v[72:75], v[232:235]
    v_mfma_f32_16x16x32_bf16 v[228:231], a[28:31], v[52:55], v[228:231]
    v_fmac_f32 v16, v18, v18
    v_mfma_f32_16x16x32_bf16 v[228:231], a[64:67], v[68:71], v[228:231]
    buffer_load_dwordx4 a[172:175], v9, s[12:15], s40 offen offset:1024 sc1
    v_fmac_f32 v17, v19, v19
    v_mfma_f32_16x16x32_bf16 v[224:227], a[28:31], v[48:51], v[224:227]
    v_lshlrev_b32 v18, 16, v67
    v_mfma_f32_16x16x32_bf16 v[224:227], a[64:67], v[64:67], v[224:227]
    v_and_b32 v19, 0xffff0000, v67
    v_mfma_f32_16x16x32_bf16 v[240:243], a[32:35], v[48:51], v[240:243]
    v_mfma_f32_16x16x32_bf16 v[240:243], a[68:71], v[64:67], v[240:243]
    buffer_load_dwordx4 a[176:179], v9, s[12:15], s40 offen offset:2048 sc1
    v_add_f32 v14, v14, v18
    v_mfma_f32_16x16x32_bf16 v[244:247], a[32:35], v[52:55], v[244:247]
    v_add_f32 v15, v15, v19
    v_mfma_f32_16x16x32_bf16 v[244:247], a[68:71], v[68:71], v[244:247]
    v_fmac_f32 v16, v18, v18
    v_mfma_f32_16x16x32_bf16 v[248:251], a[32:35], v[56:59], v[248:251]
    buffer_load_dwordx4 a[180:183], v9, s[12:15], s40 offen offset:3072 sc1
    v_fmac_f32 v17, v19, v19
    v_mfma_f32_16x16x32_bf16 v[248:251], a[68:71], v[72:75], v[248:251]
    v_mfma_f32_16x16x32_bf16 v[252:255], a[32:35], v[60:63], v[252:255]
    v_mfma_f32_16x16x32_bf16 v[252:255], a[68:71], v[76:79], v[252:255]
    s_waitcnt lgkmcnt(0)
    s_waitcnt vmcnt(13)
    s_barrier
    v_mfma_f32_16x16x32_bf16 v[112:115], a[216:219], v[80:83], v[112:115]
    v_mfma_f32_16x16x32_bf16 v[112:115], a[220:223], v[96:99], v[112:115]
    s_mov_b32 m0, s34
    s_add_u32 s34, s34, 4096
    buffer_load_dwordx4 v6, s[8:11], s33 offen sc1 lds
    s_add_u32 s33, s33, 131072
    v_mfma_f32_16x16x32_bf16 v[116:119], a[216:219], v[84:87], v[116:119]
    v_mfma_f32_16x16x32_bf16 v[116:119], a[220:223], v[100:103], v[116:119]
    v_mfma_f32_16x16x32_bf16 v[120:123], a[216:219], v[88:91], v[120:123]
    v_mfma_f32_16x16x32_bf16 v[120:123], a[220:223], v[104:107], v[120:123]
    v_mfma_f32_16x16x32_bf16 v[124:127], a[216:219], v[92:95], v[124:127]
    ds_read_b64_tr_b16 v[48:49], v10 offset:0
    v_mfma_f32_16x16x32_bf16 v[124:127], a[220:223], v[108:111], v[124:127]
    v_mfma_f32_16x16x32_bf16 v[140:143], a[224:227], v[92:95], v[140:143]
    s_add_u32 s40, s40, 4096
    buffer_load_dwordx4 a[184:187], v9, s[12:15], s40 offen offset:0 sc1
    ds_read_b64_tr_b16 v[50:51], v10 offset:2048
    v_mfma_f32_16x16x32_bf16 v[140:143], a[228:231], v[108:111], v[140:143]
    v_mfma_f32_16x16x32_bf16 v[136:139], a[224:227], v[88:91], v[136:139]
    ds_read_b64_tr_b16 v[64:65], v10 offset:4096
    v_lshlrev_b32 v18, 16, v80
    v_mfma_f32_16x16x32_bf16 v[136:139], a[228:231], v[104:107], v[136:139]
    buffer_load_dwordx4 a[188:191], v9, s[12:15], s40 offen offset:1024 sc1
    v_and_b32 v19, 0xffff0000, v80
    v_mfma_f32_16x16x32_bf16 v[132:135], a[224:227], v[84:87], v[132:135]
    ds_read_b64_tr_b16 v[66:67], v10 offset:6144
    v_add_f32 v14, v14, v18
    v_mfma_f32_16x16x32_bf16 v[132:135], a[228:231], v[100:103], v[132:135]
    v_add_f32 v15, v15, v19
    v_mfma_f32_16x16x32_bf16 v[128:131], a[224:227], v[80:83], v[128:131]
    buffer_load_dwordx4 a[192:195], v9, s[12:15], s40 offen offset:2048 sc1
    ds_read_b64_tr_b16 v[52:53], v11 offset:0
    v_mfma_f32_16x16x32_bf16 v[128:131], a[228:231], v[96:99], v[128:131]
    v_fmac_f32 v16, v18, v18
    v_mfma_f32_16x16x32_bf16 v[144:147], a[232:235], v[80:83], v[144:147]
    s_mov_b32 m0, s34
    s_add_u32 s34, s34, 4096
    ds_read_b64_tr_b16 v[54:55], v11 offset:2048
    v_mfma_f32_16x16x32_bf16 v[144:147], a[236:239], v[96:99], v[144:147]
    v_fmac_f32 v17, v19, v19
    buffer_load_dwordx4 v6, s[8:11], s33 offen sc1 lds
    s_add_u32 s33, s33, 131072
    v_mfma_f32_16x16x32_bf16 v[148:151], a[232:235], v[84:87], v[148:151]
    v_lshlrev_b32 v18, 16, v81
    ds_read_b64_tr_b16 v[68:69], v11 offset:4096
    v_mfma_f32_16x16x32_bf16 v[148:151], a[236:239], v[100:103], v[148:151]
    v_and_b32 v19, 0xffff0000, v81
    v_mfma_f32_16x16x32_bf16 v[152:155], a[232:235], v[88:91], v[152:155]
    ds_read_b64_tr_b16 v[70:71], v11 offset:6144
    v_add_f32 v14, v14, v18
    v_mfma_f32_16x16x32_bf16 v[152:155], a[236:239], v[104:107], v[152:155]
    v_add_f32 v15, v15, v19
    v_mfma_f32_16x16x32_bf16 v[156:159], a[232:235], v[92:95], v[156:159]
    v_fmac_f32 v16, v18, v18
    v_mfma_f32_16x16x32_bf16 v[156:159], a[236:239], v[108:111], v[156:159]
    ds_read_b64_tr_b16 v[56:57], v12 offset:0
    v_mfma_f32_16x16x32_bf16 v[172:175], a[240:243], v[92:95], v[172:175]
    v_fmac_f32 v17, v19, v19
    v_mfma_f32_16x16x32_bf16 v[172:175], a[244:247], v[108:111], v[172:175]
    buffer_load_dwordx4 a[196:199], v9, s[12:15], s40 offen offset:3072 sc1
    ds_read_b64_tr_b16 v[58:59], v12 offset:2048
    v_mfma_f32_16x16x32_bf16 v[168:171], a[240:243], v[88:91], v[168:171]
    v_lshlrev_b32 v18, 16, v82
    v_and_b32 v19, 0xffff0000, v82
    v_mfma_f32_16x16x32_bf16 v[168:171], a[244:247], v[104:107], v[168:171]
    ds_read_b64_tr_b16 v[72:73], v12 offset:4096
    v_add_f32 v14, v14, v18
    v_mfma_f32_16x16x32_bf16 v[164:167], a[240:243], v[84:87], v[164:167]
    s_add_u32 s40, s40, 4096
    buffer_load_dwordx4 a[200:203], v9, s[12:15], s40 offen offset:0 sc1
    v_add_f32 v15, v15, v19
    v_mfma_f32_16x16x32_bf16 v[164:167], a[244:247], v[100:103], v[164:167]
    ds_read_b64_tr_b16 v[74:75], v12 offset:6144
    v_mfma_f32_16x16x32_bf16 v[160:163], a[240:243], v[80:83], v[160:163]
    v_fmac_f32 v16, v18, v18
    v_mfma_f32_16x16x32_bf16 v[160:163], a[244:247], v[96:99], v[160:163]
    buffer_load_dwordx4 a[204:207], v9, s[12:15], s40 offen offset:1024 sc1
    v_mfma_f32_16x16x32_bf16 v[176:179], a[248:251], v[80:83], v[176:179]
    ds_read_b64_tr_b16 v[60:61], v13 offset:0
    v_fmac_f32 v17, v19, v19
    v_mfma_f32_16x16x32_bf16 v[176:179], a[252:255], v[96:99], v[176:179]
    v_lshlrev_b32 v18, 16, v83
    ds_read_b64_tr_b16 v[62:63], v13 offset:2048
    v_mfma_f32_16x16x32_bf16 v[180:183], a[248:251], v[84:87], v[180:183]
    v_and_b32 v19, 0xffff0000, v83
    buffer_load_dwordx4 a[208:211], v9, s[12:15], s40 offen offset:2048 sc1
    v_mfma_f32_16x16x32_bf16 v[180:183], a[252:255], v[100:103], v[180:183]
    ds_read_b64_tr_b16 v[76:77], v13 offset:4096
    v_add_f32 v14, v14, v18
    v_mfma_f32_16x16x32_bf16 v[184:187], a[248:251], v[88:91], v[184:187]
    v_add_f32 v15, v15, v19
    v_mfma_f32_16x16x32_bf16 v[184:187], a[252:255], v[104:107], v[184:187]
    buffer_load_dwordx4 a[212:215], v9, s[12:15], s40 offen offset:3072 sc1
    ds_read_b64_tr_b16 v[78:79], v13 offset:6144
    v_mfma_f32_16x16x32_bf16 v[188:191], a[248:251], v[92:95], v[188:191]
    v_fmac_f32 v16, v18, v18
    v_fmac_f32 v17, v19, v19
    v_mfma_f32_16x16x32_bf16 v[188:191], a[252:255], v[108:111], v[188:191]
    v_mfma_f32_16x16x32_bf16 v[204:207], a[72:75], v[92:95], v[204:207]
    s_add_u32 s40, s40, 4096
    buffer_load_dwordx4 a[0:3], v9, s[12:15], s40 offen offset:0 sc1
    v_lshlrev_b32 v18, 16, v96
    v_mfma_f32_16x16x32_bf16 v[204:207], a[76:79], v[108:111], v[204:207]
    v_and_b32 v19, 0xffff0000, v96
    v_mfma_f32_16x16x32_bf16 v[200:203], a[72:75], v[88:91], v[200:203]
    v_add_f32 v14, v14, v18
    v_mfma_f32_16x16x32_bf16 v[200:203], a[76:79], v[104:107], v[200:203]
    buffer_load_dwordx4 a[36:39], v9, s[12:15], s40 offen offset:1024 sc1
    v_add_f32 v15, v15, v19
    v_mfma_f32_16x16x32_bf16 v[196:199], a[72:75], v[84:87], v[196:199]
    v_mfma_f32_16x16x32_bf16 v[196:199], a[76:79], v[100:103], v[196:199]
    v_fmac_f32 v16, v18, v18
    v_mfma_f32_16x16x32_bf16 v[192:195], a[72:75], v[80:83], v[192:195]
    buffer_load_dwordx4 a[4:7], v9, s[12:15], s40 offen offset:2048 sc1
    v_fmac_f32 v17, v19, v19
    v_mfma_f32_16x16x32_bf16 v[192:195], a[76:79], v[96:99], v[192:195]
    v_lshlrev_b32 v18, 16, v97
    v_mfma_f32_16x16x32_bf16 v[208:211], a[80:83], v[80:83], v[208:211]
    v_and_b32 v19, 0xffff0000, v97
    v_mfma_f32_16x16x32_bf16 v[208:211], a[84:87], v[96:99], v[208:211]
    v_mfma_f32_16x16x32_bf16 v[212:215], a[80:83], v[84:87], v[212:215]
    buffer_load_dwordx4 a[40:43], v9, s[12:15], s40 offen offset:3072 sc1
    v_add_f32 v14, v14, v18
    v_mfma_f32_16x16x32_bf16 v[212:215], a[84:87], v[100:103], v[212:215]
    v_add_f32 v15, v15, v19
    v_mfma_f32_16x16x32_bf16 v[216:219], a[80:83], v[88:91], v[216:219]
    v_fmac_f32 v16, v18, v18
    v_mfma_f32_16x16x32_bf16 v[216:219], a[84:87], v[104:107], v[216:219]
    s_add_u32 s40, s40, 4096
    buffer_load_dwordx4 a[8:11], v9, s[12:15], s40 offen offset:0 sc1
    v_fmac_f32 v17, v19, v19
    v_mfma_f32_16x16x32_bf16 v[220:223], a[80:83], v[92:95], v[220:223]
    v_mfma_f32_16x16x32_bf16 v[220:223], a[84:87], v[108:111], v[220:223]
    v_lshlrev_b32 v18, 16, v98
    v_mfma_f32_16x16x32_bf16 v[236:239], a[88:91], v[92:95], v[236:239]
    buffer_load_dwordx4 a[44:47], v9, s[12:15], s40 offen offset:1024 sc1
    v_and_b32 v19, 0xffff0000, v98
    v_mfma_f32_16x16x32_bf16 v[236:239], a[92:95], v[108:111], v[236:239]
    v_add_f32 v14, v14, v18
    v_mfma_f32_16x16x32_bf16 v[232:235], a[88:91], v[88:91], v[232:235]
    v_add_f32 v15, v15, v19
    v_mfma_f32_16x16x32_bf16 v[232:235], a[92:95], v[104:107], v[232:235]
    buffer_load_dwordx4 a[12:15], v9, s[12:15], s40 offen offset:2048 sc1
    v_mfma_f32_16x16x32_bf16 v[228:231], a[88:91], v[84:87], v[228:231]
    v_fmac_f32 v16, v18, v18
    v_mfma_f32_16x16x32_bf16 v[228:231], a[92:95], v[100:103], v[228:231]
    v_fmac_f32 v17, v19, v19
    v_mfma_f32_16x16x32_bf16 v[224:227], a[88:91], v[80:83], v[224:227]
    buffer_load_dwordx4 a[48:51], v9, s[12:15], s40 offen offset:3072 sc1
    v_lshlrev_b32 v18, 16, v99
    v_mfma_f32_16x16x32_bf16 v[224:227], a[92:95], v[96:99], v[224:227]
    v_and_b32 v19, 0xffff0000, v99
    v_mfma_f32_16x16x32_bf16 v[240:243], a[96:99], v[80:83], v[240:243]
    s_movk_i32 s39, 1024
    s_add_u32 s39, s39, s43
    s_mov_b32 m0, s38
    s_add_u32 s38, s38, 4096
    v_mfma_f32_16x16x32_bf16 v[240:243], a[100:103], v[96:99], v[240:243]
    buffer_load_dwordx4 v32, s[52:55], s39 offen lds
    v_add_f32 v14, v14, v18
    v_mfma_f32_16x16x32_bf16 v[244:247], a[96:99], v[84:87], v[244:247]
    v_add_f32 v15, v15, v19
    v_mfma_f32_16x16x32_bf16 v[244:247], a[100:103], v[100:103], v[244:247]
    s_add_u32 s39, s39, 36864
    s_mov_b32 m0, s38
    s_add_u32 s38, s38, 4096
    v_fmac_f32 v16, v18, v18
    v_mfma_f32_16x16x32_bf16 v[248:251], a[96:99], v[88:91], v[248:251]
    buffer_load_dwordx4 v32, s[52:55], s39 offen lds
    v_fmac_f32 v17, v19, v19
    v_mfma_f32_16x16x32_bf16 v[248:251], a[100:103], v[104:107], v[248:251]
    v_mfma_f32_16x16x32_bf16 v[252:255], a[96:99], v[92:95], v[252:255]
    v_mfma_f32_16x16x32_bf16 v[252:255], a[100:103], v[108:111], v[252:255]
    s_waitcnt lgkmcnt(0)
    s_waitcnt vmcnt(15)
    s_barrier
    v_mfma_f32_16x16x32_bf16 v[112:115], a[104:107], v[48:51], v[112:115]
    buffer_load_dword v7, v3, s[16:19], s61 offen sc1
    v_mfma_f32_16x16x32_bf16 v[112:115], a[108:111], v[64:67], v[112:115]
    s_mov_b32 m0, s34
    s_add_u32 s34, s34, 4096
    buffer_load_dwordx4 v6, s[8:11], s33 offen sc1 lds
    s_add_u32 s33, s33, 131072
    v_mfma_f32_16x16x32_bf16 v[116:119], a[104:107], v[52:55], v[116:119]
    v_mfma_f32_16x16x32_bf16 v[116:119], a[108:111], v[68:71], v[116:119]
    v_mfma_f32_16x16x32_bf16 v[120:123], a[104:107], v[56:59], v[120:123]
    v_mfma_f32_16x16x32_bf16 v[120:123], a[108:111], v[72:75], v[120:123]
    v_mfma_f32_16x16x32_bf16 v[124:127], a[104:107], v[60:63], v[124:127]
    ds_read_b64_tr_b16 v[80:81], v10 offset:8192
    v_mfma_f32_16x16x32_bf16 v[124:127], a[108:111], v[76:79], v[124:127]
    v_mfma_f32_16x16x32_bf16 v[140:143], a[112:115], v[60:63], v[140:143]
    s_add_u32 s40, s40, 4096
    buffer_load_dwordx4 a[16:19], v9, s[12:15], s40 offen offset:0 sc1
    ds_read_b64_tr_b16 v[82:83], v10 offset:10240
    v_mfma_f32_16x16x32_bf16 v[140:143], a[116:119], v[76:79], v[140:143]
    v_mfma_f32_16x16x32_bf16 v[136:139], a[112:115], v[56:59], v[136:139]
    ds_read_b64_tr_b16 v[96:97], v10 offset:12288
    v_lshlrev_b32 v18, 16, v48
    v_mfma_f32_16x16x32_bf16 v[136:139], a[116:119], v[72:75], v[136:139]
    buffer_load_dwordx4 a[52:55], v9, s[12:15], s40 offen offset:1024 sc1
    v_and_b32 v19, 0xffff0000, v48
    v_mfma_f32_16x16x32_bf16 v[132:135], a[112:115], v[52:55], v[132:135]
    ds_read_b64_tr_b16 v[98:99], v10 offset:14336
    v_add_f32 v14, v14, v18
    v_mfma_f32_16x16x32_bf16 v[132:135], a[116:119], v[68:71], v[132:135]
    v_add_f32 v15, v15, v19
    v_mfma_f32_16x16x32_bf16 v[128:131], a[112:115], v[48:51], v[128:131]
    buffer_load_dwordx4 a[20:23], v9, s[12:15], s40 offen offset:2048 sc1
    ds_read_b64_tr_b16 v[84:85], v11 offset:8192
    v_mfma_f32_16x16x32_bf16 v[128:131], a[116:119], v[64:67], v[128:131]
    v_fmac_f32 v16, v18, v18
    v_mfma_f32_16x16x32_bf16 v[144:147], a[120:123], v[48:51], v[144:147]
    s_mov_b32 m0, s34
    s_add_u32 s34, s34, 4096
    ds_read_b64_tr_b16 v[86:87], v11 offset:10240
    v_mfma_f32_16x16x32_bf16 v[144:147], a[124:127], v[64:67], v[144:147]
    v_fmac_f32 v17, v19, v19
    buffer_load_dwordx4 v6, s[8:11], s33 offen sc1 lds
    s_add_u32 s33, s33, 131072
    v_mfma_f32_16x16x32_bf16 v[148:151], a[120:123], v[52:55], v[148:151]
    v_lshlrev_b32 v18, 16, v49
    ds_read_b64_tr_b16 v[100:101], v11 offset:12288
    v_mfma_f32_16x16x32_bf16 v[148:151], a[124:127], v[68:71], v[148:151]
    v_and_b32 v19, 0xffff0000, v49
    v_mfma_f32_16x16x32_bf16 v[152:155], a[120:123], v[56:59], v[152:155]
    ds_read_b64_tr_b16 v[102:103], v11 offset:14336
    v_add_f32 v14, v14, v18
    v_mfma_f32_16x16x32_bf16 v[152:155], a[124:127], v[72:75], v[152:155]
    v_add_f32 v15, v15, v19
L_pg5:
    s_cbranch_execz L_pg9
    s_nop 0
    v_mfma_f32_16x16x32_bf16 v[156:159], a[120:123], v[60:63], v[156:159]
    v_fmac_f32 v16, v18, v18
    v_mfma_f32_16x16x32_bf16 v[156:159], a[124:127], v[76:79], v[156:159]
    ds_read_b64_tr_b16 v[88:89], v12 offset:8192
    v_mfma_f32_16x16x32_bf16 v[172:175], a[128:131], v[60:63], v[172:175]
    v_fmac_f32 v17, v19, v19
    v_mfma_f32_16x16x32_bf16 v[172:175], a[132:135], v[76:79], v[172:175]
    buffer_load_dwordx4 a[56:59], v9, s[12:15], s40 offen offset:3072 sc1
    ds_read_b64_tr_b16 v[90:91], v12 offset:10240
    v_mfma_f32_16x16x32_bf16 v[168:171], a[128:131], v[56:59], v[168:171]
    v_lshlrev_b32 v18, 16, v50
    v_and_b32 v19, 0xffff0000, v50
    v_mfma_f32_16x16x32_bf16 v[168:171], a[132:135], v[72:75], v[168:171]
    ds_read_b64_tr_b16 v[104:105], v12 offset:12288
    v_add_f32 v14, v14, v18
    v_mfma_f32_16x16x32_bf16 v[164:167], a[128:131], v[52:55], v[164:167]
    s_add_u32 s40, s40, 4096
    buffer_load_dwordx4 a[24:27], v9, s[12:15], s40 offen offset:0 sc1
    v_add_f32 v15, v15, v19
    v_mfma_f32_16x16x32_bf16 v[164:167], a[132:135], v[68:71], v[164:167]
    ds_read_b64_tr_b16 v[106:107], v12 offset:14336
    v_mfma_f32_16x16x32_bf16 v[160:163], a[128:131], v[48:51], v[160:163]
    v_fmac_f32 v16, v18, v18
    v_mfma_f32_16x16x32_bf16 v[160:163], a[132:135], v[64:67], v[160:163]
    buffer_load_dwordx4 a[60:63], v9, s[12:15], s40 offen offset:1024 sc1
    v_mfma_f32_16x16x32_bf16 v[176:179], a[136:139], v[48:51], v[176:179]
    ds_read_b64_tr_b16 v[92:93], v13 offset:8192
    v_fmac_f32 v17, v19, v19
    v_mfma_f32_16x16x32_bf16 v[176:179], a[140:143], v[64:67], v[176:179]
    v_lshlrev_b32 v18, 16, v51
    ds_read_b64_tr_b16 v[94:95], v13 offset:10240
    v_mfma_f32_16x16x32_bf16 v[180:183], a[136:139], v[52:55], v[180:183]
    v_and_b32 v19, 0xffff0000, v51
    buffer_load_dwordx4 a[28:31], v9, s[12:15], s40 offen offset:2048 sc1
    v_mfma_f32_16x16x32_bf16 v[180:183], a[140:143], v[68:71], v[180:183]
    ds_read_b64_tr_b16 v[108:109], v13 offset:12288
    v_add_f32 v14, v14, v18
    v_mfma_f32_16x16x32_bf16 v[184:187], a[136:139], v[56:59], v[184:187]
    v_add_f32 v15, v15, v19
    v_mfma_f32_16x16x32_bf16 v[184:187], a[140:143], v[72:75], v[184:187]
    buffer_load_dwordx4 a[64:67], v9, s[12:15], s40 offen offset:3072 sc1
    ds_read_b64_tr_b16 v[110:111], v13 offset:14336
    v_mfma_f32_16x16x32_bf16 v[188:191], a[136:139], v[60:63], v[188:191]
    v_fmac_f32 v16, v18, v18
    v_fmac_f32 v17, v19, v19
    v_mfma_f32_16x16x32_bf16 v[188:191], a[140:143], v[76:79], v[188:191]
    v_mfma_f32_16x16x32_bf16 v[204:207], a[144:147], v[60:63], v[204:207]
    s_add_u32 s40, s40, 4096
    buffer_load_dwordx4 a[32:35], v9, s[12:15], s40 offen offset:0 sc1
    v_lshlrev_b32 v18, 16, v64
    v_mfma_f32_16x16x32_bf16 v[204:207], a[148:151], v[76:79], v[204:207]
    v_and_b32 v19, 0xffff0000, v64
    v_mfma_f32_16x16x32_bf16 v[200:203], a[144:147], v[56:59], v[200:203]
    v_add_f32 v14, v14, v18
    v_mfma_f32_16x16x32_bf16 v[200:203], a[148:151], v[72:75], v[200:203]
    buffer_load_dwordx4 a[68:71], v9, s[12:15], s40 offen offset:1024 sc1
    v_add_f32 v15, v15, v19
    v_mfma_f32_16x16x32_bf16 v[196:199], a[144:147], v[52:55], v[196:199]
    v_mfma_f32_16x16x32_bf16 v[196:199], a[148:151], v[68:71], v[196:199]
    v_fmac_f32 v16, v18, v18
    v_mfma_f32_16x16x32_bf16 v[192:195], a[144:147], v[48:51], v[192:195]
    buffer_load_dwordx4 a[216:219], v9, s[12:15], s40 offen offset:2048 sc1
    v_fmac_f32 v17, v19, v19
    v_mfma_f32_16x16x32_bf16 v[192:195], a[148:151], v[64:67], v[192:195]
    v_lshlrev_b32 v18, 16, v65
    v_mfma_f32_16x16x32_bf16 v[208:211], a[152:155], v[48:51], v[208:211]
    v_and_b32 v19, 0xffff0000, v65
    v_mfma_f32_16x16x32_bf16 v[208:211], a[156:159], v[64:67], v[208:211]
    v_mfma_f32_16x16x32_bf16 v[212:215], a[152:155], v[52:55], v[212:215]
    buffer_load_dwordx4 a[220:223], v9, s[12:15], s40 offen offset:3072 sc1
    v_add_f32 v14, v14, v18
    v_mfma_f32_16x16x32_bf16 v[212:215], a[156:159], v[68:71], v[212:215]
    v_add_f32 v15, v15, v19
    v_mfma_f32_16x16x32_bf16 v[216:219], a[152:155], v[56:59], v[216:219]
    v_fmac_f32 v16, v18, v18
    v_mfma_f32_16x16x32_bf16 v[216:219], a[156:159], v[72:75], v[216:219]
    s_add_u32 s40, s40, 4096
    buffer_load_dwordx4 a[224:227], v9, s[12:15], s40 offen offset:0 sc1
    v_fmac_f32 v17, v19, v19
    v_mfma_f32_16x16x32_bf16 v[220:223], a[152:155], v[60:63], v[220:223]
    v_mfma_f32_16x16x32_bf16 v[220:223], a[156:159], v[76:79], v[220:223]
    v_lshlrev_b32 v18, 16, v66
    v_mfma_f32_16x16x32_bf16 v[236:239], a[160:163], v[60:63], v[236:239]
    buffer_load_dwordx4 a[228:231], v9, s[12:15], s40 offen offset:1024 sc1
    v_and_b32 v19, 0xffff0000, v66
    v_mfma_f32_16x16x32_bf16 v[236:239], a[164:167], v[76:79], v[236:239]
    v_add_f32 v14, v14, v18
    v_mfma_f32_16x16x32_bf16 v[232:235], a[160:163], v[56:59], v[232:235]
    v_add_f32 v15, v15, v19
    v_mfma_f32_16x16x32_bf16 v[232:235], a[164:167], v[72:75], v[232:235]
    buffer_load_dwordx4 a[232:235], v9, s[12:15], s40 offen offset:2048 sc1
    v_mfma_f32_16x16x32_bf16 v[228:231], a[160:163], v[52:55], v[228:231]
    v_fmac_f32 v16, v18, v18
    v_mfma_f32_16x16x32_bf16 v[228:231], a[164:167], v[68:71], v[228:231]
    v_fmac_f32 v17, v19, v19
    v_mfma_f32_16x16x32_bf16 v[224:227], a[160:163], v[48:51], v[224:227]
    buffer_load_dwordx4 a[236:239], v9, s[12:15], s40 offen offset:3072 sc1
    v_lshlrev_b32 v18, 16, v67
    v_mfma_f32_16x16x32_bf16 v[224:227], a[164:167], v[64:67], v[224:227]
    v_and_b32 v19, 0xffff0000, v67
    v_mfma_f32_16x16x32_bf16 v[240:243], a[168:171], v[48:51], v[240:243]
    s_add_u32 s39, s28, 1
    s_and_b32 s39, s39, 7
    s_lshl_b32 s39, s39, 7
    s_add_u32 s39, s39, s43
    s_mov_b32 m0, s38
    s_add_u32 s38, s38, 4096
    v_mfma_f32_16x16x32_bf16 v[240:243], a[172:175], v[64:67], v[240:243]
    buffer_load_dwordx4 v32, s[52:55], s39 offen lds
    v_add_f32 v14, v14, v18
    v_mfma_f32_16x16x32_bf16 v[244:247], a[168:171], v[52:55], v[244:247]
    v_add_f32 v15, v15, v19
    v_mfma_f32_16x16x32_bf16 v[244:247], a[172:175], v[68:71], v[244:247]
    s_add_u32 s39, s39, 36864
    s_mov_b32 m0, s38
    s_add_u32 s38, s38, 4096
    v_fmac_f32 v16, v18, v18
    v_mfma_f32_16x16x32_bf16 v[248:251], a[168:171], v[56:59], v[248:251]
    buffer_load_dwordx4 v32, s[52:55], s39 offen lds
    v_fmac_f32 v17, v19, v19
    v_mfma_f32_16x16x32_bf16 v[248:251], a[172:175], v[72:75], v[248:251]
    v_mfma_f32_16x16x32_bf16 v[252:255], a[168:171], v[60:63], v[252:255]
    v_mfma_f32_16x16x32_bf16 v[252:255], a[172:175], v[76:79], v[252:255]
    s_waitcnt lgkmcnt(0)
    s_waitcnt vmcnt(15)
    s_barrier
    v_mfma_f32_16x16x32_bf16 v[112:115], a[176:179], v[80:83], v[112:115]
    v_cmp_ne_u32 vcc, s58, v7
    s_cbranch_vccnz L_a_spin
L_a_ok:
    v_mfma_f32_16x16x32_bf16 v[112:115], a[180:183], v[96:99], v[112:115]
    s_mov_b32 m0, s34
    s_add_u32 s34, s34, 4096
    buffer_load_dwordx4 v6, s[8:11], s33 offen sc1 lds
    s_add_u32 s33, s33, 131072
    v_mfma_f32_16x16x32_bf16 v[116:119], a[176:179], v[84:87], v[116:119]
    v_mfma_f32_16x16x32_bf16 v[116:119], a[180:183], v[100:103], v[116:119]
    v_mfma_f32_16x16x32_bf16 v[120:123], a[176:179], v[88:91], v[120:123]
    v_mfma_f32_16x16x32_bf16 v[120:123], a[180:183], v[104:107], v[120:123]
    v_mfma_f32_16x16x32_bf16 v[124:127], a[176:179], v[92:95], v[124:127]
    ds_read_b64_tr_b16 v[48:49], v10 offset:16384
    v_mfma_f32_16x16x32_bf16 v[124:127], a[180:183], v[108:111], v[124:127]
    v_mfma_f32_16x16x32_bf16 v[140:143], a[184:187], v[92:95], v[140:143]
    s_add_u32 s40, s40, 4096
    buffer_load_dwordx4 a[240:243], v9, s[12:15], s40 offen offset:0 sc1
    ds_read_b64_tr_b16 v[50:51], v10 offset:18432
    v_mfma_f32_16x16x32_bf16 v[140:143], a[188:191], v[108:111], v[140:143]
    v_mfma_f32_16x16x32_bf16 v[136:139], a[184:187], v[88:91], v[136:139]
    ds_read_b64_tr_b16 v[64:65], v10 offset:20480
    v_lshlrev_b32 v18, 16, v80
    v_mfma_f32_16x16x32_bf16 v[136:139], a[188:191], v[104:107], v[136:139]
    buffer_load_dwordx4 a[244:247], v9, s[12:15], s40 offen offset:1024 sc1
    v_and_b32 v19, 0xffff0000, v80
    v_mfma_f32_16x16x32_bf16 v[132:135], a[184:187], v[84:87], v[132:135]
    ds_read_b64_tr_b16 v[66:67], v10 offset:22528
    v_add_f32 v14, v14, v18
    v_mfma_f32_16x16x32_bf16 v[132:135], a[188:191], v[100:103], v[132:135]
    v_add_f32 v15, v15, v19
    v_mfma_f32_16x16x32_bf16 v[128:131], a[184:187], v[80:83], v[128:131]
    ds_read_b64_tr_b16 v[52:53], v11 offset:16384
    v_mfma_f32_16x16x32_bf16 v[128:131], a[188:191], v[96:99], v[128:131]
    buffer_load_dwordx4 a[248:251], v9, s[12:15], s40 offen offset:2048 sc1
    v_mfma_f32_16x16x32_bf16 v[144:147], a[192:195], v[80:83], v[144:147]
    v_fmac_f32 v16, v18, v18
    ds_read_b64_tr_b16 v[54:55], v11 offset:18432
    v_mfma_f32_16x16x32_bf16 v[144:147], a[196:199], v[96:99], v[144:147]
    v_fmac_f32 v17, v19, v19
    s_mov_b32 m0, s34
    s_add_u32 s34, s34, 4096
    v_mfma_f32_16x16x32_bf16 v[148:151], a[192:195], v[84:87], v[148:151]
    v_lshlrev_b32 v18, 16, v81
    buffer_load_dwordx4 v6, s[8:11], s33 offen sc1 lds
    s_add_u32 s33, s33, 131072
    v_mfma_f32_16x16x32_bf16 v[148:151], a[196:199], v[100:103], v[148:151]
    ds_read_b64_tr_b16 v[68:69], v11 offset:20480
    v_and_b32 v19, 0xffff0000, v81
    v_mfma_f32_16x16x32_bf16 v[152:155], a[192:195], v[88:91], v[152:155]
    ds_read_b64_tr_b16 v[70:71], v11 offset:22528
    v_add_f32 v14, v14, v18
    v_mfma_f32_16x16x32_bf16 v[152:155], a[196:199], v[104:107], v[152:155]
    v_add_f32 v15, v15, v19
    v_mfma_f32_16x16x32_bf16 v[156:159], a[192:195], v[92:95], v[156:159]
    v_fmac_f32 v16, v18, v18
    v_mfma_f32_16x16x32_bf16 v[156:159], a[196:199], v[108:111], v[156:159]
    ds_read_b64_tr_b16 v[56:57], v12 offset:16384
    v_mfma_f32_16x16x32_bf16 v[172:175], a[200:203], v[92:95], v[172:175]
    v_fmac_f32 v17, v19, v19
    v_mfma_f32_16x16x32_bf16 v[172:175], a[204:207], v[108:111], v[172:175]
    ds_read_b64_tr_b16 v[58:59], v12 offset:18432
    v_lshlrev_b32 v18, 16, v82
    v_mfma_f32_16x16x32_bf16 v[168:171], a[200:203], v[88:91], v[168:171]
    buffer_load_dwordx4 a[252:255], v9, s[12:15], s40 offen offset:3072 sc1
    v_and_b32 v19, 0xffff0000, v82
    v_mfma_f32_16x16x32_bf16 v[168:171], a[204:207], v[104:107], v[168:171]
    ds_read_b64_tr_b16 v[72:73], v12 offset:20480
    v_add_f32 v14, v14, v18
    v_mfma_f32_16x16x32_bf16 v[164:167], a[200:203], v[84:87], v[164:167]
    v_add_f32 v15, v15, v19
    v_mfma_f32_16x16x32_bf16 v[164:167], a[204:207], v[100:103], v[164:167]
    s_add_u32 s40, s40, 4096
    buffer_load_dwordx4 a[72:75], v9, s[12:15], s40 offen offset:0 sc1
    ds_read_b64_tr_b16 v[74:75], v12 offset:22528
    v_mfma_f32_16x16x32_bf16 v[160:163], a[200:203], v[80:83], v[160:163]
    v_fmac_f32 v16, v18, v18
    v_mfma_f32_16x16x32_bf16 v[160:163], a[204:207], v[96:99], v[160:163]
    ds_read_b64_tr_b16 v[60:61], v13 offset:16384
    v_mfma_f32_16x16x32_bf16 v[176:179], a[208:211], v[80:83], v[176:179]
    v_fmac_f32 v17, v19, v19
    buffer_load_dwordx4 a[76:79], v9, s[12:15], s40 offen offset:1024 sc1
    v_mfma_f32_16x16x32_bf16 v[176:179], a[212:215], v[96:99], v[176:179]
    v_lshlrev_b32 v18, 16, v83
    ds_read_b64_tr_b16 v[62:63], v13 offset:18432
    v_mfma_f32_16x16x32_bf16 v[180:183], a[208:211], v[84:87], v[180:183]
    v_and_b32 v19, 0xffff0000, v83
    v_mfma_f32_16x16x32_bf16 v[180:183], a[212:215], v[100:103], v[180:183]
    ds_read_b64_tr_b16 v[76:77], v13 offset:20480
    v_add_f32 v14, v14, v18
    v_mfma_f32_16x16x32_bf16 v[184:187], a[208:211], v[88:91], v[184:187]
    buffer_load_dwordx4 a[80:83], v9, s[12:15], s40 offen offset:2048 sc1
    v_add_f32 v15, v15, v19
    v_mfma_f32_16x16x32_bf16 v[184:187], a[212:215], v[104:107], v[184:187]
    ds_read_b64_tr_b16 v[78:79], v13 offset:22528
    v_fmac_f32 v16, v18, v18
    v_mfma_f32_16x16x32_bf16 v[188:191], a[208:211], v[92:95], v[188:191]
    v_fmac_f32 v17, v19, v19
    v_mfma_f32_16x16x32_bf16 v[188:191], a[212:215], v[108:111], v[188:191]
    buffer_load_dwordx4 a[84:87], v9, s[12:15], s40 offen offset:3072 sc1
    v_mfma_f32_16x16x32_bf16 v[204:207], a[0:3], v[92:95], v[204:207]
    v_lshlrev_b32 v18, 16, v96
    v_mfma_f32_16x16x32_bf16 v[204:207], a[36:39], v[108:111], v[204:207]
    v_and_b32 v19, 0xffff0000, v96
    v_mfma_f32_16x16x32_bf16 v[200:203], a[0:3], v[88:91], v[200:203]
    s_add_u32 s40, s40, 4096
    buffer_load_dwordx4 a[88:91], v9, s[12:15], s40 offen offset:0 sc1
    v_add_f32 v14, v14, v18
    v_mfma_f32_16x16x32_bf16 v[200:203], a[36:39], v[104:107], v[200:203]
    v_add_f32 v15, v15, v19
    v_mfma_f32_16x16x32_bf16 v[196:199], a[0:3], v[84:87], v[196:199]
    v_mfma_f32_16x16x32_bf16 v[196:199], a[36:39], v[100:103], v[196:199]
    buffer_load_dwordx4 a[92:95], v9, s[12:15], s40 offen offset:1024 sc1
    v_fmac_f32 v16, v18, v18
    v_mfma_f32_16x16x32_bf16 v[192:195], a[0:3], v[80:83], v[192:195]
    v_fmac_f32 v17, v19, v19
    v_mfma_f32_16x16x32_bf16 v[192:195], a[36:39], v[96:99], v[192:195]
    v_lshlrev_b32 v18, 16, v97
    v_mfma_f32_16x16x32_bf16 v[208:211], a[4:7], v[80:83], v[208:211]
    v_and_b32 v19, 0xffff0000, v97
    v_mfma_f32_16x16x32_bf16 v[208:211], a[40:43], v[96:99], v[208:211]
    buffer_load_dwordx4 a[96:99], v9, s[12:15], s40 offen offset:2048 sc1
    v_mfma_f32_16x16x32_bf16 v[212:215], a[4:7], v[84:87], v[212:215]
    v_add_f32 v14, v14, v18
    v_mfma_f32_16x16x32_bf16 v[212:215], a[40:43], v[100:103], v[212:215]
    v_add_f32 v15, v15, v19
    v_mfma_f32_16x16x32_bf16 v[216:219], a[4:7], v[88:91], v[216:219]
    buffer_load_dwordx4 a[100:103], v9, s[12:15], s40 offen offset:3072 sc1
    v_fmac_f32 v16, v18, v18
    v_mfma_f32_16x16x32_bf16 v[216:219], a[40:43], v[104:107], v[216:219]
    v_fmac_f32 v17, v19, v19
    v_mfma_f32_16x16x32_bf16 v[220:223], a[4:7], v[92:95], v[220:223]
    v_mfma_f32_16x16x32_bf16 v[220:223], a[40:43], v[108:111], v[220:223]
    s_add_u32 s40, s40, 4096
    buffer_load_dwordx4 a[104:107], v9, s[12:15], s40 offen offset:0 sc1
    v_mfma_f32_16x16x32_bf16 v[236:239], a[8:11], v[92:95], v[236:239]
    v_lshlrev_b32 v18, 16, v98
    v_and_b32 v19, 0xffff0000, v98
    v_mfma_f32_16x16x32_bf16 v[236:239], a[44:47], v[108:111], v[236:239]
    v_add_f32 v14, v14, v18
    v_mfma_f32_16x16x32_bf16 v[232:235], a[8:11], v[88:91], v[232:235]
    buffer_load_dwordx4 a[108:111], v9, s[12:15], s40 offen offset:1024 sc1
    v_add_f32 v15, v15, v19
    v_mfma_f32_16x16x32_bf16 v[232:235], a[44:47], v[104:107], v[232:235]
    v_mfma_f32_16x16x32_bf16 v[228:231], a[8:11], v[84:87], v[228:231]
    v_fmac_f32 v16, v18, v18
    v_mfma_f32_16x16x32_bf16 v[228:231], a[44:47], v[100:103], v[228:231]
    v_fmac_f32 v17, v19, v19
    v_mfma_f32_16x16x32_bf16 v[224:227], a[8:11], v[80:83], v[224:227]
    buffer_load_dwordx4 a[112:115], v9, s[12:15], s40 offen offset:2048 sc1
    v_lshlrev_b32 v18, 16, v99
    v_mfma_f32_16x16x32_bf16 v[224:227], a[44:47], v[96:99], v[224:227]
    v_and_b32 v19, 0xffff0000, v99
    v_mfma_f32_16x16x32_bf16 v[240:243], a[12:15], v[80:83], v[240:243]
    v_mfma_f32_16x16x32_bf16 v[240:243], a[48:51], v[96:99], v[240:243]
    buffer_load_dwordx4 a[116:119], v9, s[12:15], s40 offen offset:3072 sc1
    v_add_f32 v14, v14, v18
    v_mfma_f32_16x16x32_bf16 v[244:247], a[12:15], v[84:87], v[244:247]
    v_add_f32 v15, v15, v19
    v_mfma_f32_16x16x32_bf16 v[244:247], a[48:51], v[100:103], v[244:247]
    s_mov_b32 m0, s36
    s_mul_i32 s37, s31, 576
    v_fmac_f32 v16, v18, v18
    v_mfma_f32_16x16x32_bf16 v[248:251], a[12:15], v[88:91], v[248:251]
    buffer_load_dwordx4 v9, s[48:51], s37 offen sc1 lds
    v_fmac_f32 v17, v19, v19
    v_mfma_f32_16x16x32_bf16 v[248:251], a[48:51], v[104:107], v[248:251]
    v_mfma_f32_16x16x32_bf16 v[252:255], a[12:15], v[92:95], v[252:255]
    v_mfma_f32_16x16x32_bf16 v[252:255], a[48:51], v[108:111], v[252:255]
    s_waitcnt lgkmcnt(0)
    s_waitcnt vmcnt(14)
    s_barrier
    v_mfma_f32_16x16x32_bf16 v[112:115], a[16:19], v[48:51], v[112:115]
    v_mfma_f32_16x16x32_bf16 v[112:115], a[52:55], v[64:67], v[112:115]
    s_mov_b32 m0, s34
    s_add_u32 s34, s34, 4096
    buffer_load_dwordx4 v6, s[8:11], s33 offen sc1 lds
    s_add_u32 s33, s33, 131072
    v_mfma_f32_16x16x32_bf16 v[116:119], a[16:19], v[52:55], v[116:119]
    v_mfma_f32_16x16x32_bf16 v[116:119], a[52:55], v[68:71], v[116:119]
    v_mfma_f32_16x16x32_bf16 v[120:123], a[16:19], v[56:59], v[120:123]
    v_mfma_f32_16x16x32_bf16 v[120:123], a[52:55], v[72:75], v[120:123]
    v_mfma_f32_16x16x32_bf16 v[124:127], a[16:19], v[60:63], v[124:127]
    ds_read_b64_tr_b16 v[80:81], v10 offset:24576
    v_mfma_f32_16x16x32_bf16 v[124:127], a[52:55], v[76:79], v[124:127]
    ds_read_b64_tr_b16 v[82:83], v10 offset:26624
    v_mfma_f32_16x16x32_bf16 v[140:143], a[20:23], v[60:63], v[140:143]
    s_add_u32 s40, s40, 4096
    buffer_load_dwordx4 a[120:123], v9, s[12:15], s40 offen offset:0 sc1
    v_mfma_f32_16x16x32_bf16 v[140:143], a[56:59], v[76:79], v[140:143]
    ds_read_b64_tr_b16 v[96:97], v10 offset:28672
    v_mfma_f32_16x16x32_bf16 v[136:139], a[20:23], v[56:59], v[136:139]
    v_lshlrev_b32 v18, 16, v48
    v_mfma_f32_16x16x32_bf16 v[136:139], a[56:59], v[72:75], v[136:139]
    buffer_load_dwordx4 a[124:127], v9, s[12:15], s40 offen offset:1024 sc1
    ds_read_b64_tr_b16 v[98:99], v10 offset:30720
    v_mfma_f32_16x16x32_bf16 v[132:135], a[20:23], v[52:55], v[132:135]
    v_and_b32 v19, 0xffff0000, v48
    ds_read_b64_tr_b16 v[84:85], v11 offset:24576
    v_mfma_f32_16x16x32_bf16 v[132:135], a[56:59], v[68:71], v[132:135]
    v_add_f32 v14, v14, v18
    v_add_f32 v15, v15, v19
    v_mfma_f32_16x16x32_bf16 v[128:131], a[20:23], v[48:51], v[128:131]
    buffer_load_dwordx4 a[128:131], v9, s[12:15], s40 offen offset:2048 sc1
    ds_read_b64_tr_b16 v[86:87], v11 offset:26624
    v_mfma_f32_16x16x32_bf16 v[128:131], a[56:59], v[64:67], v[128:131]
    v_fmac_f32 v16, v18, v18
    v_mfma_f32_16x16x32_bf16 v[144:147], a[24:27], v[48:51], v[144:147]
    s_mov_b32 m0, s34
    s_add_u32 s34, s34, 4096
    ds_read_b64_tr_b16 v[100:101], v11 offset:28672
    v_mfma_f32_16x16x32_bf16 v[144:147], a[60:63], v[64:67], v[144:147]
    v_fmac_f32 v17, v19, v19
    buffer_load_dwordx4 v6, s[8:11], s33 offen sc1 lds
    s_add_u32 s33, s33, 131072
    v_mfma_f32_16x16x32_bf16 v[148:151], a[24:27], v[52:55], v[148:151]
    ds_read_b64_tr_b16 v[102:103], v11 offset:30720
    v_lshlrev_b32 v18, 16, v49
    v_mfma_f32_16x16x32_bf16 v[148:151], a[60:63], v[68:71], v[148:151]
    v_and_b32 v19, 0xffff0000, v49
    ds_read_b64_tr_b16 v[88:89], v12 offset:24576
    v_mfma_f32_16x16x32_bf16 v[152:155], a[24:27], v[56:59], v[152:155]
    v_add_f32 v14, v14, v18
    v_mfma_f32_16x16x32_bf16 v[152:155], a[60:63], v[72:75], v[152:155]
    ds_read_b64_tr_b16 v[90:91], v12 offset:26624
    v_add_f32 v15, v15, v19
    v_mfma_f32_16x16x32_bf16 v[156:159], a[24:27], v[60:63], v[156:159]
    v_fmac_f32 v16, v18, v18
    v_mfma_f32_16x16x32_bf16 v[156:159], a[60:63], v[76:79], v[156:159]
    ds_read_b64_tr_b16 v[104:105], v12 offset:28672
    v_mfma_f32_16x16x32_bf16 v[172:175], a[28:31], v[60:63], v[172:175]
    v_fmac_f32 v17, v19, v19
    ds_read_b64_tr_b16 v[106:107], v12 offset:30720
    v_mfma_f32_16x16x32_bf16 v[172:175], a[64:67], v[76:79], v[172:175]
    buffer_load_dwordx4 a[132:135], v9, s[12:15], s40 offen offset:3072 sc1
    v_lshlrev_b32 v18, 16, v50
    v_mfma_f32_16x16x32_bf16 v[168:171], a[28:31], v[56:59], v[168:171]
    ds_read_b64_tr_b16 v[92:93], v13 offset:24576
    v_and_b32 v19, 0xffff0000, v50
    v_mfma_f32_16x16x32_bf16 v[168:171], a[64:67], v[72:75], v[168:171]
    v_add_f32 v14, v14, v18
    v_mfma_f32_16x16x32_bf16 v[164:167], a[28:31], v[52:55], v[164:167]
    s_add_u32 s40, s40, 4096
    buffer_load_dwordx4 a[136:139], v9, s[12:15], s40 offen offset:0 sc1
    ds_read_b64_tr_b16 v[94:95], v13 offset:26624
    v_mfma_f32_16x16x32_bf16 v[164:167], a[64:67], v[68:71], v[164:167]
    v_add_f32 v15, v15, v19
    ds_read_b64_tr_b16 v[108:109], v13 offset:28672
    v_mfma_f32_16x16x32_bf16 v[160:163], a[28:31], v[48:51], v[160:163]
    v_fmac_f32 v16, v18, v18
    v_mfma_f32_16x16x32_bf16 v[160:163], a[64:67], v[64:67], v[160:163]
    buffer_load_dwordx4 a[140:143], v9, s[12:15], s40 offen offset:1024 sc1
    v_mfma_f32_16x16x32_bf16 v[176:179], a[32:35], v[48:51], v[176:179]
    ds_read_b64_tr_b16 v[110:111], v13 offset:30720
    v_fmac_f32 v17, v19, v19
    v_mfma_f32_16x16x32_bf16 v[176:179], a[68:71], v[64:67], v[176:179]
    v_lshlrev_b32 v18, 16, v51
    v_add_u32 v10, 32768, v10
    v_mfma_f32_16x16x32_bf16 v[180:183], a[32:35], v[52:55], v[180:183]
    v_and_b32 v19, 0xffff0000, v51
    buffer_load_dwordx4 a[144:147], v9, s[12:15], s40 offen offset:2048 sc1
    v_mfma_f32_16x16x32_bf16 v[180:183], a[68:71], v[68:71], v[180:183]
    v_add_u32 v11, 32768, v11
    v_add_f32 v14, v14, v18
    v_mfma_f32_16x16x32_bf16 v[184:187], a[32:35], v[56:59], v[184:187]
    v_add_u32 v12, 32768, v12
    v_add_f32 v15, v15, v19
    v_mfma_f32_16x16x32_bf16 v[184:187], a[68:71], v[72:75], v[184:187]
    buffer_load_dwordx4 a[148:151], v9, s[12:15], s40 offen offset:3072 sc1
    v_fmac_f32 v16, v18, v18
    v_mfma_f32_16x16x32_bf16 v[188:191], a[32:35], v[60:63], v[188:191]
    v_add_u32 v13, 32768, v13
    v_fmac_f32 v17, v19, v19
    v_mfma_f32_16x16x32_bf16 v[188:191], a[68:71], v[76:79], v[188:191]
    v_mfma_f32_16x16x32_bf16 v[204:207], a[216:219], v[60:63], v[204:207]
    s_add_u32 s40, s40, 4096
    buffer_load_dwordx4 a[152:155], v9, s[12:15], s40 offen offset:0 sc1
    v_lshlrev_b32 v18, 16, v64
    v_mfma_f32_16x16x32_bf16 v[204:207], a[220:223], v[76:79], v[204:207]
    v_and_b32 v19, 0xffff0000, v64
    v_mfma_f32_16x16x32_bf16 v[200:203], a[216:219], v[56:59], v[200:203]
    v_add_f32 v14, v14, v18
    v_mfma_f32_16x16x32_bf16 v[200:203], a[220:223], v[72:75], v[200:203]
    buffer_load_dwordx4 a[156:159], v9, s[12:15], s40 offen offset:1024 sc1
    v_add_f32 v15, v15, v19
    v_mfma_f32_16x16x32_bf16 v[196:199], a[216:219], v[52:55], v[196:199]
    v_mfma_f32_16x16x32_bf16 v[196:199], a[220:223], v[68:71], v[196:199]
    v_fmac_f32 v16, v18, v18
    v_mfma_f32_16x16x32_bf16 v[192:195], a[216:219], v[48:51], v[192:195]
    buffer_load_dwordx4 a[160:163], v9, s[12:15], s40 offen offset:2048 sc1
    v_fmac_f32 v17, v19, v19
    v_mfma_f32_16x16x32_bf16 v[192:195], a[220:223], v[64:67], v[192:195]
    v_lshlrev_b32 v18, 16, v65
    v_mfma_f32_16x16x32_bf16 v[208:211], a[224:227], v[48:51], v[208:211]
    v_and_b32 v19, 0xffff0000, v65
    v_mfma_f32_16x16x32_bf16 v[208:211], a[228:231], v[64:67], v[208:211]
    v_mfma_f32_16x16x32_bf16 v[212:215], a[224:227], v[52:55], v[212:215]
    buffer_load_dwordx4 a[164:167], v9, s[12:15], s40 offen offset:3072 sc1
    v_add_f32 v14, v14, v18
    v_mfma_f32_16x16x32_bf16 v[212:215], a[228:231], v[68:71], v[212:215]
    v_add_f32 v15, v15, v19
    v_mfma_f32_16x16x32_bf16 v[216:219], a[224:227], v[56:59], v[216:219]
    v_fmac_f32 v16, v18, v18
    v_mfma_f32_16x16x32_bf16 v[216:219], a[228:231], v[72:75], v[216:219]
    s_add_u32 s40, s40, 4096
    buffer_load_dwordx4 a[168:171], v9, s[12:15], s40 offen offset:0 sc1
    v_fmac_f32 v17, v19, v19
    v_mfma_f32_16x16x32_bf16 v[220:223], a[224:227], v[60:63], v[220:223]
    v_mfma_f32_16x16x32_bf16 v[220:223], a[228:231], v[76:79], v[220:223]
    v_lshlrev_b32 v18, 16, v66
    v_mfma_f32_16x16x32_bf16 v[236:239], a[232:235], v[60:63], v[236:239]
    buffer_load_dwordx4 a[172:175], v9, s[12:15], s40 offen offset:1024 sc1
    v_and_b32 v19, 0xffff0000, v66
    v_mfma_f32_16x16x32_bf16 v[236:239], a[236:239], v[76:79], v[236:239]
    v_add_f32 v14, v14, v18
    v_mfma_f32_16x16x32_bf16 v[232:235], a[232:235], v[56:59], v[232:235]
    v_add_f32 v15, v15, v19
    v_mfma_f32_16x16x32_bf16 v[232:235], a[236:239], v[72:75], v[232:235]
    buffer_load_dwordx4 a[176:179], v9, s[12:15], s40 offen offset:2048 sc1
    v_mfma_f32_16x16x32_bf16 v[228:231], a[232:235], v[52:55], v[228:231]
    v_fmac_f32 v16, v18, v18
    v_mfma_f32_16x16x32_bf16 v[228:231], a[236:239], v[68:71], v[228:231]
    v_fmac_f32 v17, v19, v19
    v_mfma_f32_16x16x32_bf16 v[224:227], a[232:235], v[48:51], v[224:227]
    buffer_load_dwordx4 a[180:183], v9, s[12:15], s40 offen offset:3072 sc1
    v_lshlrev_b32 v18, 16, v67
    v_mfma_f32_16x16x32_bf16 v[224:227], a[236:239], v[64:67], v[224:227]
    v_and_b32 v19, 0xffff0000, v67
    v_mfma_f32_16x16x32_bf16 v[240:243], a[240:243], v[48:51], v[240:243]
    s_add_u32 s39, s28, 2
    s_and_b32 s39, s39, 7
    s_lshl_b32 s39, s39, 7
    s_add_u32 s39, s39, s43
    s_mov_b32 m0, s38
    s_add_u32 s38, s38, 4096
    v_mfma_f32_16x16x32_bf16 v[240:243], a[244:247], v[64:67], v[240:243]
    buffer_load_dwordx4 v32, s[52:55], s39 offen lds
    v_add_f32 v14, v14, v18
    v_mfma_f32_16x16x32_bf16 v[244:247], a[240:243], v[52:55], v[244:247]
    v_add_f32 v15, v15, v19
    v_mfma_f32_16x16x32_bf16 v[244:247], a[244:247], v[68:71], v[244:247]
    s_add_u32 s39, s39, 36864
    s_mov_b32 m0, s38
    s_add_u32 s38, s38, 4096
    v_fmac_f32 v16, v18, v18
    v_mfma_f32_16x16x32_bf16 v[248:251], a[240:243], v[56:59], v[248:251]
    buffer_load_dwordx4 v32, s[52:55], s39 offen lds
    v_fmac_f32 v17, v19, v19
    v_mfma_f32_16x16x32_bf16 v[248:251], a[244:247], v[72:75], v[248:251]
    v_mfma_f32_16x16x32_bf16 v[252:255], a[240:243], v[60:63], v[252:255]
    v_mfma_f32_16x16x32_bf16 v[252:255], a[244:247], v[76:79], v[252:255]
    s_waitcnt lgkmcnt(0)
    s_waitcnt vmcnt(33)
    s_waitcnt vmcnt(15)
    s_barrier
    v_mfma_f32_16x16x32_bf16 v[112:115], a[248:251], v[80:83], v[112:115]
    v_lshrrev_b32 v8, 2, v2
    v_mfma_f32_16x16x32_bf16 v[112:115], a[252:255], v[96:99], v[112:115]
    s_add_u32 s40, s40, 4096
    buffer_load_dwordx4 a[184:187], v9, s[12:15], s40 offen offset:0 sc1
    v_lshlrev_b32 v28, 7, v8
    v_mfma_f32_16x16x32_bf16 v[116:119], a[248:251], v[84:87], v[116:119]
    v_mfma_f32_16x16x32_bf16 v[116:119], a[252:255], v[100:103], v[116:119]
    v_and_b32 v29, 3, v2
    v_mfma_f32_16x16x32_bf16 v[120:123], a[248:251], v[88:91], v[120:123]
    buffer_load_dwordx4 a[188:191], v9, s[12:15], s40 offen offset:1024 sc1
    v_lshl_add_u32 v28, v29, 3, v28
    v_mfma_f32_16x16x32_bf16 v[120:123], a[252:255], v[104:107], v[120:123]
    v_mfma_f32_16x16x32_bf16 v[124:127], a[248:251], v[92:95], v[124:127]
    ds_read_b64_tr_b16 v[48:49], v10 offset:0
    v_bfe_u32 v29, v2, 3, 2
    v_mfma_f32_16x16x32_bf16 v[124:127], a[252:255], v[108:111], v[124:127]
    v_mfma_f32_16x16x32_bf16 v[140:143], a[72:75], v[92:95], v[140:143]
    buffer_load_dwordx4 a[192:195], v9, s[12:15], s40 offen offset:2048 sc1
    ds_read_b64_tr_b16 v[50:51], v10 offset:2048
    v_mfma_f32_16x16x32_bf16 v[140:143], a[76:79], v[108:111], v[140:143]
    s_lshl_b32 s35, s31, 11
    v_add_u32 v30, s35, v28
    v_mfma_f32_16x16x32_bf16 v[136:139], a[72:75], v[88:91], v[136:139]
    ds_read_b64_tr_b16 v[64:65], v10 offset:4096
    v_lshlrev_b32 v18, 16, v80
    v_mfma_f32_16x16x32_bf16 v[136:139], a[76:79], v[104:107], v[136:139]
    v_and_b32 v19, 0xffff0000, v80
    v_xor_b32 v31, 0, v29
    v_mfma_f32_16x16x32_bf16 v[132:135], a[72:75], v[84:87], v[132:135]
    buffer_load_dwordx4 a[196:199], v9, s[12:15], s40 offen offset:3072 sc1
    ds_read_b64_tr_b16 v[66:67], v10 offset:6144
    v_mfma_f32_16x16x32_bf16 v[132:135], a[76:79], v[100:103], v[132:135]
    v_add_f32 v14, v14, v18
    v_lshl_add_u32 v31, v31, 5, v30
    v_mfma_f32_16x16x32_bf16 v[128:131], a[72:75], v[80:83], v[128:131]
    v_add_f32 v15, v15, v19
    ds_read_b64_tr_b16 v[52:53], v11 offset:0
    v_mfma_f32_16x16x32_bf16 v[128:131], a[76:79], v[96:99], v[128:131]
    ds_read_b64_tr_b16 v[36:37], v31
    v_mfma_f32_16x16x32_bf16 v[144:147], a[80:83], v[80:83], v[144:147]
    v_fmac_f32 v16, v18, v18
    s_add_u32 s40, s40, 4096
    buffer_load_dwordx4 a[200:203], v9, s[12:15], s40 offen offset:0 sc1
    v_mfma_f32_16x16x32_bf16 v[144:147], a[84:87], v[96:99], v[144:147]
    ds_read_b64_tr_b16 v[54:55], v11 offset:2048
    v_fmac_f32 v17, v19, v19
    v_mfma_f32_16x16x32_bf16 v[148:151], a[80:83], v[84:87], v[148:151]
    v_xor_b32 v31, 1, v29
    v_lshlrev_b32 v18, 16, v81
    v_mfma_f32_16x16x32_bf16 v[148:151], a[84:87], v[100:103], v[148:151]
    v_lshl_add_u32 v31, v31, 5, v30
    ds_read_b64_tr_b16 v[68:69], v11 offset:4096
    v_mfma_f32_16x16x32_bf16 v[152:155], a[80:83], v[88:91], v[152:155]
    v_and_b32 v19, 0xffff0000, v81
    ds_read_b64_tr_b16 v[38:39], v31
    v_mfma_f32_16x16x32_bf16 v[152:155], a[84:87], v[104:107], v[152:155]
    buffer_load_dwordx4 a[204:207], v9, s[12:15], s40 offen offset:1024 sc1
    ds_read_b64_tr_b16 v[70:71], v11 offset:6144
    v_mfma_f32_16x16x32_bf16 v[156:159], a[80:83], v[92:95], v[156:159]
    v_add_f32 v14, v14, v18
    v_add_f32 v15, v15, v19
    v_mfma_f32_16x16x32_bf16 v[156:159], a[84:87], v[108:111], v[156:159]
    v_xor_b32 v31, 2, v29
    v_mfma_f32_16x16x32_bf16 v[172:175], a[88:91], v[92:95], v[172:175]
    v_fmac_f32 v16, v18, v18
    v_lshl_add_u32 v31, v31, 5, v30
    v_mfma_f32_16x16x32_bf16 v[172:175], a[92:95], v[108:111], v[172:175]
    ds_read_b64_tr_b16 v[56:57], v12 offset:0
    v_fmac_f32 v17, v19, v19
    v_mfma_f32_16x16x32_bf16 v[168:171], a[88:91], v[88:91], v[168:171]
    buffer_load_dwordx4 a[208:211], v9, s[12:15], s40 offen offset:2048 sc1
    ds_read_b64_tr_b16 v[40:41], v31
    v_mfma_f32_16x16x32_bf16 v[168:171], a[92:95], v[104:107], v[168:171]
    ds_read_b64_tr_b16 v[58:59], v12 offset:2048
    v_lshlrev_b32 v18, 16, v82
    v_mfma_f32_16x16x32_bf16 v[164:167], a[88:91], v[84:87], v[164:167]
    v_xor_b32 v31, 3, v29
    v_and_b32 v19, 0xffff0000, v82
    v_mfma_f32_16x16x32_bf16 v[164:167], a[92:95], v[100:103], v[164:167]
    ds_read_b64_tr_b16 v[72:73], v12 offset:4096
    v_add_f32 v14, v14, v18
    v_mfma_f32_16x16x32_bf16 v[160:163], a[88:91], v[80:83], v[160:163]
    v_lshl_add_u32 v31, v31, 5, v30
    buffer_load_dwordx4 a[212:215], v9, s[12:15], s40 offen offset:3072 sc1
    v_mfma_f32_16x16x32_bf16 v[160:163], a[92:95], v[96:99], v[160:163]
    v_add_f32 v15, v15, v19
    v_mfma_f32_16x16x32_bf16 v[176:179], a[96:99], v[80:83], v[176:179]
    ds_read_b64_tr_b16 v[74:75], v12 offset:6144
    ds_read_b64_tr_b16 v[42:43], v31
    v_mfma_f32_16x16x32_bf16 v[176:179], a[100:103], v[96:99], v[176:179]
    v_fmac_f32 v16, v18, v18
    s_lshr_b32 s42, s28, 1
    v_mfma_f32_16x16x32_bf16 v[180:183], a[96:99], v[84:87], v[180:183]
    ds_read_b64_tr_b16 v[60:61], v13 offset:0
    v_fmac_f32 v17, v19, v19
    v_mfma_f32_16x16x32_bf16 v[180:183], a[100:103], v[100:103], v[180:183]
    s_add_u32 s40, s40, 4096
    buffer_load_dwordx4 a[0:3], v9, s[12:15], s40 offen offset:0 sc1
    v_lshlrev_b32 v18, 16, v83
    v_mfma_f32_16x16x32_bf16 v[184:187], a[96:99], v[88:91], v[184:187]
    s_lshl_b32 s42, s42, 2
    ds_read_b64_tr_b16 v[62:63], v13 offset:2048
    v_mfma_f32_16x16x32_bf16 v[184:187], a[100:103], v[104:107], v[184:187]
    v_and_b32 v19, 0xffff0000, v83
    s_add_u32 s42, s42, s30
    v_mfma_f32_16x16x32_bf16 v[188:191], a[96:99], v[92:95], v[188:191]
    ds_read_b64_tr_b16 v[76:77], v13 offset:4096
    v_add_f32 v14, v14, v18
    v_mfma_f32_16x16x32_bf16 v[188:191], a[100:103], v[108:111], v[188:191]
    s_lshl_b32 s35, s42, 9
    v_mfma_f32_16x16x32_bf16 v[204:207], a[104:107], v[92:95], v[204:207]
    buffer_load_dwordx4 a[36:39], v9, s[12:15], s40 offen offset:1024 sc1
    v_add_f32 v15, v15, v19
    v_mfma_f32_16x16x32_bf16 v[204:207], a[108:111], v[108:111], v[204:207]
    ds_read_b64_tr_b16 v[78:79], v13 offset:6144
L_pg6:
    s_cbranch_execz L_wret1
    s_nop 0
    v_fmac_f32 v16, v18, v18
    v_mfma_f32_16x16x32_bf16 v[200:203], a[104:107], v[88:91], v[200:203]
    s_add_u32 s35, s35, 65536
    v_fmac_f32 v17, v19, v19
    v_mfma_f32_16x16x32_bf16 v[200:203], a[108:111], v[104:107], v[200:203]
    v_and_b32 v30, 0x1ff, v28
    buffer_load_dwordx4 a[4:7], v9, s[12:15], s40 offen offset:2048 sc1
    v_mfma_f32_16x16x32_bf16 v[196:199], a[104:107], v[84:87], v[196:199]
    v_lshlrev_b32 v18, 16, v96
    v_add_u32 v30, s35, v30
    v_mfma_f32_16x16x32_bf16 v[196:199], a[108:111], v[100:103], v[196:199]
    v_and_b32 v19, 0xffff0000, v96
    v_add_f32 v14, v14, v18
    v_mfma_f32_16x16x32_bf16 v[192:195], a[104:107], v[80:83], v[192:195]
    s_lshl_b32 s35, s30, 1
    v_add_f32 v15, v15, v19
    v_mfma_f32_16x16x32_bf16 v[192:195], a[108:111], v[96:99], v[192:195]
    v_bfe_u32 v31, v2, 3, 1
    v_mfma_f32_16x16x32_bf16 v[208:211], a[112:115], v[80:83], v[208:211]
    buffer_load_dwordx4 a[40:43], v9, s[12:15], s40 offen offset:3072 sc1
    v_fmac_f32 v16, v18, v18
    v_mfma_f32_16x16x32_bf16 v[208:211], a[116:119], v[96:99], v[208:211]
    v_add_u32 v31, s35, v31
    v_fmac_f32 v17, v19, v19
    v_mfma_f32_16x16x32_bf16 v[212:215], a[112:115], v[84:87], v[212:215]
    v_lshlrev_b32 v18, 16, v97
    v_and_b32 v31, 3, v31
    v_mfma_f32_16x16x32_bf16 v[212:215], a[116:119], v[100:103], v[212:215]
    s_add_u32 s40, s40, 4096
    buffer_load_dwordx4 a[8:11], v9, s[12:15], s40 offen offset:0 sc1
    v_and_b32 v19, 0xffff0000, v97
    v_mfma_f32_16x16x32_bf16 v[216:219], a[112:115], v[88:91], v[216:219]
    s_and_b32 s35, s28, 1
    v_add_f32 v14, v14, v18
    v_mfma_f32_16x16x32_bf16 v[216:219], a[116:119], v[104:107], v[216:219]
    s_lshl_b32 s35, s35, 1
    v_add_f32 v15, v15, v19
    v_mfma_f32_16x16x32_bf16 v[220:223], a[112:115], v[92:95], v[220:223]
    v_bfe_u32 v29, v2, 4, 1
    buffer_load_dwordx4 a[44:47], v9, s[12:15], s40 offen offset:1024 sc1
    v_mfma_f32_16x16x32_bf16 v[220:223], a[116:119], v[108:111], v[220:223]
    v_fmac_f32 v16, v18, v18
    v_mfma_f32_16x16x32_bf16 v[236:239], a[120:123], v[92:95], v[236:239]
    v_fmac_f32 v17, v19, v19
    v_add_u32 v33, s35, v29
    v_mfma_f32_16x16x32_bf16 v[236:239], a[124:127], v[108:111], v[236:239]
    v_lshlrev_b32 v18, 16, v98
    v_xor_b32 v31, v31, v33
    v_mfma_f32_16x16x32_bf16 v[232:235], a[120:123], v[88:91], v[232:235]
    buffer_load_dwordx4 a[12:15], v9, s[12:15], s40 offen offset:2048 sc1
    v_and_b32 v19, 0xffff0000, v98
    v_mfma_f32_16x16x32_bf16 v[232:235], a[124:127], v[104:107], v[232:235]
    v_lshl_add_u32 v31, v31, 5, v30
    v_add_f32 v14, v14, v18
    v_mfma_f32_16x16x32_bf16 v[228:231], a[120:123], v[84:87], v[228:231]
    v_add_f32 v15, v15, v19
    ds_read_b64_tr_b16 v[44:45], v31
    v_mfma_f32_16x16x32_bf16 v[228:231], a[124:127], v[100:103], v[228:231]
    buffer_load_dwordx4 a[48:51], v9, s[12:15], s40 offen offset:3072 sc1
    v_fmac_f32 v16, v18, v18
    v_mfma_f32_16x16x32_bf16 v[224:227], a[120:123], v[80:83], v[224:227]
    v_fmac_f32 v17, v19, v19
    v_lshlrev_b32 v18, 16, v99
    v_mfma_f32_16x16x32_bf16 v[224:227], a[124:127], v[96:99], v[224:227]
    s_add_u32 s39, s28, 3
    s_and_b32 s39, s39, 7
    s_lshl_b32 s39, s39, 7
    s_add_u32 s39, s39, s43
    s_mov_b32 m0, s38
    s_add_u32 s38, s38, 4096
    s_waitcnt vmcnt(30)
    v_mfma_f32_16x16x32_bf16 v[240:243], a[128:131], v[80:83], v[240:243]
    v_and_b32 v19, 0xffff0000, v99
    buffer_load_dwordx4 v32, s[52:55], s39 offen lds
    v_mfma_f32_16x16x32_bf16 v[240:243], a[132:135], v[96:99], v[240:243]
    v_add_f32 v14, v14, v18
    v_mfma_f32_16x16x32_bf16 v[244:247], a[128:131], v[84:87], v[244:247]
    v_add_f32 v15, v15, v19
    v_mfma_f32_16x16x32_bf16 v[244:247], a[132:135], v[100:103], v[244:247]
    s_add_u32 s39, s39, 36864
    s_mov_b32 m0, s38
    s_add_u32 s38, s38, 4096
    v_fmac_f32 v16, v18, v18
    v_mfma_f32_16x16x32_bf16 v[248:251], a[128:131], v[88:91], v[248:251]
    buffer_load_dwordx4 v32, s[52:55], s39 offen lds
    v_fmac_f32 v17, v19, v19
    v_mfma_f32_16x16x32_bf16 v[248:251], a[132:135], v[104:107], v[248:251]
    v_mfma_f32_16x16x32_bf16 v[252:255], a[128:131], v[92:95], v[252:255]
    v_mfma_f32_16x16x32_bf16 v[252:255], a[132:135], v[108:111], v[252:255]
    s_waitcnt lgkmcnt(0)
    s_waitcnt vmcnt(30)
    v_mfma_f32_16x16x32_bf16 v[112:115], a[136:139], v[48:51], v[112:115]
    v_lshlrev_b32 v18, 16, v48
    v_and_b32 v19, 0xffff0000, v48
    v_mfma_f32_16x16x32_bf16 v[112:115], a[140:143], v[64:67], v[112:115]
    s_add_u32 s40, s40, 4096
    buffer_load_dwordx4 a[16:19], v9, s[12:15], s40 offen offset:0 sc1
    v_add_f32 v14, v14, v18
    v_mfma_f32_16x16x32_bf16 v[116:119], a[136:139], v[52:55], v[116:119]
    v_add_f32 v15, v15, v19
    v_fmac_f32 v16, v18, v18
    v_mfma_f32_16x16x32_bf16 v[116:119], a[140:143], v[68:71], v[116:119]
    v_fmac_f32 v17, v19, v19
    v_lshlrev_b32 v18, 16, v49
    v_mfma_f32_16x16x32_bf16 v[120:123], a[136:139], v[56:59], v[120:123]
    v_and_b32 v19, 0xffff0000, v49
    v_add_f32 v14, v14, v18
    v_mfma_f32_16x16x32_bf16 v[120:123], a[140:143], v[72:75], v[120:123]
    buffer_load_dwordx4 a[52:55], v9, s[12:15], s40 offen offset:1024 sc1
    v_add_f32 v15, v15, v19
    v_mfma_f32_16x16x32_bf16 v[124:127], a[136:139], v[60:63], v[124:127]
    v_fmac_f32 v16, v18, v18
    v_fmac_f32 v17, v19, v19
    v_mfma_f32_16x16x32_bf16 v[124:127], a[140:143], v[76:79], v[124:127]
    v_lshlrev_b32 v18, 16, v50
    s_waitcnt vmcnt(30)
    v_mfma_f32_16x16x32_bf16 v[140:143], a[144:147], v[60:63], v[140:143]
    v_and_b32 v19, 0xffff0000, v50
    v_add_f32 v14, v14, v18
    v_mfma_f32_16x16x32_bf16 v[140:143], a[148:151], v[76:79], v[140:143]
    v_add_f32 v15, v15, v19
    buffer_load_dwordx4 a[20:23], v9, s[12:15], s40 offen offset:2048 sc1
    v_mfma_f32_16x16x32_bf16 v[136:139], a[144:147], v[56:59], v[136:139]
    v_fmac_f32 v16, v18, v18
    v_fmac_f32 v17, v19, v19
    v_mfma_f32_16x16x32_bf16 v[136:139], a[148:151], v[72:75], v[136:139]
    v_lshlrev_b32 v18, 16, v51
    v_and_b32 v19, 0xffff0000, v51
    v_mfma_f32_16x16x32_bf16 v[132:135], a[144:147], v[52:55], v[132:135]
    v_add_f32 v14, v14, v18
    v_add_f32 v15, v15, v19
    v_mfma_f32_16x16x32_bf16 v[132:135], a[148:151], v[68:71], v[132:135]
    v_fmac_f32 v16, v18, v18
    v_fmac_f32 v17, v19, v19
    v_mfma_f32_16x16x32_bf16 v[128:131], a[144:147], v[48:51], v[128:131]
    buffer_load_dwordx4 a[56:59], v9, s[12:15], s40 offen offset:3072 sc1
    v_lshlrev_b32 v18, 16, v64
    v_mfma_f32_16x16x32_bf16 v[128:131], a[148:151], v[64:67], v[128:131]
    v_and_b32 v19, 0xffff0000, v64
    s_waitcnt vmcnt(30)
    v_mfma_f32_16x16x32_bf16 v[144:147], a[152:155], v[48:51], v[144:147]
    v_add_f32 v14, v14, v18
    v_add_f32 v15, v15, v19
    v_mfma_f32_16x16x32_bf16 v[144:147], a[156:159], v[64:67], v[144:147]
    v_fmac_f32 v16, v18, v18
    v_fmac_f32 v17, v19, v19
    v_mfma_f32_16x16x32_bf16 v[148:151], a[152:155], v[52:55], v[148:151]
    v_lshlrev_b32 v18, 16, v65
    s_add_u32 s40, s40, 4096
    buffer_load_dwordx4 a[24:27], v9, s[12:15], s40 offen offset:0 sc1
    v_mfma_f32_16x16x32_bf16 v[148:151], a[156:159], v[68:71], v[148:151]
    v_and_b32 v19, 0xffff0000, v65
    v_add_f32 v14, v14, v18
    v_mfma_f32_16x16x32_bf16 v[152:155], a[152:155], v[56:59], v[152:155]
    v_add_f32 v15, v15, v19
    v_fmac_f32 v16, v18, v18
    v_mfma_f32_16x16x32_bf16 v[152:155], a[156:159], v[72:75], v[152:155]
    v_fmac_f32 v17, v19, v19
    v_lshlrev_b32 v18, 16, v66
    v_mfma_f32_16x16x32_bf16 v[156:159], a[152:155], v[60:63], v[156:159]
    v_and_b32 v19, 0xffff0000, v66
    v_add_f32 v14, v14, v18
    v_mfma_f32_16x16x32_bf16 v[156:159], a[156:159], v[76:79], v[156:159]
    v_add_f32 v15, v15, v19
    s_waitcnt vmcnt(29)
    v_mfma_f32_16x16x32_bf16 v[172:175], a[160:163], v[60:63], v[172:175]
    buffer_load_dwordx4 a[60:63], v9, s[12:15], s40 offen offset:1024 sc1
    v_fmac_f32 v16, v18, v18
    v_mfma_f32_16x16x32_bf16 v[172:175], a[164:167], v[76:79], v[172:175]
    v_fmac_f32 v17, v19, v19
    v_lshlrev_b32 v18, 16, v67
    v_mfma_f32_16x16x32_bf16 v[168:171], a[160:163], v[56:59], v[168:171]
    v_and_b32 v19, 0xffff0000, v67
    v_add_f32 v14, v14, v18
    v_mfma_f32_16x16x32_bf16 v[168:171], a[164:167], v[72:75], v[168:171]
    v_add_f32 v15, v15, v19
    v_fmac_f32 v16, v18, v18
    v_mfma_f32_16x16x32_bf16 v[164:167], a[160:163], v[52:55], v[164:167]
    s_add_u32 s40, s40, 4096
    buffer_load_dwordx4 a[28:31], v9, s[12:15], s40 offen offset:0 sc1
    v_fmac_f32 v17, v19, v19
    v_mfma_f32_16x16x32_bf16 v[164:167], a[164:167], v[68:71], v[164:167]
    v_add_f32 v14, v14, v15
    v_add_f32 v15, v16, v17
    v_mfma_f32_16x16x32_bf16 v[160:163], a[160:163], v[48:51], v[160:163]
    v_mov_b32 v16, v14
    v_mov_b32 v17, v15
    v_mfma_f32_16x16x32_bf16 v[160:163], a[164:167], v[64:67], v[160:163]
    s_nop 0
    s_waitcnt vmcnt(29)
    v_mfma_f32_16x16x32_bf16 v[176:179], a[168:171], v[48:51], v[176:179]
    v_permlane16_swap_b32 v14, v16
    buffer_load_dwordx4 a[64:67], v9, s[12:15], s40 offen offset:1024 sc1
    v_mfma_f32_16x16x32_bf16 v[176:179], a[172:175], v[64:67], v[176:179]
    v_permlane16_swap_b32 v15, v17
    v_add_f32 v14, v14, v16
    v_mfma_f32_16x16x32_bf16 v[180:183], a[168:171], v[52:55], v[180:183]
    v_add_f32 v15, v15, v17
    v_mov_b32 v16, v14
    v_mfma_f32_16x16x32_bf16 v[180:183], a[172:175], v[68:71], v[180:183]
    v_mov_b32 v17, v15
    s_nop 0
    v_mfma_f32_16x16x32_bf16 v[184:187], a[168:171], v[56:59], v[184:187]
    buffer_load_dwordx4 a[32:35], v9, s[12:15], s40 offen offset:2048 sc1
    v_permlane32_swap_b32 v14, v16
    v_mfma_f32_16x16x32_bf16 v[184:187], a[172:175], v[72:75], v[184:187]
    v_permlane32_swap_b32 v15, v17
    v_add_f32 v14, v14, v16
    v_mfma_f32_16x16x32_bf16 v[188:191], a[168:171], v[60:63], v[188:191]
    v_add_f32 v15, v15, v17
    v_mfma_f32_16x16x32_bf16 v[188:191], a[172:175], v[76:79], v[188:191]
    v_mul_f32 v14, 0x3ae38e39, v14
    s_waitcnt vmcnt(29)
    v_mfma_f32_16x16x32_bf16 v[204:207], a[176:179], v[60:63], v[204:207]
    v_mul_f32 v15, 0x3ae38e39, v15
    buffer_load_dwordx4 a[68:71], v9, s[12:15], s40 offen offset:3072 sc1
    v_mfma_f32_16x16x32_bf16 v[204:207], a[180:183], v[76:79], v[204:207]
    v_fma_f32 v15, -v14, v14, v15
    v_max_f32 v15, 0, v15
    v_mfma_f32_16x16x32_bf16 v[200:203], a[176:179], v[56:59], v[200:203]
    v_cvt_pk_bf16_f32 v14, v14, v15
    v_and_b32 v15, 0xffff0000, v14
    v_mfma_f32_16x16x32_bf16 v[200:203], a[180:183], v[72:75], v[200:203]
    v_add_f32 v15, 0x3727c5ac, v15
    v_mfma_f32_16x16x32_bf16 v[196:199], a[176:179], v[52:55], v[196:199]
    v_cvt_pk_bf16_f32 v15, v15, v15
    v_and_b32 v15, 0xffff0000, v15
    v_mfma_f32_16x16x32_bf16 v[196:199], a[180:183], v[68:71], v[196:199]
    s_add_u32 s40, s40, 4096
    buffer_load_dwordx4 a[216:219], v9, s[12:15], s40 offen offset:0 sc1
    v_sqrt_f32 v15, v15
    v_mfma_f32_16x16x32_bf16 v[192:195], a[176:179], v[48:51], v[192:195]
    s_nop 0
    v_mfma_f32_16x16x32_bf16 v[192:195], a[180:183], v[64:67], v[192:195]
    v_cvt_pk_bf16_f32 v15, v15, v15
    s_waitcnt vmcnt(27)
    v_mfma_f32_16x16x32_bf16 v[208:211], a[184:187], v[48:51], v[208:211]
    v_and_b32 v15, 0xffff0000, v15
    v_lshlrev_b32 v14, 16, v14
    v_mfma_f32_16x16x32_bf16 v[208:211], a[188:191], v[64:67], v[208:211]
    buffer_load_dwordx4 a[220:223], v9, s[12:15], s40 offen offset:1024 sc1
    v_and_b32 v7, 15, v2
    v_mfma_f32_16x16x32_bf16 v[212:215], a[184:187], v[52:55], v[212:215]
    v_lshlrev_b32 v7, 2, v7
    v_add_u32 v7, 155648, v7
    v_mfma_f32_16x16x32_bf16 v[212:215], a[188:191], v[68:71], v[212:215]
    s_lshl_b32 s35, s30, 6
    v_add_u32 v8, s35, v7
    v_mfma_f32_16x16x32_bf16 v[216:219], a[184:187], v[56:59], v[216:219]
    ds_write_b32 v8, v14
    v_mfma_f32_16x16x32_bf16 v[216:219], a[188:191], v[72:75], v[216:219]
    ds_write_b32 v8, v15 offset:256
    v_mfma_f32_16x16x32_bf16 v[220:223], a[184:187], v[60:63], v[220:223]
    buffer_load_dwordx4 a[224:227], v9, s[12:15], s40 offen offset:2048 sc1
    v_and_b32 v4, 48, v2
    v_mfma_f32_16x16x32_bf16 v[220:223], a[188:191], v[76:79], v[220:223]
    v_add_u32 v4, s36, v4
    s_waitcnt vmcnt(27)
    v_mfma_f32_16x16x32_bf16 v[236:239], a[192:195], v[60:63], v[236:239]
    v_lshl_add_u32 v16, v33, 6, v7
    v_xor_b32 v29, 64, v8
    v_mfma_f32_16x16x32_bf16 v[236:239], a[196:199], v[76:79], v[236:239]
    v_xor_b32 v30, 128, v8
    v_xor_b32 v31, 192, v8
    v_mfma_f32_16x16x32_bf16 v[232:235], a[192:195], v[56:59], v[232:235]
    buffer_load_dwordx4 a[228:231], v9, s[12:15], s40 offen offset:3072 sc1
    s_waitcnt lgkmcnt(0)
    v_mfma_f32_16x16x32_bf16 v[232:235], a[196:199], v[72:75], v[232:235]
    s_barrier
    ds_read_b32 v20, v8
    v_mfma_f32_16x16x32_bf16 v[228:231], a[192:195], v[52:55], v[228:231]
    ds_read_b32 v21, v29
    v_mfma_f32_16x16x32_bf16 v[228:231], a[196:199], v[68:71], v[228:231]
    ds_read_b32 v22, v30
    ds_read_b32 v23, v31
    v_mfma_f32_16x16x32_bf16 v[224:227], a[192:195], v[48:51], v[224:227]
    ds_read_b32 v24, v7 offset:256
    v_mfma_f32_16x16x32_bf16 v[224:227], a[196:199], v[64:67], v[224:227]
    s_add_u32 s40, s40, 4096
    buffer_load_dwordx4 a[232:235], v9, s[12:15], s40 offen offset:0 sc1
    s_waitcnt vmcnt(27)
    v_mfma_f32_16x16x32_bf16 v[240:243], a[200:203], v[48:51], v[240:243]
    ds_read_b32 v25, v7 offset:320
    ds_read_b32 v26, v7 offset:384
    v_mfma_f32_16x16x32_bf16 v[240:243], a[204:207], v[64:67], v[240:243]
    ds_read_b32 v27, v7 offset:448
    ds_read_b32 v17, v16 offset:256
    v_mfma_f32_16x16x32_bf16 v[244:247], a[200:203], v[52:55], v[244:247]
    v_mfma_f32_16x16x32_bf16 v[244:247], a[204:207], v[68:71], v[244:247]
    buffer_load_dwordx4 a[236:239], v9, s[12:15], s40 offen offset:1024 sc1
    v_mfma_f32_16x16x32_bf16 v[248:251], a[200:203], v[56:59], v[248:251]
    v_mfma_f32_16x16x32_bf16 v[248:251], a[204:207], v[72:75], v[248:251]
    v_mfma_f32_16x16x32_bf16 v[252:255], a[200:203], v[60:63], v[252:255]
    v_mfma_f32_16x16x32_bf16 v[252:255], a[204:207], v[76:79], v[252:255]
    ds_read_b128 v[76:79], v4 offset:0
    ds_read_b128 v[80:83], v4 offset:64
    ds_read_b128 v[84:87], v4 offset:128
    ds_read_b128 v[88:91], v4 offset:192
    ds_read_b128 v[92:95], v4 offset:256
    ds_read_b128 v[96:99], v4 offset:320
    ds_read_b128 v[100:103], v4 offset:384
    ds_read_b128 v[104:107], v4 offset:448
    ds_read_b128 v[108:111], v4 offset:512
    s_lshl_b32 s35, s30, 14
    s_add_u32 s35, s35, 0
    s_lshl_b32 s36, s30, 10
    s_add_u32 s35, s35, s36
    v_add_u32 v16, s35, v9
    s_lshr_b32 s36, s30, 1
    s_add_u32 s36, s36, 16
    s_lshl_b32 s37, s30, 2
    s_sub_u32 s36, s36, s37
    s_lshl_b32 s36, s36, 12
    s_and_b32 s37, s30, 1
    s_lshl_b32 s37, s37, 3
    s_add_u32 s36, s36, s37
    v_xor_b32 v28, 0, v16
    v_add_u32 v10, s36, v28
    v_xor_b32 v29, 1024, v16
    v_add_u32 v11, s36, v29
    v_xor_b32 v30, 2048, v16
    v_add_u32 v12, s36, v30
    v_xor_b32 v31, 3072, v16
    v_add_u32 v13, s36, v31
    s_waitcnt lgkmcnt(0)
.p2align 3
    v_pk_fma_f32 v[112:113], v[76:77], v[20:21], v[112:113] op_sel:[0,0,0] op_sel_hi:[1,0,1] neg_lo:[0,1,0] neg_hi:[0,1,0]
    v_pk_fma_f32 v[114:115], v[78:79], v[20:21], v[114:115] op_sel:[0,0,0] op_sel_hi:[1,0,1] neg_lo:[0,1,0] neg_hi:[0,1,0]
    v_cvt_pk_bf16_f32 v48, v112, v113
    v_cvt_pk_bf16_f32 v49, v114, v115
    v_pk_max_i16 v48, v48, 0
    v_pk_max_i16 v49, v49, 0
    v_pk_fma_f32 v[128:129], v[80:81], v[20:21], v[128:129] op_sel:[0,0,0] op_sel_hi:[1,0,1] neg_lo:[0,1,0] neg_hi:[0,1,0]
    v_pk_fma_f32 v[130:131], v[82:83], v[20:21], v[130:131] op_sel:[0,0,0] op_sel_hi:[1,0,1] neg_lo:[0,1,0] neg_hi:[0,1,0]
    v_cvt_pk_bf16_f32 v50, v128, v129
    v_cvt_pk_bf16_f32 v51, v130, v131
    v_pk_max_i16 v50, v50, 0
    v_pk_max_i16 v51, v51, 0
    ds_write_b128 v28, v[48:51] offset:0
    s_add_u32 s39, s28, 4
    s_and_b32 s39, s39, 7
    s_lshl_b32 s39, s39, 7
    s_add_u32 s39, s39, s43
    s_mov_b32 m0, s38
    s_add_u32 s38, s38, 4096
    buffer_load_dwordx4 v32, s[52:55], s39 offen lds
    s_add_u32 s39, s39, 36864
    s_mov_b32 m0, s38
    s_add_u32 s38, s38, 4096
    buffer_load_dwordx4 v32, s[52:55], s39 offen lds
    v_pk_fma_f32 v[116:117], v[76:77], v[20:21], v[116:117] op_sel:[0,1,0] op_sel_hi:[1,1,1] neg_lo:[0,1,0] neg_hi:[0,1,0]
    v_pk_fma_f32 v[118:119], v[78:79], v[20:21], v[118:119] op_sel:[0,1,0] op_sel_hi:[1,1,1] neg_lo:[0,1,0] neg_hi:[0,1,0]
    v_cvt_pk_bf16_f32 v52, v116, v117
    v_cvt_pk_bf16_f32 v53, v118, v119
    v_pk_max_i16 v52, v52, 0
    v_pk_max_i16 v53, v53, 0
    v_pk_fma_f32 v[132:133], v[80:81], v[20:21], v[132:133] op_sel:[0,1,0] op_sel_hi:[1,1,1] neg_lo:[0,1,0] neg_hi:[0,1,0]
    v_pk_fma_f32 v[134:135], v[82:83], v[20:21], v[134:135] op_sel:[0,1,0] op_sel_hi:[1,1,1] neg_lo:[0,1,0] neg_hi:[0,1,0]
    v_cvt_pk_bf16_f32 v54, v132, v133
    v_cvt_pk_bf16_f32 v55, v134, v135
    v_pk_max_i16 v54, v54, 0
    v_pk_max_i16 v55, v55, 0
    ds_write_b128 v29, v[52:55] offset:0
    s_add_u32 s39, s28, 5
    s_and_b32 s39, s39, 7
    s_lshl_b32 s39, s39, 7
    s_add_u32 s39, s39, s43
    s_mov_b32 m0, s38
    s_add_u32 s38, s38, 4096
    buffer_load_dwordx4 v32, s[52:55], s39 offen lds
    s_add_u32 s39, s39, 36864
    s_mov_b32 m0, s38
    s_add_u32 s38, s38, 4096
    buffer_load_dwordx4 v32, s[52:55], s39 offen lds
    v_pk_fma_f32 v[120:121], v[76:77], v[22:23], v[120:121] op_sel:[0,0,0] op_sel_hi:[1,0,1] neg_lo:[0,1,0] neg_hi:[0,1,0]
    v_pk_fma_f32 v[122:123], v[78:79], v[22:23], v[122:123] op_sel:[0,0,0] op_sel_hi:[1,0,1] neg_lo:[0,1,0] neg_hi:[0,1,0]
    v_cvt_pk_bf16_f32 v56, v120, v121
    v_cvt_pk_bf16_f32 v57, v122, v123
    v_pk_max_i16 v56, v56, 0
    v_pk_max_i16 v57, v57, 0
    v_pk_fma_f32 v[136:137], v[80:81], v[22:23], v[136:137] op_sel:[0,0,0] op_sel_hi:[1,0,1] neg_lo:[0,1,0] neg_hi:[0,1,0]
    v_pk_fma_f32 v[138:139], v[82:83], v[22:23], v[138:139] op_sel:[0,0,0] op_sel_hi:[1,0,1] neg_lo:[0,1,0] neg_hi:[0,1,0]
    v_cvt_pk_bf16_f32 v58, v136, v137
    v_cvt_pk_bf16_f32 v59, v138, v139
    v_pk_max_i16 v58, v58, 0
    v_pk_max_i16 v59, v59, 0
    ds_write_b128 v30, v[56:59] offset:0
    s_add_u32 s39, s28, 6
    s_and_b32 s39, s39, 7
    s_lshl_b32 s39, s39, 7
    s_add_u32 s39, s39, s43
    s_mov_b32 m0, s38
    s_add_u32 s38, s38, 4096
    buffer_load_dwordx4 v32, s[52:55], s39 offen lds
    v_pk_fma_f32 v[124:125], v[76:77], v[22:23], v[124:125] op_sel:[0,1,0] op_sel_hi:[1,1,1] neg_lo:[0,1,0] neg_hi:[0,1,0]
    v_pk_fma_f32 v[126:127], v[78:79], v[22:23], v[126:127] op_sel:[0,1,0] op_sel_hi:[1,1,1] neg_lo:[0,1,0] neg_hi:[0,1,0]
    v_cvt_pk_bf16_f32 v60, v124, v125
    v_cvt_pk_bf16_f32 v61, v126, v127
    v_pk_max_i16 v60, v60, 0
    v_pk_max_i16 v61, v61, 0
    v_pk_fma_f32 v[140:141], v[80:81], v[22:23], v[140:141] op_sel:[0,1,0] op_sel_hi:[1,1,1] neg_lo:[0,1,0] neg_hi:[0,1,0]
    v_pk_fma_f32 v[142:143], v[82:83], v[22:23], v[142:143] op_sel:[0,1,0] op_sel_hi:[1,1,1] neg_lo:[0,1,0] neg_hi:[0,1,0]
    v_cvt_pk_bf16_f32 v62, v140, v141
    v_cvt_pk_bf16_f32 v63, v142, v143
    v_pk_max_i16 v62, v62, 0
    v_pk_max_i16 v63, v63, 0
    ds_write_b128 v31, v[60:63] offset:0
    s_add_u32 s39, s39, 36864
    s_mov_b32 m0, s38
    s_add_u32 s38, s38, 4096
    buffer_load_dwordx4 v32, s[52:55], s39 offen lds
    s_add_u32 s39, s28, 7
    s_and_b32 s39, s39, 7
    s_lshl_b32 s39, s39, 7
    s_add_u32 s39, s39, s43
    s_mov_b32 m0, s38
    s_add_u32 s38, s38, 4096
    buffer_load_dwordx4 v32, s[52:55], s39 offen lds
    v_pk_fma_f32 v[144:145], v[84:85], v[20:21], v[144:145] op_sel:[0,0,0] op_sel_hi:[1,0,1] neg_lo:[0,1,0] neg_hi:[0,1,0]
    v_pk_fma_f32 v[146:147], v[86:87], v[20:21], v[146:147] op_sel:[0,0,0] op_sel_hi:[1,0,1] neg_lo:[0,1,0] neg_hi:[0,1,0]
    v_cvt_pk_bf16_f32 v64, v144, v145
    v_cvt_pk_bf16_f32 v65, v146, v147
    v_pk_max_i16 v64, v64, 0
    v_pk_max_i16 v65, v65, 0
    v_pk_fma_f32 v[160:161], v[88:89], v[20:21], v[160:161] op_sel:[0,0,0] op_sel_hi:[1,0,1] neg_lo:[0,1,0] neg_hi:[0,1,0]
    v_pk_fma_f32 v[162:163], v[90:91], v[20:21], v[162:163] op_sel:[0,0,0] op_sel_hi:[1,0,1] neg_lo:[0,1,0] neg_hi:[0,1,0]
    v_cvt_pk_bf16_f32 v66, v160, v161
    v_cvt_pk_bf16_f32 v67, v162, v163
    v_pk_max_i16 v66, v66, 0
    v_pk_max_i16 v67, v67, 0
    ds_write_b128 v28, v[64:67] offset:4096
    s_add_u32 s39, s39, 36864
    s_mov_b32 m0, s38
    s_add_u32 s38, s38, 4096
    buffer_load_dwordx4 v32, s[52:55], s39 offen lds
    s_add_u32 s39, s28, 8
    s_and_b32 s39, s39, 7
    s_lshl_b32 s39, s39, 7
    s_add_u32 s39, s39, s43
    s_mov_b32 m0, s38
    s_add_u32 s38, s38, 4096
    buffer_load_dwordx4 v32, s[52:55], s39 offen lds
    v_pk_fma_f32 v[148:149], v[84:85], v[20:21], v[148:149] op_sel:[0,1,0] op_sel_hi:[1,1,1] neg_lo:[0,1,0] neg_hi:[0,1,0]
    v_pk_fma_f32 v[150:151], v[86:87], v[20:21], v[150:151] op_sel:[0,1,0] op_sel_hi:[1,1,1] neg_lo:[0,1,0] neg_hi:[0,1,0]
    v_cvt_pk_bf16_f32 v68, v148, v149
    v_cvt_pk_bf16_f32 v69, v150, v151
    v_pk_max_i16 v68, v68, 0
    v_pk_max_i16 v69, v69, 0
    v_pk_fma_f32 v[164:165], v[88:89], v[20:21], v[164:165] op_sel:[0,1,0] op_sel_hi:[1,1,1] neg_lo:[0,1,0] neg_hi:[0,1,0]
    v_pk_fma_f32 v[166:167], v[90:91], v[20:21], v[166:167] op_sel:[0,1,0] op_sel_hi:[1,1,1] neg_lo:[0,1,0] neg_hi:[0,1,0]
    v_cvt_pk_bf16_f32 v70, v164, v165
    v_cvt_pk_bf16_f32 v71, v166, v167
    v_pk_max_i16 v70, v70, 0
    v_pk_max_i16 v71, v71, 0
    ds_write_b128 v29, v[68:71] offset:4096
    s_add_u32 s39, s39, 36864
    s_mov_b32 m0, s38
    s_add_u32 s38, s38, 4096
    buffer_load_dwordx4 v32, s[52:55], s39 offen lds
    v_pk_fma_f32 v[152:153], v[84:85], v[22:23], v[152:153] op_sel:[0,0,0] op_sel_hi:[1,0,1] neg_lo:[0,1,0] neg_hi:[0,1,0]
    v_pk_fma_f32 v[154:155], v[86:87], v[22:23], v[154:155] op_sel:[0,0,0] op_sel_hi:[1,0,1] neg_lo:[0,1,0] neg_hi:[0,1,0]
    v_cvt_pk_bf16_f32 v48, v152, v153
    v_cvt_pk_bf16_f32 v49, v154, v155
    v_pk_max_i16 v48, v48, 0
    v_pk_max_i16 v49, v49, 0
    v_pk_fma_f32 v[168:169], v[88:89], v[22:23], v[168:169] op_sel:[0,0,0] op_sel_hi:[1,0,1] neg_lo:[0,1,0] neg_hi:[0,1,0]
    v_pk_fma_f32 v[170:171], v[90:91], v[22:23], v[170:171] op_sel:[0,0,0] op_sel_hi:[1,0,1] neg_lo:[0,1,0] neg_hi:[0,1,0]
    v_cvt_pk_bf16_f32 v50, v168, v169
    v_cvt_pk_bf16_f32 v51, v170, v171
    v_pk_max_i16 v50, v50, 0
    v_pk_max_i16 v51, v51, 0
    ds_write_b128 v30, v[48:51] offset:4096
    buffer_load_dwordx4 a[240:243], v9, s[12:15], s40 offen offset:2048 sc1
    buffer_load_dwordx4 a[244:247], v9, s[12:15], s40 offen offset:3072 sc1
    v_pk_fma_f32 v[156:157], v[84:85], v[22:23], v[156:157] op_sel:[0,1,0] op_sel_hi:[1,1,1] neg_lo:[0,1,0] neg_hi:[0,1,0]
    v_pk_fma_f32 v[158:159], v[86:87], v[22:23], v[158:159] op_sel:[0,1,0] op_sel_hi:[1,1,1] neg_lo:[0,1,0] neg_hi:[0,1,0]
    v_cvt_pk_bf16_f32 v52, v156, v157
    v_cvt_pk_bf16_f32 v53, v158, v159
    v_pk_max_i16 v52, v52, 0
    v_pk_max_i16 v53, v53, 0
    v_pk_fma_f32 v[172:173], v[88:89], v[22:23], v[172:173] op_sel:[0,1,0] op_sel_hi:[1,1,1] neg_lo:[0,1,0] neg_hi:[0,1,0]
    v_pk_fma_f32 v[174:175], v[90:91], v[22:23], v[174:175] op_sel:[0,1,0] op_sel_hi:[1,1,1] neg_lo:[0,1,0] neg_hi:[0,1,0]
    v_cvt_pk_bf16_f32 v54, v172, v173
    v_cvt_pk_bf16_f32 v55, v174, v175
    v_pk_max_i16 v54, v54, 0
    v_pk_max_i16 v55, v55, 0
    ds_write_b128 v31, v[52:55] offset:4096
    s_add_u32 s40, s40, 4096
    buffer_load_dwordx4 a[248:251], v9, s[12:15], s40 offen offset:0 sc1
    v_pk_fma_f32 v[176:177], v[92:93], v[20:21], v[176:177] op_sel:[0,0,0] op_sel_hi:[1,0,1] neg_lo:[0,1,0] neg_hi:[0,1,0]
    v_pk_fma_f32 v[178:179], v[94:95], v[20:21], v[178:179] op_sel:[0,0,0] op_sel_hi:[1,0,1] neg_lo:[0,1,0] neg_hi:[0,1,0]
    v_cvt_pk_bf16_f32 v56, v176, v177
    v_cvt_pk_bf16_f32 v57, v178, v179
    v_pk_max_i16 v56, v56, 0
    v_pk_max_i16 v57, v57, 0
    v_pk_fma_f32 v[192:193], v[96:97], v[20:21], v[192:193] op_sel:[0,0,0] op_sel_hi:[1,0,1] neg_lo:[0,1,0] neg_hi:[0,1,0]
    v_pk_fma_f32 v[194:195], v[98:99], v[20:21], v[194:195] op_sel:[0,0,0] op_sel_hi:[1,0,1] neg_lo:[0,1,0] neg_hi:[0,1,0]
    v_cvt_pk_bf16_f32 v58, v192, v193
    v_cvt_pk_bf16_f32 v59, v194, v195
    v_pk_max_i16 v58, v58, 0
    v_pk_max_i16 v59, v59, 0
    ds_write_b128 v28, v[56:59] offset:8192
    buffer_load_dwordx4 a[252:255], v9, s[12:15], s40 offen offset:1024 sc1
    buffer_load_dwordx4 a[72:75], v9, s[12:15], s40 offen offset:2048 sc1
    v_pk_fma_f32 v[180:181], v[92:93], v[20:21], v[180:181] op_sel:[0,1,0] op_sel_hi:[1,1,1] neg_lo:[0,1,0] neg_hi:[0,1,0]
    v_pk_fma_f32 v[182:183], v[94:95], v[20:21], v[182:183] op_sel:[0,1,0] op_sel_hi:[1,1,1] neg_lo:[0,1,0] neg_hi:[0,1,0]
    v_cvt_pk_bf16_f32 v60, v180, v181
    v_cvt_pk_bf16_f32 v61, v182, v183
    v_pk_max_i16 v60, v60, 0
    v_pk_max_i16 v61, v61, 0
    v_pk_fma_f32 v[196:197], v[96:97], v[20:21], v[196:197] op_sel:[0,1,0] op_sel_hi:[1,1,1] neg_lo:[0,1,0] neg_hi:[0,1,0]
    v_pk_fma_f32 v[198:199], v[98:99], v[20:21], v[198:199] op_sel:[0,1,0] op_sel_hi:[1,1,1] neg_lo:[0,1,0] neg_hi:[0,1,0]
    v_cvt_pk_bf16_f32 v62, v196, v197
    v_cvt_pk_bf16_f32 v63, v198, v199
    v_pk_max_i16 v62, v62, 0
    v_pk_max_i16 v63, v63, 0
    ds_write_b128 v29, v[60:63] offset:8192
    buffer_load_dwordx4 a[76:79], v9, s[12:15], s40 offen offset:3072 sc1
    s_add_u32 s40, s40, 4096
    buffer_load_dwordx4 a[80:83], v9, s[12:15], s40 offen offset:2048 sc1
    v_pk_fma_f32 v[184:185], v[92:93], v[22:23], v[184:185] op_sel:[0,0,0] op_sel_hi:[1,0,1] neg_lo:[0,1,0] neg_hi:[0,1,0]
    v_pk_fma_f32 v[186:187], v[94:95], v[22:23], v[186:187] op_sel:[0,0,0] op_sel_hi:[1,0,1] neg_lo:[0,1,0] neg_hi:[0,1,0]
    v_cvt_pk_bf16_f32 v64, v184, v185
    v_cvt_pk_bf16_f32 v65, v186, v187
    v_pk_max_i16 v64, v64, 0
    v_pk_max_i16 v65, v65, 0
    v_pk_fma_f32 v[200:201], v[96:97], v[22:23], v[200:201] op_sel:[0,0,0] op_sel_hi:[1,0,1] neg_lo:[0,1,0] neg_hi:[0,1,0]
    v_pk_fma_f32 v[202:203], v[98:99], v[22:23], v[202:203] op_sel:[0,0,0] op_sel_hi:[1,0,1] neg_lo:[0,1,0] neg_hi:[0,1,0]
    v_cvt_pk_bf16_f32 v66, v200, v201
    v_cvt_pk_bf16_f32 v67, v202, v203
    v_pk_max_i16 v66, v66, 0
    v_pk_max_i16 v67, v67, 0
    ds_write_b128 v30, v[64:67] offset:8192
    buffer_load_dwordx4 a[84:87], v9, s[12:15], s40 offen offset:3072 sc1
    v_pk_fma_f32 v[188:189], v[92:93], v[22:23], v[188:189] op_sel:[0,1,0] op_sel_hi:[1,1,1] neg_lo:[0,1,0] neg_hi:[0,1,0]
    v_pk_fma_f32 v[190:191], v[94:95], v[22:23], v[190:191] op_sel:[0,1,0] op_sel_hi:[1,1,1] neg_lo:[0,1,0] neg_hi:[0,1,0]
    v_cvt_pk_bf16_f32 v68, v188, v189
    v_cvt_pk_bf16_f32 v69, v190, v191
    v_pk_max_i16 v68, v68, 0
    v_pk_max_i16 v69, v69, 0
    v_pk_fma_f32 v[204:205], v[96:97], v[22:23], v[204:205] op_sel:[0,1,0] op_sel_hi:[1,1,1] neg_lo:[0,1,0] neg_hi:[0,1,0]
    v_pk_fma_f32 v[206:207], v[98:99], v[22:23], v[206:207] op_sel:[0,1,0] op_sel_hi:[1,1,1] neg_lo:[0,1,0] neg_hi:[0,1,0]
    v_cvt_pk_bf16_f32 v70, v204, v205
    v_cvt_pk_bf16_f32 v71, v206, v207
    v_pk_max_i16 v70, v70, 0
    v_pk_max_i16 v71, v71, 0
    ds_write_b128 v31, v[68:71] offset:8192
    s_add_u32 s40, s40, 4096
    buffer_load_dwordx4 a[88:91], v9, s[12:15], s40 offen offset:0 sc1
    buffer_load_dwordx4 a[92:95], v9, s[12:15], s40 offen offset:1024 sc1
    v_pk_fma_f32 v[208:209], v[100:101], v[20:21], v[208:209] op_sel:[0,0,0] op_sel_hi:[1,0,1] neg_lo:[0,1,0] neg_hi:[0,1,0]
    v_pk_fma_f32 v[210:211], v[102:103], v[20:21], v[210:211] op_sel:[0,0,0] op_sel_hi:[1,0,1] neg_lo:[0,1,0] neg_hi:[0,1,0]
    v_cvt_pk_bf16_f32 v48, v208, v209
    v_cvt_pk_bf16_f32 v49, v210, v211
    v_pk_max_i16 v48, v48, 0
    v_pk_max_i16 v49, v49, 0
    v_pk_fma_f32 v[224:225], v[104:105], v[20:21], v[224:225] op_sel:[0,0,0] op_sel_hi:[1,0,1] neg_lo:[0,1,0] neg_hi:[0,1,0]
    v_pk_fma_f32 v[226:227], v[106:107], v[20:21], v[226:227] op_sel:[0,0,0] op_sel_hi:[1,0,1] neg_lo:[0,1,0] neg_hi:[0,1,0]
    v_cvt_pk_bf16_f32 v50, v224, v225
    v_cvt_pk_bf16_f32 v51, v226, v227
    v_pk_max_i16 v50, v50, 0
    v_pk_max_i16 v51, v51, 0
    ds_write_b128 v28, v[48:51] offset:12288
    buffer_load_dwordx4 a[96:99], v9, s[12:15], s40 offen offset:2048 sc1
    buffer_load_dwordx4 a[100:103], v9, s[12:15], s40 offen offset:3072 sc1
    v_pk_fma_f32 v[212:213], v[100:101], v[20:21], v[212:213] op_sel:[0,1,0] op_sel_hi:[1,1,1] neg_lo:[0,1,0] neg_hi:[0,1,0]
    v_pk_fma_f32 v[214:215], v[102:103], v[20:21], v[214:215] op_sel:[0,1,0] op_sel_hi:[1,1,1] neg_lo:[0,1,0] neg_hi:[0,1,0]
    v_cvt_pk_bf16_f32 v52, v212, v213
    v_cvt_pk_bf16_f32 v53, v214, v215
    v_pk_max_i16 v52, v52, 0
    v_pk_max_i16 v53, v53, 0
    v_pk_fma_f32 v[228:229], v[104:105], v[20:21], v[228:229] op_sel:[0,1,0] op_sel_hi:[1,1,1] neg_lo:[0,1,0] neg_hi:[0,1,0]
    v_pk_fma_f32 v[230:231], v[106:107], v[20:21], v[230:231] op_sel:[0,1,0] op_sel_hi:[1,1,1] neg_lo:[0,1,0] neg_hi:[0,1,0]
    v_cvt_pk_bf16_f32 v54, v228, v229
    v_cvt_pk_bf16_f32 v55, v230, v231
    v_pk_max_i16 v54, v54, 0
    v_pk_max_i16 v55, v55, 0
    ds_write_b128 v29, v[52:55] offset:12288
    s_add_u32 s40, s40, 4096
    buffer_load_dwordx4 a[104:107], v9, s[12:15], s40 offen offset:0 sc1
    v_pk_fma_f32 v[216:217], v[100:101], v[22:23], v[216:217] op_sel:[0,0,0] op_sel_hi:[1,0,1] neg_lo:[0,1,0] neg_hi:[0,1,0]
    v_pk_fma_f32 v[218:219], v[102:103], v[22:23], v[218:219] op_sel:[0,0,0] op_sel_hi:[1,0,1] neg_lo:[0,1,0] neg_hi:[0,1,0]
    v_cvt_pk_bf16_f32 v56, v216, v217
    v_cvt_pk_bf16_f32 v57, v218, v219
    v_pk_max_i16 v56, v56, 0
    v_pk_max_i16 v57, v57, 0
    v_pk_fma_f32 v[232:233], v[104:105], v[22:23], v[232:233] op_sel:[0,0,0] op_sel_hi:[1,0,1] neg_lo:[0,1,0] neg_hi:[0,1,0]
    v_pk_fma_f32 v[234:235], v[106:107], v[22:23], v[234:235] op_sel:[0,0,0] op_sel_hi:[1,0,1] neg_lo:[0,1,0] neg_hi:[0,1,0]
    v_cvt_pk_bf16_f32 v58, v232, v233
    v_cvt_pk_bf16_f32 v59, v234, v235
    v_pk_max_i16 v58, v58, 0
    v_pk_max_i16 v59, v59, 0
    ds_write_b128 v30, v[56:59] offset:12288
    buffer_load_dwordx4 a[108:111], v9, s[12:15], s40 offen offset:1024 sc1
L_pg7:
    s_cbranch_execz L_wret1
    s_nop 0
    buffer_load_dwordx4 a[112:115], v9, s[12:15], s40 offen offset:2048 sc1
    v_pk_fma_f32 v[220:221], v[100:101], v[22:23], v[220:221] op_sel:[0,1,0] op_sel_hi:[1,1,1] neg_lo:[0,1,0] neg_hi:[0,1,0]
    v_pk_fma_f32 v[222:223], v[102:103], v[22:23], v[222:223] op_sel:[0,1,0] op_sel_hi:[1,1,1] neg_lo:[0,1,0] neg_hi:[0,1,0]
    v_cvt_pk_bf16_f32 v60, v220, v221
    v_cvt_pk_bf16_f32 v61, v222, v223
    v_pk_max_i16 v60, v60, 0
    v_pk_max_i16 v61, v61, 0
    v_pk_fma_f32 v[236:237], v[104:105], v[22:23], v[236:237] op_sel:[0,1,0] op_sel_hi:[1,1,1] neg_lo:[0,1,0] neg_hi:[0,1,0]
    v_pk_fma_f32 v[238:239], v[106:107], v[22:23], v[238:239] op_sel:[0,1,0] op_sel_hi:[1,1,1] neg_lo:[0,1,0] neg_hi:[0,1,0]
    v_cvt_pk_bf16_f32 v62, v236, v237
    v_cvt_pk_bf16_f32 v63, v238, v239
    v_pk_max_i16 v62, v62, 0
    v_pk_max_i16 v63, v63, 0
    ds_write_b128 v31, v[60:63] offset:12288
    buffer_load_dwordx4 a[116:119], v9, s[12:15], s40 offen offset:3072 sc1
    v_pk_fma_f32 v[240:241], v[108:109], v[20:21], v[240:241] op_sel:[0,0,0] op_sel_hi:[1,0,1] neg_lo:[0,1,0] neg_hi:[0,1,0]
    v_pk_fma_f32 v[242:243], v[110:111], v[20:21], v[242:243] op_sel:[0,0,0] op_sel_hi:[1,0,1] neg_lo:[0,1,0] neg_hi:[0,1,0]
    v_cvt_pk_bf16_f32 v64, v240, v241
    v_cvt_pk_bf16_f32 v65, v242, v243
    v_pk_max_i16 v64, v64, 0
    v_pk_max_i16 v65, v65, 0
    ds_write_b64 v10, v[64:65]
    v_pk_fma_f32 v[244:245], v[108:109], v[20:21], v[244:245] op_sel:[0,1,0] op_sel_hi:[1,1,1] neg_lo:[0,1,0] neg_hi:[0,1,0]
    v_pk_fma_f32 v[246:247], v[110:111], v[20:21], v[246:247] op_sel:[0,1,0] op_sel_hi:[1,1,1] neg_lo:[0,1,0] neg_hi:[0,1,0]
    v_cvt_pk_bf16_f32 v68, v244, v245
    v_cvt_pk_bf16_f32 v69, v246, v247
    v_pk_max_i16 v68, v68, 0
    v_pk_max_i16 v69, v69, 0
    ds_write_b64 v11, v[68:69]
    v_pk_fma_f32 v[248:249], v[108:109], v[22:23], v[248:249] op_sel:[0,0,0] op_sel_hi:[1,0,1] neg_lo:[0,1,0] neg_hi:[0,1,0]
    v_pk_fma_f32 v[250:251], v[110:111], v[22:23], v[250:251] op_sel:[0,0,0] op_sel_hi:[1,0,1] neg_lo:[0,1,0] neg_hi:[0,1,0]
    v_cvt_pk_bf16_f32 v48, v248, v249
    v_cvt_pk_bf16_f32 v49, v250, v251
    v_pk_max_i16 v48, v48, 0
    v_pk_max_i16 v49, v49, 0
    ds_write_b64 v12, v[48:49]
    v_pk_fma_f32 v[252:253], v[108:109], v[22:23], v[252:253] op_sel:[0,1,0] op_sel_hi:[1,1,1] neg_lo:[0,1,0] neg_hi:[0,1,0]
    v_pk_fma_f32 v[254:255], v[110:111], v[22:23], v[254:255] op_sel:[0,1,0] op_sel_hi:[1,1,1] neg_lo:[0,1,0] neg_hi:[0,1,0]
    v_cvt_pk_bf16_f32 v52, v252, v253
    v_cvt_pk_bf16_f32 v53, v254, v255
    v_pk_max_i16 v52, v52, 0
    v_pk_max_i16 v53, v53, 0
    ds_write_b64 v13, v[52:53]
    s_waitcnt vmcnt(16)
    s_waitcnt lgkmcnt(0)
    v_add_u32 v10, 0, v9
    v_add_u32 v11, 36864, v9
    s_barrier
    ds_read_b128 a[120:123], v10 offset:0
    ds_read_b128 a[124:127], v10 offset:4096
    ds_read_b128 a[128:131], v10 offset:8192
    ds_read_b128 a[132:135], v10 offset:12288
    ds_read_b128 a[136:139], v10 offset:16384
    ds_read_b128 a[140:143], v10 offset:20480
    ds_read_b128 a[144:147], v10 offset:1024
    ds_read_b128 a[148:151], v10 offset:5120
    ds_read_b128 a[152:155], v10 offset:9216
    ds_read_b128 a[156:159], v10 offset:13312
    v_mov_b32 v94, v46
    v_mov_b32 v95, v33
    v_mov_b32 v16, v17
    v_lshlrev_b32 v64, 16, v36
    v_and_b32 v65, 0xffff0000, v36
    v_pk_mul_f32 v[64:65], v[64:65], v[24:25] op_sel:[0,0] op_sel_hi:[1,0]
    v_lshlrev_b32 v66, 16, v37
    v_and_b32 v67, 0xffff0000, v37
    v_pk_mul_f32 v[66:67], v[66:67], v[24:25] op_sel:[0,0] op_sel_hi:[1,0]
    v_lshlrev_b32 v68, 16, v38
    v_and_b32 v69, 0xffff0000, v38
    v_pk_mul_f32 v[68:69], v[68:69], v[24:25] op_sel:[0,1] op_sel_hi:[1,1]
    v_lshlrev_b32 v70, 16, v39
    v_and_b32 v71, 0xffff0000, v39
    v_pk_mul_f32 v[70:71], v[70:71], v[24:25] op_sel:[0,1] op_sel_hi:[1,1]
    v_lshlrev_b32 v72, 16, v40
    v_and_b32 v73, 0xffff0000, v40
    v_pk_mul_f32 v[72:73], v[72:73], v[26:27] op_sel:[0,0] op_sel_hi:[1,0]
    v_lshlrev_b32 v74, 16, v41
    v_and_b32 v75, 0xffff0000, v41
    v_pk_mul_f32 v[74:75], v[74:75], v[26:27] op_sel:[0,0] op_sel_hi:[1,0]
    v_lshlrev_b32 v76, 16, v42
    v_and_b32 v77, 0xffff0000, v42
    v_pk_mul_f32 v[76:77], v[76:77], v[26:27] op_sel:[0,1] op_sel_hi:[1,1]
    v_lshlrev_b32 v78, 16, v43
    v_and_b32 v79, 0xffff0000, v43
    v_pk_mul_f32 v[78:79], v[78:79], v[26:27] op_sel:[0,1] op_sel_hi:[1,1]
    v_lshlrev_b32 v80, 16, v44
    v_and_b32 v81, 0xffff0000, v44
    v_pk_mul_f32 v[80:81], v[80:81], v[16:17] op_sel:[0,0] op_sel_hi:[1,0]
    v_lshlrev_b32 v82, 16, v45
    v_and_b32 v83, 0xffff0000, v45
    v_pk_mul_f32 v[82:83], v[82:83], v[16:17] op_sel:[0,0] op_sel_hi:[1,0]
    s_waitcnt lgkmcnt(7)
    v_mfma_f32_16x16x32_bf16 v[48:51], a[208:211], a[120:123], 0
    ds_read_b128 a[160:163], v10 offset:17408
    s_add_u32 s40, s40, 4096
    buffer_load_dwordx4 a[164:167], v9, s[12:15], s40 offen offset:0 sc1
    v_mfma_f32_16x16x32_bf16 v[48:51], a[212:215], a[124:127], v[48:51]
    ds_read_b128 a[168:171], v10 offset:21504
    v_mfma_f32_16x16x32_bf16 v[48:51], a[0:3], a[128:131], v[48:51]
    ds_read_b128 a[172:175], v10 offset:2048
    s_waitcnt lgkmcnt(7)
    v_mfma_f32_16x16x32_bf16 v[48:51], a[36:39], a[132:135], v[48:51]
    ds_read_b128 a[176:179], v10 offset:6144
    v_mfma_f32_16x16x32_bf16 v[48:51], a[4:7], a[136:139], v[48:51]
    ds_read_b128 a[180:183], v10 offset:10240
    v_mfma_f32_16x16x32_bf16 v[48:51], a[40:43], a[140:143], v[48:51]
    ds_read_b128 a[184:187], v10 offset:14336
    s_waitcnt lgkmcnt(7)
    v_mfma_f32_16x16x32_bf16 v[52:55], a[208:211], a[144:147], 0
    ds_read_b128 a[188:191], v10 offset:18432
    buffer_load_dwordx4 a[192:195], v9, s[12:15], s40 offen offset:1024 sc1
    v_mfma_f32_16x16x32_bf16 v[52:55], a[212:215], a[148:151], v[52:55]
    ds_read_b128 a[196:199], v10 offset:22528
    v_mfma_f32_16x16x32_bf16 v[52:55], a[0:3], a[152:155], v[52:55]
    ds_read_b128 a[200:203], v10 offset:3072
    s_waitcnt lgkmcnt(7)
    v_mfma_f32_16x16x32_bf16 v[52:55], a[36:39], a[156:159], v[52:55]
    ds_read_b128 a[204:207], v10 offset:7168
    v_mfma_f32_16x16x32_bf16 v[52:55], a[4:7], a[160:163], v[52:55]
    ds_read_b128 v[104:107], v10 offset:11264
    v_mfma_f32_16x16x32_bf16 v[52:55], a[40:43], a[168:171], v[52:55]
    ds_read_b128 v[108:111], v10 offset:15360
    s_waitcnt lgkmcnt(7)
    v_mfma_f32_16x16x32_bf16 v[56:59], a[208:211], a[172:175], 0
    ds_read_b128 v[112:115], v10 offset:19456
    buffer_load_dwordx4 v[116:119], v9, s[12:15], s40 offen offset:2048 sc1
    v_mfma_f32_16x16x32_bf16 v[56:59], a[212:215], a[176:179], v[56:59]
    ds_read_b128 v[120:123], v10 offset:23552
    v_mfma_f32_16x16x32_bf16 v[56:59], a[0:3], a[180:183], v[56:59]
    ds_read_b128 v[124:127], v10 offset:24576
    s_waitcnt lgkmcnt(7)
    v_mfma_f32_16x16x32_bf16 v[56:59], a[36:39], a[184:187], v[56:59]
    ds_read_b128 v[128:131], v10 offset:28672
    v_mfma_f32_16x16x32_bf16 v[56:59], a[4:7], a[188:191], v[56:59]
    ds_read_b128 v[132:135], v10 offset:32768
    buffer_load_dwordx4 v[136:139], v9, s[12:15], s40 offen offset:3072 sc1
    v_mfma_f32_16x16x32_bf16 v[56:59], a[40:43], a[196:199], v[56:59]
    ds_read_b128 v[140:143], v11 offset:0
    s_waitcnt lgkmcnt(7)
    v_mfma_f32_16x16x32_bf16 v[60:63], a[208:211], a[200:203], 0
    ds_read_b128 v[144:147], v11 offset:4096
    v_mfma_f32_16x16x32_bf16 v[60:63], a[212:215], a[204:207], v[60:63]
    ds_read_b128 v[148:151], v11 offset:8192
    v_mfma_f32_16x16x32_bf16 v[60:63], a[0:3], v[104:107], v[60:63]
    ds_read_b128 v[152:155], v10 offset:25600
    s_waitcnt lgkmcnt(7)
    v_mfma_f32_16x16x32_bf16 v[60:63], a[36:39], v[108:111], v[60:63]
    ds_read_b128 v[156:159], v10 offset:29696
    v_mfma_f32_16x16x32_bf16 v[60:63], a[4:7], v[112:115], v[60:63]
    ds_read_b128 v[160:163], v10 offset:33792
    s_add_u32 s40, s40, 4096
    buffer_load_dwordx4 v[164:167], v9, s[12:15], s40 offen offset:0 sc1
    v_mfma_f32_16x16x32_bf16 v[60:63], a[40:43], v[120:123], v[60:63]
    ds_read_b128 v[168:171], v11 offset:1024
    s_waitcnt lgkmcnt(7)
    v_mfma_f32_16x16x32_bf16 v[48:51], a[8:11], v[124:127], v[48:51]
    ds_read_b128 v[172:175], v11 offset:5120
    v_mfma_f32_16x16x32_bf16 v[48:51], a[44:47], v[128:131], v[48:51]
    ds_read_b128 v[176:179], v11 offset:9216
    v_mfma_f32_16x16x32_bf16 v[48:51], a[12:15], v[132:135], v[48:51]
    ds_read_b128 v[180:183], v10 offset:26624
    s_waitcnt lgkmcnt(7)
    v_mfma_f32_16x16x32_bf16 v[48:51], a[48:51], v[140:143], v[48:51]
    ds_read_b128 v[184:187], v10 offset:30720
    v_mfma_f32_16x16x32_bf16 v[48:51], a[16:19], v[144:147], v[48:51]
    ds_read_b128 v[188:191], v10 offset:34816
    buffer_load_dwordx4 v[192:195], v9, s[12:15], s40 offen offset:1024 sc1
    v_mfma_f32_16x16x32_bf16 v[48:51], a[52:55], v[148:151], v[48:51]
    ds_read_b128 v[196:199], v11 offset:2048
    s_waitcnt lgkmcnt(7)
    v_mfma_f32_16x16x32_bf16 v[52:55], a[8:11], v[152:155], v[52:55]
    ds_read_b128 v[200:203], v11 offset:6144
    v_mfma_f32_16x16x32_bf16 v[52:55], a[44:47], v[156:159], v[52:55]
    ds_read_b128 v[204:207], v11 offset:10240
    v_mfma_f32_16x16x32_bf16 v[52:55], a[12:15], v[160:163], v[52:55]
    ds_read_b128 v[208:211], v10 offset:27648
    s_waitcnt lgkmcnt(7)
    v_mfma_f32_16x16x32_bf16 v[52:55], a[48:51], v[168:171], v[52:55]
    ds_read_b128 v[212:215], v10 offset:31744
    s_add_u32 s40, s40, 4096
    buffer_load_dwordx4 v[216:219], v9, s[12:15], s40 offen offset:0 sc1
    v_mfma_f32_16x16x32_bf16 v[52:55], a[16:19], v[172:175], v[52:55]
    ds_read_b128 v[220:223], v10 offset:35840
    v_mfma_f32_16x16x32_bf16 v[52:55], a[52:55], v[176:179], v[52:55]
    ds_read_b128 v[224:227], v11 offset:3072
    s_waitcnt lgkmcnt(7)
    v_mfma_f32_16x16x32_bf16 v[56:59], a[8:11], v[180:183], v[56:59]
    ds_read_b128 v[228:231], v11 offset:7168
    v_mfma_f32_16x16x32_bf16 v[56:59], a[44:47], v[184:187], v[56:59]
    ds_read_b128 v[232:235], v11 offset:11264
    v_mfma_f32_16x16x32_bf16 v[56:59], a[12:15], v[188:191], v[56:59]
    ds_read_b128 v[236:239], v11 offset:12288
    s_waitcnt lgkmcnt(7)
    v_mfma_f32_16x16x32_bf16 v[56:59], a[48:51], v[196:199], v[56:59]
    ds_read_b128 v[240:243], v11 offset:16384
    buffer_load_dwordx4 v[244:247], v9, s[12:15], s40 offen offset:1024 sc1
    v_mfma_f32_16x16x32_bf16 v[56:59], a[16:19], v[200:203], v[56:59]
    ds_read_b128 v[248:251], v11 offset:20480
    ds_read_b64_tr_b16 v[252:253], v94 offset:0
    ds_read_b64_tr_b16 v[254:255], v94 offset:2048
    v_mfma_f32_16x16x32_bf16 v[56:59], a[52:55], v[204:207], v[56:59]
    ds_read_b128 a[128:131], v11 offset:24576
    s_waitcnt lgkmcnt(9)
    v_mfma_f32_16x16x32_bf16 v[60:63], a[8:11], v[208:211], v[60:63]
    ds_read_b128 a[148:151], v11 offset:28672
    ds_read_b64_tr_b16 a[172:173], v94 offset:4096
    ds_read_b64_tr_b16 a[174:175], v94 offset:6144
    v_mfma_f32_16x16x32_bf16 v[60:63], a[44:47], v[212:215], v[60:63]
    ds_read_b128 a[196:199], v11 offset:32768
    v_mfma_f32_16x16x32_bf16 v[60:63], a[12:15], v[220:223], v[60:63]
    ds_read_b128 a[208:211], v11 offset:13312
    s_waitcnt lgkmcnt(11)
    v_mfma_f32_16x16x32_bf16 v[60:63], a[48:51], v[224:227], v[60:63]
    ds_read_b128 a[212:215], v11 offset:17408
    buffer_load_dwordx4 a[0:3], v9, s[12:15], s40 offen offset:2048 sc1
    v_mfma_f32_16x16x32_bf16 v[60:63], a[16:19], v[228:231], v[60:63]
    ds_read_b128 a[36:39], v11 offset:21504
    v_mfma_f32_16x16x32_bf16 v[60:63], a[52:55], v[232:235], v[60:63]
    ds_read_b128 a[4:7], v11 offset:25600
    s_waitcnt lgkmcnt(11)
    v_mfma_f32_16x16x32_bf16 v[48:51], a[20:23], v[236:239], v[48:51]
    ds_read_b128 v[112:115], v11 offset:29696
    v_mfma_f32_16x16x32_bf16 v[48:51], a[56:59], v[240:243], v[48:51]
    ds_read_b128 a[40:43], v11 offset:33792
    v_mfma_f32_16x16x32_bf16 v[48:51], a[24:27], v[248:251], v[48:51]
    ds_read_b128 v[140:143], v11 offset:14336
    s_waitcnt lgkmcnt(7)
    v_mfma_f32_16x16x32_bf16 v[48:51], a[60:63], a[128:131], v[48:51]
    ds_read_b128 v[148:151], v11 offset:18432
    v_mfma_f32_16x16x32_bf16 v[48:51], v[252:255], a[148:151], v[48:51]
    ds_read_b128 v[160:163], v11 offset:22528
    v_mfma_f32_16x16x32_bf16 v[48:51], a[172:175], a[196:199], v[48:51]
    ds_read_b128 v[172:175], v11 offset:26624
    s_waitcnt lgkmcnt(7)
    v_mfma_f32_16x16x32_bf16 v[52:55], a[20:23], a[208:211], v[52:55]
    ds_read_b128 v[184:187], v11 offset:30720
    buffer_load_dwordx4 v[196:199], v9, s[12:15], s40 offen offset:3072 sc1
    v_mfma_f32_16x16x32_bf16 v[52:55], a[56:59], a[212:215], v[52:55]
    ds_read_b128 a[8:11], v11 offset:34816
    s_add_u32 s40, s40, 4096
    buffer_load_dwordx4 v[208:211], v9, s[12:15], s40 offen offset:0 sc1
    v_mfma_f32_16x16x32_bf16 v[52:55], a[24:27], a[36:39], v[52:55]
    ds_read_b128 a[44:47], v11 offset:15360
    s_waitcnt lgkmcnt(7)
    v_mfma_f32_16x16x32_bf16 v[52:55], a[60:63], a[4:7], v[52:55]
    ds_read_b128 a[12:15], v11 offset:19456
    v_mfma_f32_16x16x32_bf16 v[52:55], v[252:255], v[112:115], v[52:55]
    ds_read_b128 v[220:223], v11 offset:23552
    v_mfma_f32_16x16x32_bf16 v[52:55], a[172:175], a[40:43], v[52:55]
    ds_read_b128 a[48:51], v11 offset:27648
    s_waitcnt lgkmcnt(7)
    v_mfma_f32_16x16x32_bf16 v[56:59], a[20:23], v[140:143], v[56:59]
    ds_read_b128 a[16:19], v11 offset:31744
    buffer_load_dwordx4 a[52:55], v9, s[12:15], s40 offen offset:1024 sc1
    v_mfma_f32_16x16x32_bf16 v[56:59], a[56:59], v[148:151], v[56:59]
    ds_read_b128 v[232:235], v11 offset:35840
    v_mfma_f32_16x16x32_bf16 v[56:59], a[24:27], v[160:163], v[56:59]
    s_waitcnt lgkmcnt(6)
    v_mfma_f32_16x16x32_bf16 v[56:59], a[60:63], v[172:175], v[56:59]
    v_mfma_f32_16x16x32_bf16 v[56:59], v[252:255], v[184:187], v[56:59]
    ds_read_b128 v[240:243], v10 offset:8192
    v_mfma_f32_16x16x32_bf16 v[56:59], a[172:175], a[8:11], v[56:59]
    s_waitcnt lgkmcnt(4)
    v_mfma_f32_16x16x32_bf16 v[60:63], a[20:23], a[44:47], v[60:63]
    buffer_load_dwordx4 a[148:151], v9, s[12:15], s40 offen offset:2048 sc1
    v_mfma_f32_16x16x32_bf16 v[60:63], a[56:59], a[12:15], v[60:63]
    v_mfma_f32_16x16x32_bf16 v[60:63], a[24:27], v[220:223], v[60:63]
    s_waitcnt lgkmcnt(1)
    v_mfma_f32_16x16x32_bf16 v[60:63], a[60:63], a[48:51], v[60:63]
    ds_read_b128 a[208:211], v10 offset:5120
    v_mfma_f32_16x16x32_bf16 v[60:63], v[252:255], a[16:19], v[60:63]
    v_mfma_f32_16x16x32_bf16 v[60:63], a[172:175], v[232:235], v[60:63]
    v_mfma_f32_16x16x32_bf16 v[32:35], a[28:31], a[120:123], 0
    buffer_load_dwordx4 a[4:7], v9, s[12:15], s40 offen offset:3072 sc1
    s_lshl_b32 s35, s30, 14
    v_mfma_f32_16x16x32_bf16 v[32:35], a[64:67], a[124:127], v[32:35]
    s_waitcnt lgkmcnt(1)
    v_mfma_f32_16x16x32_bf16 v[32:35], a[32:35], v[240:243], v[32:35]
    ds_read_b128 a[40:43], v10 offset:2048
    s_lshl_b32 s36, s28, 10
    v_mfma_f32_16x16x32_bf16 v[32:35], a[68:71], a[132:135], v[32:35]
    s_add_u32 s35, s35, s36
    v_mfma_f32_16x16x32_bf16 v[32:35], a[216:219], a[136:139], v[32:35]
    s_add_u32 s36, s35, 0x2000
    s_nop 0
    v_mfma_f32_16x16x32_bf16 v[32:35], a[220:223], a[140:143], v[32:35]
    s_nop 0
    v_and_b32 v7, 15, v2
    v_mfma_f32_16x16x32_bf16 v[36:39], a[28:31], a[144:147], 0
    v_cvt_pk_bf16_f32 v28, v48, v49
    s_waitcnt lgkmcnt(1)
    v_mfma_f32_16x16x32_bf16 v[36:39], a[64:67], a[208:211], v[36:39]
    ds_read_b128 v[160:163], v10 offset:22528
    v_cvt_pk_bf16_f32 v29, v50, v51
    v_mfma_f32_16x16x32_bf16 v[36:39], a[32:35], a[152:155], v[36:39]
    v_lshrrev_b32 v8, 4, v2
    v_cvt_pk_bf16_f32 v30, v52, v53
    v_mfma_f32_16x16x32_bf16 v[36:39], a[68:71], a[156:159], v[36:39]
    v_cvt_pk_bf16_f32 v31, v54, v55
    buffer_store_dwordx4 v[28:31], v9, s[4:7], s35 offen sc1
    v_mfma_f32_16x16x32_bf16 v[36:39], a[216:219], a[160:163], v[36:39]
    v_and_b32 v4, 1, v7
    v_lshlrev_b32 v4, 4, v4
    v_mfma_f32_16x16x32_bf16 v[36:39], a[220:223], a[168:171], v[36:39]
    v_mov_b32 v5, 0x3f80
    s_waitcnt lgkmcnt(1)
    v_mfma_f32_16x16x32_bf16 v[40:43], a[28:31], a[40:43], 0
    ds_read_b128 v[184:187], v10 offset:19456
    v_lshlrev_b32 v4, v4, v5
    v_mfma_f32_16x16x32_bf16 v[40:43], a[64:67], a[176:179], v[40:43]
    v_lshrrev_b32 v5, 1, v7
    v_lshlrev_b32 v6, 1, v8
    v_mfma_f32_16x16x32_bf16 v[40:43], a[32:35], a[180:183], v[40:43]
    v_sub_u32 v6, v5, v6
    v_mov_b32 v84, 0
    v_mfma_f32_16x16x32_bf16 v[40:43], a[68:71], a[184:187], v[40:43]
    v_mov_b32 v85, 0
    v_mfma_f32_16x16x32_bf16 v[40:43], a[216:219], a[188:191], v[40:43]
    s_add_u32 s40, s40, 4096
    buffer_load_dwordx4 a[20:23], v9, s[12:15], s40 offen offset:0 sc1
    s_waitcnt lgkmcnt(1)
    v_mfma_f32_16x16x32_bf16 v[40:43], a[220:223], v[160:163], v[40:43]
    ds_read_b128 a[56:59], v11 offset:0
    v_mov_b32 v88, 0
    v_mfma_f32_16x16x32_bf16 v[44:47], a[28:31], a[200:203], 0
    v_mov_b32 v89, 0
    v_mfma_f32_16x16x32_bf16 v[44:47], a[64:67], a[204:207], v[44:47]
    ds_read_b128 a[12:15], v11 offset:8192
    v_cmp_eq_u32 vcc, 0, v6
    v_mfma_f32_16x16x32_bf16 v[44:47], a[32:35], v[104:107], v[44:47]
    buffer_load_dwordx4 a[24:27], v9, s[12:15], s40 offen offset:1024 sc1
    v_mfma_f32_16x16x32_bf16 v[44:47], a[68:71], v[108:111], v[44:47]
    s_nop 1
    s_waitcnt lgkmcnt(2)
    v_mfma_f32_16x16x32_bf16 v[44:47], a[216:219], v[184:187], v[44:47]
    ds_read_b128 a[60:63], v10 offset:33792
    v_cndmask_b32 v86, 0, v4, vcc
    v_mfma_f32_16x16x32_bf16 v[44:47], a[220:223], v[120:123], v[44:47]
    v_mfma_f32_16x16x32_bf16 v[32:35], a[224:227], v[124:127], v[32:35]
    ds_read_b128 a[48:51], v11 offset:5120
    buffer_load_dwordx4 v[252:255], v9, s[12:15], s40 offen offset:2048 sc1
    v_mfma_f32_16x16x32_bf16 v[32:35], a[228:231], v[128:131], v[32:35]
    v_cmp_eq_u32 vcc, 1, v6
    v_mfma_f32_16x16x32_bf16 v[32:35], a[232:235], v[132:135], v[32:35]
    s_nop 1
    s_waitcnt lgkmcnt(2)
    v_mfma_f32_16x16x32_bf16 v[32:35], a[236:239], a[56:59], v[32:35]
    ds_read_b128 a[172:175], v10 offset:30720
    s_waitcnt vmcnt(32)
    v_mfma_f32_16x16x32_bf16 v[32:35], a[240:243], v[144:147], v[32:35]
    v_cndmask_b32 v87, 0, v4, vcc
    buffer_load_dwordx4 v[240:243], v9, s[12:15], s40 offen offset:3072 sc1
    v_mfma_f32_16x16x32_bf16 v[32:35], a[244:247], a[12:15], v[32:35]
    ds_read_b128 a[208:211], v11 offset:2048
    v_cmp_eq_u32 vcc, 0, v5
    v_mfma_f32_16x16x32_bf16 v[36:39], a[224:227], v[152:155], v[36:39]
    s_nop 1
    v_mfma_f32_16x16x32_bf16 v[36:39], a[228:231], v[156:159], v[36:39]
    v_cndmask_b32 v90, 0, v4, vcc
    s_waitcnt lgkmcnt(2)
    v_mfma_f32_16x16x32_bf16 v[36:39], a[232:235], a[60:63], v[36:39]
    ds_read_b128 a[40:43], v10 offset:27648
    s_add_u32 s40, s40, 4096
    buffer_load_dwordx4 v[160:163], v9, s[12:15], s40 offen offset:0 sc1
    v_mfma_f32_16x16x32_bf16 v[36:39], a[236:239], v[168:171], v[36:39]
    v_cmp_eq_u32 vcc, 1, v5
    v_mfma_f32_16x16x32_bf16 v[36:39], a[240:243], a[48:51], v[36:39]
    ds_read_b128 a[28:31], v10 offset:35840
    v_cvt_pk_bf16_f32 v20, v56, v57
    v_mfma_f32_16x16x32_bf16 v[36:39], a[244:247], v[176:179], v[36:39]
    v_cvt_pk_bf16_f32 v21, v58, v59
    v_cvt_pk_bf16_f32 v22, v60, v61
    v_mfma_f32_16x16x32_bf16 v[40:43], a[224:227], v[180:183], v[40:43]
    v_cvt_pk_bf16_f32 v23, v62, v63
    s_waitcnt lgkmcnt(2)
    v_mfma_f32_16x16x32_bf16 v[40:43], a[228:231], a[172:175], v[40:43]
    ds_read_b128 a[64:67], v11 offset:11264
    s_nop 1
    v_mfma_f32_16x16x32_bf16 v[40:43], a[232:235], v[188:191], v[40:43]
    buffer_store_dwordx4 v[20:23], v9, s[4:7], s36 offen sc1
    v_cndmask_b32 v91, 0, v4, vcc
    v_mfma_f32_16x16x32_bf16 v[40:43], a[236:239], a[208:211], v[40:43]
    ds_read_b128 a[32:35], v11 offset:16384
    v_cmp_eq_u32 vcc, 2, v5
    v_mfma_f32_16x16x32_bf16 v[40:43], a[240:243], v[200:203], v[40:43]
    ds_read_b64_tr_b16 a[68:69], v94 offset:8192
    ds_read_b64_tr_b16 a[70:71], v94 offset:10240
    s_nop 1
    v_mfma_f32_16x16x32_bf16 v[40:43], a[244:247], v[204:207], v[40:43]
    v_cndmask_b32 v92, 0, v4, vcc
    s_waitcnt lgkmcnt(4)
    v_mfma_f32_16x16x32_bf16 v[44:47], a[224:227], a[40:43], v[44:47]
    ds_read_b128 a[216:219], v11 offset:28672
    ds_read_b64_tr_b16 v[184:185], v94 offset:12288
    ds_read_b64_tr_b16 v[186:187], v94 offset:14336
    v_mfma_f32_16x16x32_bf16 v[44:47], a[228:231], v[212:215], v[44:47]
    v_cmp_eq_u32 vcc, 3, v5
    v_mfma_f32_16x16x32_bf16 v[44:47], a[232:235], a[28:31], v[44:47]
    ds_read_b128 a[220:223], v11 offset:13312
    s_nop 1
    v_mfma_f32_16x16x32_bf16 v[44:47], a[236:239], v[224:227], v[44:47]
    v_cndmask_b32 v93, 0, v4, vcc
    v_mfma_f32_16x16x32_bf16 v[44:47], a[240:243], v[228:231], v[44:47]
    s_waitcnt lgkmcnt(6)
    v_mfma_f32_16x16x32_bf16 v[44:47], a[244:247], a[64:67], v[44:47]
    ds_read_b128 a[56:59], v11 offset:25600
    s_waitcnt vmcnt(33)
    v_mfma_f32_16x16x32_bf16 v[32:35], a[248:251], v[236:239], v[32:35]
    v_lshlrev_b32 v3, 2, v7
    buffer_load_dwordx4 a[60:63], v9, s[12:15], s40 offen offset:1024 sc1
    v_mfma_f32_16x16x32_bf16 v[32:35], a[252:255], a[32:35], v[32:35]
    ds_read_b128 a[172:175], v11 offset:33792
    s_waitcnt vmcnt(32)
    v_mfma_f32_16x16x32_bf16 v[32:35], a[72:75], v[248:251], v[32:35]
    v_lshlrev_b32 v1, 12, v2
    v_lshrrev_b32 v4, 3, v2
    v_mfma_f32_16x16x32_bf16 v[32:35], a[76:79], a[128:131], v[32:35]
    s_waitcnt lgkmcnt(6)
    s_waitcnt lgkmcnt(2)
    v_mfma_f32_16x16x32_bf16 v[32:35], a[68:71], a[216:219], v[32:35]
    ds_read_b128 a[224:227], v11 offset:22528
    v_mfma_f32_16x16x32_bf16 v[32:35], v[184:187], a[196:199], v[32:35]
    v_lshlrev_b32 v4, 12, v4
    buffer_load_dwordx4 a[40:43], v9, s[12:15], s40 offen offset:2048 sc1
    v_mfma_f32_16x16x32_bf16 v[36:39], a[248:251], a[220:223], v[36:39]
    ds_read_b128 a[228:231], v11 offset:30720
    v_lshl_add_u32 v4, v2, 7, v4
    v_mfma_f32_16x16x32_bf16 v[36:39], a[252:255], a[212:215], v[36:39]
    v_mov_b32 v5, s58
    v_mfma_f32_16x16x32_bf16 v[36:39], a[72:75], a[36:39], v[36:39]
    buffer_load_dwordx4 a[232:235], v9, s[12:15], s40 offen offset:3072 sc1
    s_waitcnt lgkmcnt(2)
    v_mfma_f32_16x16x32_bf16 v[36:39], a[76:79], a[56:59], v[36:39]
    ds_read_b128 a[236:239], v11 offset:19456
    v_lshlrev_b32 v6, 10, v8
    v_mfma_f32_16x16x32_bf16 v[36:39], a[68:71], v[112:115], v[36:39]
    v_lshl_add_u32 v6, v7, 4, v6
    v_mfma_f32_16x16x32_bf16 v[36:39], v[184:187], a[172:175], v[36:39]
    ds_read_b128 a[240:243], v11 offset:27648
    s_lshl_b32 s50, s31, 11
    v_mfma_f32_16x16x32_bf16 v[40:43], a[248:251], v[140:143], v[40:43]
    s_add_u32 s40, s40, 4096
    buffer_load_dwordx4 a[244:247], v9, s[12:15], s40 offen offset:2048 sc1
    s_lshl_b32 s51, s31, 7
    v_mfma_f32_16x16x32_bf16 v[40:43], a[252:255], v[148:151], v[40:43]
    s_waitcnt lgkmcnt(2)
    v_mfma_f32_16x16x32_bf16 v[40:43], a[72:75], a[224:227], v[40:43]
    s_lshl_b32 s52, s28, 13
    v_mfma_f32_16x16x32_bf16 v[40:43], a[76:79], v[172:175], v[40:43]
    s_lshl_b32 s53, s30, 8
    v_mfma_f32_16x16x32_bf16 v[40:43], a[68:71], a[228:231], v[40:43]
    ds_read_b128 a[64:67], v10 offset:8192
    buffer_load_dwordx4 a[216:219], v9, s[12:15], s40 offen offset:3072 sc1
    v_mfma_f32_16x16x32_bf16 v[40:43], v[184:187], a[8:11], v[40:43]
    s_add_u32 s52, s52, s53
    v_mfma_f32_16x16x32_bf16 v[44:47], a[248:251], a[44:47], v[44:47]
    s_add_u32 s53, s52, 0x1000
    s_waitcnt lgkmcnt(1)
    v_mfma_f32_16x16x32_bf16 v[44:47], a[252:255], a[236:239], v[44:47]
    v_mfma_f32_16x16x32_bf16 v[44:47], a[72:75], v[220:223], v[44:47]
    s_add_u32 s40, s40, 4096
    buffer_load_dwordx4 a[220:223], v9, s[12:15], s40 offen offset:0 sc1
    v_add_u32 v8, 36864, v94
    v_mfma_f32_16x16x32_bf16 v[44:47], a[76:79], a[240:243], v[44:47]
    ds_read_b128 a[56:59], v10 offset:5120
    v_mfma_f32_16x16x32_bf16 v[44:47], a[68:71], a[16:19], v[44:47]
    v_mfma_f32_16x16x32_bf16 v[44:47], v[184:187], v[232:235], v[44:47]
    s_waitcnt vmcnt(35)
    v_mfma_f32_16x16x32_bf16 v[48:51], a[80:83], a[120:123], 0
    buffer_load_dwordx4 a[172:175], v9, s[12:15], s40 offen offset:1024 sc1
    s_add_u32 s35, s28, 1
    v_mfma_f32_16x16x32_bf16 v[48:51], a[84:87], a[124:127], v[48:51]
    s_waitcnt vmcnt(34)
    s_waitcnt lgkmcnt(1)
    v_mfma_f32_16x16x32_bf16 v[48:51], a[88:91], a[64:67], v[48:51]
    ds_read_b128 a[224:227], v10 offset:2048
    s_and_b32 s35, s35, 7
    v_mfma_f32_16x16x32_bf16 v[48:51], a[92:95], a[132:135], v[48:51]
    s_lshl_b32 s35, s35, 2
    s_waitcnt vmcnt(32)
    v_mfma_f32_16x16x32_bf16 v[48:51], a[96:99], a[136:139], v[48:51]
    s_add_u32 s35, s35, s30
    s_lshl_b32 s55, s35, 7
    v_mfma_f32_16x16x32_bf16 v[48:51], a[100:103], a[140:143], v[48:51]
    s_lshl_b32 s35, s35, 11
    s_add_u32 s35, s35, 2097152
    v_mfma_f32_16x16x32_bf16 v[52:55], a[80:83], a[144:147], 0
    s_add_u32 s36, s35, 1024
    s_waitcnt lgkmcnt(1)
    v_mfma_f32_16x16x32_bf16 v[52:55], a[84:87], a[56:59], v[52:55]
    ds_read_b128 a[228:231], v10 offset:22528
    v_cvt_pk_bf16_f32 v28, v32, v33
    v_mfma_f32_16x16x32_bf16 v[52:55], a[88:91], a[152:155], v[52:55]
    v_cvt_pk_bf16_f32 v29, v34, v35
    v_cvt_pk_bf16_f32 v30, v36, v37
    v_mfma_f32_16x16x32_bf16 v[52:55], a[92:95], a[156:159], v[52:55]
    v_cvt_pk_bf16_f32 v31, v38, v39
    buffer_store_dwordx4 v[28:31], v9, s[4:7], s35 offen sc1
    v_mfma_f32_16x16x32_bf16 v[52:55], a[96:99], a[160:163], v[52:55]
    v_mfma_f32_16x16x32_bf16 v[52:55], a[100:103], a[168:171], v[52:55]
    s_waitcnt lgkmcnt(1)
    v_mfma_f32_16x16x32_bf16 v[56:59], a[80:83], a[224:227], 0
    ds_read_b128 a[248:251], v10 offset:19456
    v_mfma_f32_16x16x32_bf16 v[56:59], a[84:87], a[176:179], v[56:59]
    v_mfma_f32_16x16x32_bf16 v[56:59], a[88:91], a[180:183], v[56:59]
    v_mfma_f32_16x16x32_bf16 v[56:59], a[92:95], a[184:187], v[56:59]
    buffer_load_dwordx4 a[252:255], v9, s[12:15], s40 offen offset:2048 sc1
    v_mfma_f32_16x16x32_bf16 v[56:59], a[96:99], a[188:191], v[56:59]
    s_waitcnt lgkmcnt(1)
    v_mfma_f32_16x16x32_bf16 v[56:59], a[100:103], a[228:231], v[56:59]
    ds_read_b128 a[236:239], v11 offset:0
    v_mfma_f32_16x16x32_bf16 v[60:63], a[80:83], a[200:203], 0
    v_mfma_f32_16x16x32_bf16 v[60:63], a[84:87], a[204:207], v[60:63]
    buffer_load_dwordx4 a[72:75], v9, s[12:15], s40 offen offset:3072 sc1
    v_mfma_f32_16x16x32_bf16 v[60:63], a[88:91], v[104:107], v[60:63]
    v_mfma_f32_16x16x32_bf16 v[60:63], a[92:95], v[108:111], v[60:63]
    s_waitcnt lgkmcnt(1)
    v_mfma_f32_16x16x32_bf16 v[60:63], a[96:99], a[248:251], v[60:63]
    ds_read_b128 a[76:79], v10 offset:33792
    v_mfma_f32_16x16x32_bf16 v[60:63], a[100:103], v[120:123], v[60:63]
    s_add_u32 s40, s40, 4096
    buffer_load_dwordx4 a[240:243], v9, s[12:15], s40 offen offset:0 sc1
    s_waitcnt vmcnt(34)
    v_mfma_f32_16x16x32_bf16 v[48:51], a[104:107], v[124:127], v[48:51]
    v_mfma_f32_16x16x32_bf16 v[48:51], a[108:111], v[128:131], v[48:51]
    v_cvt_pk_bf16_f32 v20, v40, v41
    s_waitcnt vmcnt(32)
    v_mfma_f32_16x16x32_bf16 v[48:51], a[112:115], v[132:135], v[48:51]
    v_cvt_pk_bf16_f32 v21, v42, v43
    s_waitcnt lgkmcnt(1)
    v_mfma_f32_16x16x32_bf16 v[48:51], a[116:119], a[236:239], v[48:51]
    ds_read_b128 a[68:71], v10 offset:30720
    s_waitcnt vmcnt(30)
    v_mfma_f32_16x16x32_bf16 v[48:51], a[164:167], v[144:147], v[48:51]
    v_cvt_pk_bf16_f32 v22, v44, v45
    v_cvt_pk_bf16_f32 v23, v46, v47
    v_mfma_f32_16x16x32_bf16 v[48:51], a[192:195], a[12:15], v[48:51]
    buffer_store_dwordx4 v[20:23], v9, s[4:7], s36 offen sc1
    v_mfma_f32_16x16x32_bf16 v[52:55], a[104:107], v[152:155], v[52:55]
    v_mfma_f32_16x16x32_bf16 v[52:55], a[108:111], v[156:159], v[52:55]
    s_waitcnt lgkmcnt(1)
    v_mfma_f32_16x16x32_bf16 v[52:55], a[112:115], a[76:79], v[52:55]
    ds_read_b128 v[184:187], v10 offset:27648
    v_mfma_f32_16x16x32_bf16 v[52:55], a[116:119], v[168:171], v[52:55]
    v_mfma_f32_16x16x32_bf16 v[52:55], a[164:167], a[48:51], v[52:55]
    v_mfma_f32_16x16x32_bf16 v[52:55], a[192:195], v[176:179], v[52:55]
    v_mfma_f32_16x16x32_bf16 v[56:59], a[104:107], v[180:183], v[56:59]
    s_waitcnt lgkmcnt(1)
    v_mfma_f32_16x16x32_bf16 v[56:59], a[108:111], a[68:71], v[56:59]
    ds_read_b128 a[56:59], v11 offset:11264
    v_mfma_f32_16x16x32_bf16 v[56:59], a[112:115], v[188:191], v[56:59]
    v_mfma_f32_16x16x32_bf16 v[56:59], a[116:119], a[208:211], v[56:59]
    buffer_load_dwordx4 a[224:227], v9, s[12:15], s40 offen offset:1024 sc1
    v_mfma_f32_16x16x32_bf16 v[56:59], a[164:167], v[200:203], v[56:59]
    ds_read_b64_tr_b16 a[228:229], v94 offset:16384
    ds_read_b64_tr_b16 a[230:231], v94 offset:18432
    v_rcp_f32 v24, v24
    v_mfma_f32_16x16x32_bf16 v[56:59], a[192:195], v[204:207], v[56:59]
    s_waitcnt lgkmcnt(3)
    v_mfma_f32_16x16x32_bf16 v[60:63], a[104:107], v[184:187], v[60:63]
    ds_read_b128 a[80:83], v11 offset:28672
    ds_read_b64_tr_b16 a[84:85], v94 offset:20480
    ds_read_b64_tr_b16 a[86:87], v94 offset:22528
    v_mfma_f32_16x16x32_bf16 v[60:63], a[108:111], v[212:215], v[60:63]
    buffer_load_dwordx4 a[88:91], v9, s[12:15], s40 offen offset:2048 sc1
    v_mfma_f32_16x16x32_bf16 v[60:63], a[112:115], a[28:31], v[60:63]
    ds_read_b128 a[92:95], v11 offset:13312
    v_mfma_f32_16x16x32_bf16 v[60:63], a[116:119], v[224:227], v[60:63]
    v_mfma_f32_16x16x32_bf16 v[60:63], a[164:167], v[228:231], v[60:63]
    buffer_load_dwordx4 a[96:99], v9, s[12:15], s40 offen offset:3072 sc1
    s_waitcnt lgkmcnt(6)
    v_mfma_f32_16x16x32_bf16 v[60:63], a[192:195], a[56:59], v[60:63]
    ds_read_b128 a[248:251], v11 offset:25600
    s_waitcnt vmcnt(32)
    v_mfma_f32_16x16x32_bf16 v[48:51], v[116:119], v[236:239], v[48:51]
    v_rcp_f32 v25, v25
L_pg8:
    s_cbranch_execz L_wret1
    s_nop 0
    v_mfma_f32_16x16x32_bf16 v[48:51], v[136:139], a[32:35], v[48:51]
    ds_read_b128 a[100:103], v11 offset:33792
    s_waitcnt vmcnt(30)
    v_mfma_f32_16x16x32_bf16 v[48:51], v[164:167], v[248:251], v[48:51]
    s_add_u32 s40, s40, 4096
    buffer_load_dwordx4 a[236:239], v9, s[12:15], s40 offen offset:0 sc1
    v_mfma_f32_16x16x32_bf16 v[48:51], v[192:195], a[128:131], v[48:51]
    s_waitcnt lgkmcnt(6)
    s_waitcnt lgkmcnt(2)
    v_mfma_f32_16x16x32_bf16 v[48:51], a[228:231], a[80:83], v[48:51]
    ds_read_b128 a[76:79], v11 offset:22528
    v_mfma_f32_16x16x32_bf16 v[48:51], a[84:87], a[196:199], v[48:51]
    s_lshl_b32 s37, s30, 10
    s_lshl_b32 s38, s28, 2
    v_mfma_f32_16x16x32_bf16 v[52:55], v[116:119], a[92:95], v[52:55]
    ds_read_b128 a[68:71], v11 offset:30720
    v_rcp_f32 v26, v26
    v_mfma_f32_16x16x32_bf16 v[52:55], v[136:139], a[212:215], v[52:55]
    s_add_u32 s37, s37, s38
    s_waitcnt vmcnt(16)
    v_mfma_f32_16x16x32_bf16 v[52:55], v[164:167], a[36:39], v[52:55]
    buffer_store_dword v5, v4, s[24:27], s37 offen offset:32 sc1
    s_waitcnt lgkmcnt(2)
    v_mfma_f32_16x16x32_bf16 v[52:55], v[192:195], a[248:251], v[52:55]
    ds_read_b128 a[104:107], v11 offset:19456
    buffer_load_dwordx4 v[184:187], v9, s[12:15], s40 offen offset:1024 sc1
    v_mfma_f32_16x16x32_bf16 v[52:55], a[228:231], v[112:115], v[52:55]
    v_rcp_f32 v27, v27
    v_mfma_f32_16x16x32_bf16 v[52:55], a[84:87], a[100:103], v[52:55]
    ds_read_b128 a[108:111], v11 offset:27648
    v_mfma_f32_16x16x32_bf16 v[56:59], v[116:119], v[140:143], v[56:59]
    buffer_load_dwordx4 a[112:115], v9, s[12:15], s40 offen offset:2048 sc1
    v_mfma_f32_16x16x32_bf16 v[56:59], v[136:139], v[148:151], v[56:59]
    s_waitcnt lgkmcnt(2)
    v_mfma_f32_16x16x32_bf16 v[56:59], v[164:167], a[76:79], v[56:59]
    v_mfma_f32_16x16x32_bf16 v[56:59], v[192:195], v[172:175], v[56:59]
    v_mfma_f32_16x16x32_bf16 v[56:59], a[228:231], a[68:71], v[56:59]
    buffer_load_dwordx4 a[116:119], v9, s[12:15], s40 offen offset:3072 sc1
    v_rcp_f32 v0, v17
    v_mfma_f32_16x16x32_bf16 v[56:59], a[84:87], a[8:11], v[56:59]
    v_mfma_f32_16x16x32_bf16 v[60:63], v[116:119], a[44:47], v[60:63]
    s_waitcnt lgkmcnt(0)
    v_mfma_f32_16x16x32_bf16 v[60:63], v[136:139], a[104:107], v[60:63]
    v_mfma_f32_16x16x32_bf16 v[60:63], v[164:167], v[220:223], v[60:63]
    s_add_u32 s40, s40, 4096
    buffer_load_dwordx4 a[164:167], v9, s[12:15], s40 offen offset:0 sc1
    v_mfma_f32_16x16x32_bf16 v[60:63], v[192:195], a[108:111], v[60:63]
    ds_read_b128 a[192:195], v10 offset:5120
    v_mfma_f32_16x16x32_bf16 v[60:63], a[228:231], a[16:19], v[60:63]
    v_mfma_f32_16x16x32_bf16 v[60:63], a[84:87], v[232:235], v[60:63]
    v_mfma_f32_16x16x32_bf16 v[32:35], v[216:219], a[120:123], 0
    buffer_load_dword v7, v3, s[24:27], s51 offen sc1
    v_mfma_f32_16x16x32_bf16 v[32:35], v[244:247], a[124:127], v[32:35]
    buffer_load_dwordx4 a[56:59], v9, s[12:15], s40 offen offset:1024 sc1
    v_mfma_f32_16x16x32_bf16 v[32:35], a[0:3], a[64:67], v[32:35]
    ds_read_b128 a[80:83], v10 offset:2048
    s_add_u32 s35, s28, 2
    v_mfma_f32_16x16x32_bf16 v[32:35], v[196:199], a[132:135], v[32:35]
    s_and_b32 s35, s35, 7
    v_mfma_f32_16x16x32_bf16 v[32:35], v[208:211], a[136:139], v[32:35]
    s_lshl_b32 s35, s35, 2
    s_add_u32 s35, s35, s30
    v_mfma_f32_16x16x32_bf16 v[32:35], a[52:55], a[140:143], v[32:35]
    s_lshl_b32 s54, s35, 7
    s_lshl_b32 s35, s35, 11
    v_mfma_f32_16x16x32_bf16 v[36:39], v[216:219], a[144:147], 0
    s_add_u32 s35, s35, 4194304
    s_waitcnt lgkmcnt(1)
    v_mfma_f32_16x16x32_bf16 v[36:39], v[244:247], a[192:195], v[36:39]
    ds_read_b128 a[248:251], v10 offset:22528
    s_add_u32 s36, s35, 1024
    v_mfma_f32_16x16x32_bf16 v[36:39], a[0:3], a[152:155], v[36:39]
    v_cvt_pk_bf16_f32 v28, v48, v49
    v_cvt_pk_bf16_f32 v29, v50, v51
    v_mfma_f32_16x16x32_bf16 v[36:39], v[196:199], a[156:159], v[36:39]
    v_cvt_pk_bf16_f32 v30, v52, v53
    v_cvt_pk_bf16_f32 v31, v54, v55
    v_mfma_f32_16x16x32_bf16 v[36:39], v[208:211], a[160:163], v[36:39]
    buffer_store_dwordx4 v[28:31], v9, s[4:7], s35 offen sc1
    v_mfma_f32_16x16x32_bf16 v[36:39], a[52:55], a[168:171], v[36:39]
    s_waitcnt lgkmcnt(1)
    v_mfma_f32_16x16x32_bf16 v[40:43], v[216:219], a[80:83], 0
    ds_read_b128 a[76:79], v10 offset:19456
    v_mfma_f32_16x16x32_bf16 v[40:43], v[244:247], a[176:179], v[40:43]
    s_add_u32 s40, s40, 4096
    buffer_load_dwordx4 v[116:119], v9, s[12:15], s40 offen offset:0 sc1
    v_mfma_f32_16x16x32_bf16 v[40:43], a[0:3], a[180:183], v[40:43]
    v_mfma_f32_16x16x32_bf16 v[40:43], v[196:199], a[184:187], v[40:43]
    v_mfma_f32_16x16x32_bf16 v[40:43], v[208:211], a[188:191], v[40:43]
    buffer_load_dwordx4 v[136:139], v9, s[12:15], s40 offen offset:1024 sc1
    s_waitcnt lgkmcnt(1)
    v_mfma_f32_16x16x32_bf16 v[40:43], a[52:55], a[248:251], v[40:43]
    ds_read_b128 a[104:107], v11 offset:0
    v_cvt_pk_bf16_f32 v20, v56, v57
    v_mfma_f32_16x16x32_bf16 v[44:47], v[216:219], a[200:203], 0
    v_cvt_pk_bf16_f32 v21, v58, v59
    v_cvt_pk_bf16_f32 v22, v60, v61
    v_mfma_f32_16x16x32_bf16 v[44:47], v[244:247], a[204:207], v[44:47]
    v_cvt_pk_bf16_f32 v23, v62, v63
    buffer_store_dwordx4 v[20:23], v9, s[4:7], s36 offen sc1
    v_mfma_f32_16x16x32_bf16 v[44:47], a[0:3], v[104:107], v[44:47]
    v_mfma_f32_16x16x32_bf16 v[44:47], v[196:199], v[108:111], v[44:47]
    s_waitcnt lgkmcnt(1)
    v_mfma_f32_16x16x32_bf16 v[44:47], v[208:211], a[76:79], v[44:47]
    ds_read_b128 v[164:167], v10 offset:33792
    v_mfma_f32_16x16x32_bf16 v[44:47], a[52:55], v[120:123], v[44:47]
    v_mfma_f32_16x16x32_bf16 v[32:35], a[148:151], v[124:127], v[32:35]
    v_mfma_f32_16x16x32_bf16 v[32:35], a[4:7], v[128:131], v[32:35]
    v_mfma_f32_16x16x32_bf16 v[32:35], a[20:23], v[132:135], v[32:35]
    s_waitcnt lgkmcnt(1)
    v_mfma_f32_16x16x32_bf16 v[32:35], a[24:27], a[104:107], v[32:35]
    ds_read_b128 v[192:195], v10 offset:30720
    v_mfma_f32_16x16x32_bf16 v[32:35], v[252:255], v[144:147], v[32:35]
    buffer_load_dwordx4 a[228:231], v9, s[12:15], s40 offen offset:2048 sc1
    v_mfma_f32_16x16x32_bf16 v[32:35], v[240:243], a[12:15], v[32:35]
    v_mfma_f32_16x16x32_bf16 v[36:39], a[148:151], v[152:155], v[36:39]
    v_mfma_f32_16x16x32_bf16 v[36:39], a[4:7], v[156:159], v[36:39]
    buffer_load_dwordx4 a[84:87], v9, s[12:15], s40 offen offset:3072 sc1
    s_waitcnt lgkmcnt(1)
    v_mfma_f32_16x16x32_bf16 v[36:39], a[20:23], v[164:167], v[36:39]
    ds_read_b128 v[216:219], v10 offset:27648
    s_waitcnt vmcnt(17)
    v_mfma_f32_16x16x32_bf16 v[36:39], a[24:27], v[168:171], v[36:39]
    buffer_store_dword v5, v1, s[24:27], s55 offen offset:4 sc1
    v_mfma_f32_16x16x32_bf16 v[36:39], v[252:255], a[48:51], v[36:39]
    v_mfma_f32_16x16x32_bf16 v[36:39], v[240:243], v[176:179], v[36:39]
    s_add_u32 s40, s40, 4096
    buffer_load_dwordx4 v[244:247], v9, s[12:15], s40 offen offset:0 sc1
    v_mfma_f32_16x16x32_bf16 v[40:43], a[148:151], v[180:183], v[40:43]
    s_waitcnt lgkmcnt(1)
    v_mfma_f32_16x16x32_bf16 v[40:43], a[4:7], v[192:195], v[40:43]
    ds_read_b128 a[0:3], v11 offset:11264
    v_mfma_f32_16x16x32_bf16 v[40:43], a[20:23], v[188:191], v[40:43]
    buffer_load_dwordx4 v[196:199], v9, s[12:15], s40 offen offset:1024 sc1
    v_mfma_f32_16x16x32_bf16 v[40:43], a[24:27], a[208:211], v[40:43]
    v_mfma_f32_16x16x32_bf16 v[40:43], v[252:255], v[200:203], v[40:43]
    ds_read_b64_tr_b16 v[208:209], v94 offset:24576
    ds_read_b64_tr_b16 v[210:211], v94 offset:26624
    s_waitcnt vmcnt(10)
    v_cmp_ne_u32 vcc, s58, v7
    s_and_b32 s37, vcc_lo, 0xff00
    s_cbranch_scc1 L_chk_P0_spin
L_chk_P0:
    v_mfma_f32_16x16x32_bf16 v[40:43], v[240:243], v[204:207], v[40:43]
    buffer_load_dwordx4 v[12:15], v6, s[4:7], s52 offen sc1
    s_waitcnt lgkmcnt(3)
    v_mfma_f32_16x16x32_bf16 v[44:47], a[148:151], v[216:219], v[44:47]
    ds_read_b128 a[76:79], v11 offset:28672
    ds_read_b64_tr_b16 a[52:53], v94 offset:28672
    ds_read_b64_tr_b16 a[54:55], v94 offset:30720
    v_mfma_f32_16x16x32_bf16 v[44:47], a[4:7], v[212:215], v[44:47]
    v_mfma_f32_16x16x32_bf16 v[44:47], a[20:23], a[28:31], v[44:47]
    v_mfma_f32_16x16x32_bf16 v[44:47], a[24:27], v[224:227], v[44:47]
    v_mfma_f32_16x16x32_bf16 v[44:47], v[252:255], v[228:231], v[44:47]
    s_waitcnt lgkmcnt(5)
    v_mfma_f32_16x16x32_bf16 v[44:47], v[240:243], a[0:3], v[44:47]
    ds_read_b128 a[104:107], v11 offset:25600
    v_mfma_f32_16x16x32_bf16 v[32:35], v[160:163], v[236:239], v[32:35]
    v_mfma_f32_16x16x32_bf16 v[32:35], a[60:63], a[32:35], v[32:35]
    buffer_load_dwordx4 v[164:167], v9, s[12:15], s40 offen offset:2048 sc1
    v_mfma_f32_16x16x32_bf16 v[32:35], a[40:43], v[248:251], v[32:35]
    v_mfma_f32_16x16x32_bf16 v[32:35], a[232:235], a[128:131], v[32:35]
    s_waitcnt lgkmcnt(4)
    s_waitcnt lgkmcnt(3)
    v_mfma_f32_16x16x32_bf16 v[32:35], v[208:211], a[76:79], v[32:35]
    ds_read_b128 v[192:195], v11 offset:22528
    s_waitcnt lgkmcnt(2)
    v_mfma_f32_16x16x32_bf16 v[32:35], a[52:55], a[196:199], v[32:35]
    buffer_load_dwordx4 a[148:151], v9, s[12:15], s40 offen offset:3072 sc1
    v_mfma_f32_16x16x32_bf16 v[36:39], v[160:163], a[92:95], v[36:39]
    v_mfma_f32_16x16x32_bf16 v[36:39], a[60:63], a[212:215], v[36:39]
    buffer_load_dwordx4 v[16:19], v6, s[4:7], s53 offen sc1
    v_mfma_f32_16x16x32_bf16 v[36:39], a[40:43], a[36:39], v[36:39]
    s_waitcnt lgkmcnt(1)
    v_mfma_f32_16x16x32_bf16 v[36:39], a[232:235], a[104:107], v[36:39]
    ds_read_b128 v[216:219], v11 offset:19456
    v_mfma_f32_16x16x32_bf16 v[36:39], v[208:211], v[112:115], v[36:39]
    v_mfma_f32_16x16x32_bf16 v[36:39], a[52:55], a[100:103], v[36:39]
    v_mfma_f32_16x16x32_bf16 v[40:43], v[160:163], v[140:143], v[40:43]
    v_mfma_f32_16x16x32_bf16 v[40:43], a[60:63], v[148:151], v[40:43]
    s_waitcnt lgkmcnt(1)
    v_mfma_f32_16x16x32_bf16 v[40:43], a[40:43], v[192:195], v[40:43]
    v_mfma_f32_16x16x32_bf16 v[40:43], a[232:235], v[172:175], v[40:43]
    s_add_u32 s40, s40, 4096
    buffer_load_dwordx4 a[4:7], v9, s[12:15], s40 offen offset:0 sc1
    v_mfma_f32_16x16x32_bf16 v[40:43], v[208:211], a[68:71], v[40:43]
    v_mfma_f32_16x16x32_bf16 v[40:43], a[52:55], a[8:11], v[40:43]
    v_mfma_f32_16x16x32_bf16 v[44:47], v[160:163], a[44:47], v[44:47]
    buffer_load_dwordx4 a[20:23], v9, s[12:15], s40 offen offset:1024 sc1
    s_waitcnt lgkmcnt(0)
    v_mfma_f32_16x16x32_bf16 v[44:47], a[60:63], v[216:219], v[44:47]
    v_mfma_f32_16x16x32_bf16 v[44:47], a[40:43], v[220:223], v[44:47]
    v_mfma_f32_16x16x32_bf16 v[44:47], a[232:235], a[108:111], v[44:47]
    buffer_load_dwordx4 a[24:27], v9, s[12:15], s40 offen offset:2048 sc1
    v_mfma_f32_16x16x32_bf16 v[44:47], v[208:211], a[16:19], v[44:47]
    v_mfma_f32_16x16x32_bf16 v[44:47], a[52:55], v[232:235], v[44:47]
    v_mfma_f32_16x16x32_bf16 v[48:51], a[244:247], a[120:123], 0
    buffer_load_dword v7, v3, s[24:27], s51 offen sc1
    v_mfma_f32_16x16x32_bf16 v[48:51], a[216:219], a[124:127], v[48:51]
    buffer_load_dwordx4 v[252:255], v9, s[12:15], s40 offen offset:3072 sc1
    v_mfma_f32_16x16x32_bf16 v[48:51], a[220:223], a[64:67], v[48:51]
    s_add_u32 s35, s28, 3
    s_and_b32 s35, s35, 7
    v_mfma_f32_16x16x32_bf16 v[48:51], a[172:175], a[132:135], v[48:51]
    s_lshl_b32 s35, s35, 2
    v_mfma_f32_16x16x32_bf16 v[48:51], a[252:255], a[136:139], v[48:51]
    s_add_u32 s35, s35, s30
    s_lshl_b32 s55, s35, 7
    v_mfma_f32_16x16x32_bf16 v[48:51], a[72:75], a[140:143], v[48:51]
    s_lshl_b32 s35, s35, 11
    s_add_u32 s35, s35, 6291456
    v_mfma_f32_16x16x32_bf16 v[52:55], a[244:247], a[144:147], 0
    s_add_u32 s36, s35, 1024
    v_cvt_pk_bf16_f32 v28, v32, v33
    v_mfma_f32_16x16x32_bf16 v[52:55], a[216:219], a[192:195], v[52:55]
    v_cvt_pk_bf16_f32 v29, v34, v35
    v_cvt_pk_bf16_f32 v30, v36, v37
    v_mfma_f32_16x16x32_bf16 v[52:55], a[220:223], a[152:155], v[52:55]
    v_cvt_pk_bf16_f32 v31, v38, v39
    buffer_store_dwordx4 v[28:31], v9, s[4:7], s35 offen sc1
    v_mfma_f32_16x16x32_bf16 v[52:55], a[172:175], a[156:159], v[52:55]
    v_mfma_f32_16x16x32_bf16 v[52:55], a[252:255], a[160:163], v[52:55]
    v_mfma_f32_16x16x32_bf16 v[52:55], a[72:75], a[168:171], v[52:55]
    v_mfma_f32_16x16x32_bf16 v[56:59], a[244:247], a[80:83], 0
    ds_read_b128 v[240:243], v10 offset:19456
    s_add_u32 s40, s40, 4096
    buffer_load_dwordx4 a[0:3], v9, s[12:15], s40 offen offset:0 sc1
    v_mfma_f32_16x16x32_bf16 v[56:59], a[216:219], a[176:179], v[56:59]
    v_mfma_f32_16x16x32_bf16 v[56:59], a[220:223], a[180:183], v[56:59]
    v_mfma_f32_16x16x32_bf16 v[56:59], a[172:175], a[184:187], v[56:59]
    buffer_load_dwordx4 a[76:79], v9, s[12:15], s40 offen offset:1024 sc1
    v_mfma_f32_16x16x32_bf16 v[56:59], a[252:255], a[188:191], v[56:59]
    v_cvt_pk_bf16_f32 v20, v40, v41
    v_cvt_pk_bf16_f32 v21, v42, v43
    v_mfma_f32_16x16x32_bf16 v[56:59], a[72:75], a[248:251], v[56:59]
    ds_read_b128 a[104:107], v11 offset:0
    v_cvt_pk_bf16_f32 v22, v44, v45
    v_mfma_f32_16x16x32_bf16 v[60:63], a[244:247], a[200:203], 0
    v_cvt_pk_bf16_f32 v23, v46, v47
    buffer_store_dwordx4 v[20:23], v9, s[4:7], s36 offen sc1
    v_mfma_f32_16x16x32_bf16 v[60:63], a[216:219], a[204:207], v[60:63]
    v_mfma_f32_16x16x32_bf16 v[60:63], a[220:223], v[104:107], v[60:63]
    v_mfma_f32_16x16x32_bf16 v[60:63], a[172:175], v[108:111], v[60:63]
    s_waitcnt lgkmcnt(1)
    v_mfma_f32_16x16x32_bf16 v[60:63], a[252:255], v[240:243], v[60:63]
    ds_read_b128 v[192:195], v10 offset:33792
    v_mfma_f32_16x16x32_bf16 v[60:63], a[72:75], v[120:123], v[60:63]
    v_mfma_f32_16x16x32_bf16 v[48:51], a[240:243], v[124:127], v[48:51]
    v_mfma_f32_16x16x32_bf16 v[48:51], a[224:227], v[128:131], v[48:51]
    v_mfma_f32_16x16x32_bf16 v[48:51], a[88:91], v[132:135], v[48:51]
    s_waitcnt lgkmcnt(1)
    v_mfma_f32_16x16x32_bf16 v[48:51], a[96:99], a[104:107], v[48:51]
    ds_read_b128 v[160:163], v10 offset:30720
    v_mfma_f32_16x16x32_bf16 v[48:51], a[236:239], v[144:147], v[48:51]
    buffer_load_dwordx4 a[60:63], v9, s[12:15], s40 offen offset:2048 sc1
    v_mfma_f32_16x16x32_bf16 v[48:51], v[184:187], a[12:15], v[48:51]
    buffer_load_dwordx4 v[216:219], v9, s[12:15], s40 offen offset:3072 sc1
    v_mfma_f32_16x16x32_bf16 v[52:55], a[240:243], v[152:155], v[52:55]
    v_mfma_f32_16x16x32_bf16 v[52:55], a[224:227], v[156:159], v[52:55]
    s_waitcnt vmcnt(20)
    s_waitcnt lgkmcnt(1)
    v_mfma_f32_16x16x32_bf16 v[52:55], a[88:91], v[192:195], v[52:55]
    ds_read_b128 a[40:43], v10 offset:27648
    buffer_store_dword v5, v1, s[24:27], s54 offen offset:8 sc1
    v_mfma_f32_16x16x32_bf16 v[52:55], a[96:99], v[168:171], v[52:55]
    v_mfma_f32_16x16x32_bf16 v[52:55], a[236:239], a[48:51], v[52:55]
    s_add_u32 s40, s40, 4096
    buffer_load_dwordx4 a[232:235], v9, s[12:15], s40 offen offset:2048 sc1
    v_mfma_f32_16x16x32_bf16 v[52:55], v[184:187], v[176:179], v[52:55]
    v_mfma_f32_16x16x32_bf16 v[56:59], a[240:243], v[180:183], v[56:59]
    buffer_load_dwordx4 v[208:211], v9, s[12:15], s40 offen offset:3072 sc1
    s_waitcnt lgkmcnt(1)
    v_mfma_f32_16x16x32_bf16 v[56:59], a[224:227], v[160:163], v[56:59]
    ds_read_b128 a[52:55], v11 offset:11264
    v_mfma_f32_16x16x32_bf16 v[56:59], a[88:91], v[188:191], v[56:59]
    v_mfma_f32_16x16x32_bf16 v[56:59], a[96:99], a[208:211], v[56:59]
    s_add_u32 s40, s40, 4096
    buffer_load_dwordx4 a[244:247], v9, s[12:15], s40 offen offset:0 sc1
    v_mfma_f32_16x16x32_bf16 v[56:59], a[236:239], v[200:203], v[56:59]
    ds_read_b64_tr_b16 a[216:217], v94 offset:32768
    ds_read_b64_tr_b16 a[218:219], v94 offset:34816
    v_mfma_f32_16x16x32_bf16 v[56:59], v[184:187], v[204:207], v[56:59]
    s_waitcnt vmcnt(11)
    v_cmp_ne_u32 vcc, s58, v7
    s_and_b32 s37, vcc_lo, 0x2
    s_cbranch_scc1 L_chk_P1_spin
L_chk_P1:
    s_waitcnt lgkmcnt(3)
    v_mfma_f32_16x16x32_bf16 v[60:63], a[240:243], a[40:43], v[60:63]
    ds_read_b128 a[220:223], v11 offset:28672
    ds_read_b64_tr_b16 a[172:173], v8 offset:0
    ds_read_b64_tr_b16 a[174:175], v8 offset:2048
    v_mfma_f32_16x16x32_bf16 v[60:63], a[224:227], v[212:215], v[60:63]
    s_add_u32 s37, s50, 2097152
    buffer_load_dwordx4 v[96:99], v9, s[4:7], s37 offen offset:0 sc1
    v_mfma_f32_16x16x32_bf16 v[60:63], a[88:91], a[28:31], v[60:63]
    v_mfma_f32_16x16x32_bf16 v[60:63], a[96:99], v[224:227], v[60:63]
    v_mfma_f32_16x16x32_bf16 v[60:63], a[236:239], v[228:231], v[60:63]
    s_waitcnt lgkmcnt(5)
    v_mfma_f32_16x16x32_bf16 v[60:63], v[184:187], a[52:55], v[60:63]
    ds_read_b128 a[252:255], v11 offset:25600
    v_mfma_f32_16x16x32_bf16 v[48:51], a[112:115], v[236:239], v[48:51]
    v_mfma_f32_16x16x32_bf16 v[48:51], a[116:119], a[32:35], v[48:51]
    v_mfma_f32_16x16x32_bf16 v[48:51], a[164:167], v[248:251], v[48:51]
    buffer_load_dwordx4 a[72:75], v9, s[12:15], s40 offen offset:1024 sc1
    v_mfma_f32_16x16x32_bf16 v[48:51], a[56:59], a[128:131], v[48:51]
    s_waitcnt lgkmcnt(4)
    s_waitcnt lgkmcnt(3)
    v_mfma_f32_16x16x32_bf16 v[48:51], a[216:219], a[220:223], v[48:51]
    ds_read_b128 a[240:243], v11 offset:22528
    s_waitcnt lgkmcnt(2)
    v_mfma_f32_16x16x32_bf16 v[48:51], a[172:175], a[196:199], v[48:51]
    buffer_load_dwordx4 a[224:227], v9, s[12:15], s40 offen offset:2048 sc1
    v_mfma_f32_16x16x32_bf16 v[52:55], a[112:115], a[92:95], v[52:55]
    v_mfma_f32_16x16x32_bf16 v[52:55], a[116:119], a[212:215], v[52:55]
    buffer_load_dwordx4 v[100:103], v9, s[4:7], s37 offen offset:1024 sc1
    v_mfma_f32_16x16x32_bf16 v[52:55], a[164:167], a[36:39], v[52:55]
    s_waitcnt lgkmcnt(1)
    v_mfma_f32_16x16x32_bf16 v[52:55], a[56:59], a[252:255], v[52:55]
    ds_read_b128 a[88:91], v11 offset:19456
    v_mfma_f32_16x16x32_bf16 v[52:55], a[216:219], v[112:115], v[52:55]
    v_mfma_f32_16x16x32_bf16 v[52:55], a[172:175], a[100:103], v[52:55]
    v_mfma_f32_16x16x32_bf16 v[80:83], v[90:93], v[12:15], v[80:83]
    v_mfma_f32_16x16x32_bf16 v[80:83], v[90:93], v[16:19], v[80:83]
    v_mfma_f32_16x16x32_bf16 v[56:59], a[112:115], v[140:143], v[56:59]
    v_mfma_f32_16x16x32_bf16 v[56:59], a[116:119], v[148:151], v[56:59]
    s_waitcnt lgkmcnt(1)
    v_mfma_f32_16x16x32_bf16 v[56:59], a[164:167], a[240:243], v[56:59]
    v_mfma_f32_16x16x32_bf16 v[56:59], a[56:59], v[172:175], v[56:59]
    buffer_load_dwordx4 a[96:99], v9, s[12:15], s40 offen offset:3072 sc1
    v_mfma_f32_16x16x32_bf16 v[56:59], a[216:219], a[68:71], v[56:59]
    v_mfma_f32_16x16x32_bf16 v[56:59], a[172:175], a[8:11], v[56:59]
    v_mfma_f32_16x16x32_bf16 v[60:63], a[112:115], a[44:47], v[60:63]
    s_add_u32 s40, s40, 4096
    buffer_load_dwordx4 a[236:239], v9, s[12:15], s40 offen offset:0 sc1
    s_waitcnt lgkmcnt(0)
    v_mfma_f32_16x16x32_bf16 v[60:63], a[116:119], a[88:91], v[60:63]
    v_mfma_f32_16x16x32_bf16 v[60:63], a[164:167], v[220:223], v[60:63]
    v_mfma_f32_16x16x32_bf16 v[60:63], a[56:59], a[108:111], v[60:63]
    buffer_load_dwordx4 v[184:187], v9, s[12:15], s40 offen offset:1024 sc1
    v_mfma_f32_16x16x32_bf16 v[60:63], a[216:219], a[16:19], v[60:63]
    v_mfma_f32_16x16x32_bf16 v[60:63], a[172:175], v[232:235], v[60:63]
    v_mfma_f32_16x16x32_bf16 v[32:35], v[116:119], a[120:123], 0
    buffer_load_dword v7, v3, s[24:27], s51 offen sc1
    v_mfma_f32_16x16x32_bf16 v[32:35], v[136:139], a[124:127], v[32:35]
    buffer_load_dwordx4 a[52:55], v9, s[12:15], s40 offen offset:2048 sc1
    v_mfma_f32_16x16x32_bf16 v[32:35], a[228:231], a[64:67], v[32:35]
    s_add_u32 s35, s28, 4
    s_and_b32 s35, s35, 7
    v_mfma_f32_16x16x32_bf16 v[32:35], a[84:87], a[132:135], v[32:35]
    s_lshl_b32 s35, s35, 2
    v_mfma_f32_16x16x32_bf16 v[32:35], v[244:247], a[136:139], v[32:35]
    s_add_u32 s35, s35, s30
    s_lshl_b32 s54, s35, 7
    v_mfma_f32_16x16x32_bf16 v[32:35], v[196:199], a[140:143], v[32:35]
    s_lshl_b32 s35, s35, 11
    s_add_u32 s35, s35, 8388608
    v_mfma_f32_16x16x32_bf16 v[36:39], v[116:119], a[144:147], 0
    s_add_u32 s36, s35, 1024
    v_cvt_pk_bf16_f32 v28, v48, v49
    v_mfma_f32_16x16x32_bf16 v[36:39], v[136:139], a[192:195], v[36:39]
    v_cvt_pk_bf16_f32 v29, v50, v51
    v_cvt_pk_bf16_f32 v30, v52, v53
    v_mfma_f32_16x16x32_bf16 v[36:39], a[228:231], a[152:155], v[36:39]
    v_cvt_pk_bf16_f32 v31, v54, v55
    buffer_store_dwordx4 v[28:31], v9, s[4:7], s35 offen sc1
    v_mfma_f32_16x16x32_bf16 v[36:39], a[84:87], a[156:159], v[36:39]
    v_mfma_f32_16x16x32_bf16 v[36:39], v[244:247], a[160:163], v[36:39]
    v_mfma_f32_16x16x32_bf16 v[36:39], v[196:199], a[168:171], v[36:39]
    v_mfma_f32_16x16x32_bf16 v[40:43], v[116:119], a[80:83], 0
    v_mfma_f32_16x16x32_bf16 v[40:43], v[136:139], a[176:179], v[40:43]
    buffer_load_dwordx4 a[220:223], v9, s[12:15], s40 offen offset:3072 sc1
    v_mfma_f32_16x16x32_bf16 v[40:43], a[228:231], a[180:183], v[40:43]
    v_mfma_f32_16x16x32_bf16 v[40:43], a[84:87], a[184:187], v[40:43]
    v_mfma_f32_16x16x32_bf16 v[40:43], v[244:247], a[188:191], v[40:43]
    s_add_u32 s40, s40, 4096
    buffer_load_dwordx4 a[252:255], v9, s[12:15], s40 offen offset:0 sc1
    v_mfma_f32_16x16x32_bf16 v[40:43], v[196:199], a[248:251], v[40:43]
    v_cvt_pk_bf16_f32 v20, v56, v57
    v_cvt_pk_bf16_f32 v21, v58, v59
    v_mfma_f32_16x16x32_bf16 v[44:47], v[116:119], a[200:203], 0
    v_cvt_pk_bf16_f32 v22, v60, v61
    v_cvt_pk_bf16_f32 v23, v62, v63
    v_mfma_f32_16x16x32_bf16 v[44:47], v[136:139], a[204:207], v[44:47]
    buffer_store_dwordx4 v[20:23], v9, s[4:7], s36 offen sc1
    v_mfma_f32_16x16x32_bf16 v[44:47], a[228:231], v[104:107], v[44:47]
    v_mfma_f32_16x16x32_bf16 v[44:47], a[84:87], v[108:111], v[44:47]
    v_mfma_f32_16x16x32_bf16 v[44:47], v[244:247], v[240:243], v[44:47]
    v_mfma_f32_16x16x32_bf16 v[44:47], v[196:199], v[120:123], v[44:47]
    v_mfma_f32_16x16x32_bf16 v[32:35], v[164:167], v[124:127], v[32:35]
    v_mfma_f32_16x16x32_bf16 v[32:35], a[148:151], v[128:131], v[32:35]
    v_mfma_f32_16x16x32_bf16 v[32:35], a[4:7], v[132:135], v[32:35]
    v_mfma_f32_16x16x32_bf16 v[32:35], a[20:23], a[104:107], v[32:35]
    s_waitcnt vmcnt(23)
    v_mfma_f32_16x16x32_bf16 v[32:35], a[24:27], v[144:147], v[32:35]
    buffer_load_dwordx4 a[240:243], v9, s[12:15], s40 offen offset:1024 sc1
    v_mfma_f32_16x16x32_bf16 v[32:35], v[252:255], a[12:15], v[32:35]
    v_mfma_f32_16x16x32_bf16 v[36:39], v[164:167], v[152:155], v[36:39]
    v_mfma_f32_16x16x32_bf16 v[36:39], a[148:151], v[156:159], v[36:39]
    buffer_load_dwordx4 a[112:115], v9, s[12:15], s40 offen offset:2048 sc1
    v_mfma_f32_16x16x32_bf16 v[36:39], a[4:7], v[192:195], v[36:39]
    s_waitcnt vmcnt(21)
    v_mfma_f32_16x16x32_bf16 v[36:39], a[20:23], v[168:171], v[36:39]
    buffer_store_dword v5, v1, s[24:27], s55 offen offset:12 sc1
    v_mfma_f32_16x16x32_bf16 v[36:39], a[24:27], a[48:51], v[36:39]
    v_mfma_f32_16x16x32_bf16 v[36:39], v[252:255], v[176:179], v[36:39]
    buffer_load_dwordx4 a[116:119], v9, s[12:15], s40 offen offset:3072 sc1
    v_mfma_f32_16x16x32_bf16 v[40:43], v[164:167], v[180:183], v[40:43]
    v_mfma_f32_16x16x32_bf16 v[40:43], a[148:151], v[160:163], v[40:43]
    ds_read_b128 a[88:91], v11 offset:11264
    v_mfma_f32_16x16x32_bf16 v[40:43], a[4:7], v[188:191], v[40:43]
    s_add_u32 s40, s40, 4096
    buffer_load_dwordx4 a[164:167], v9, s[12:15], s40 offen offset:0 sc1
    v_mfma_f32_16x16x32_bf16 v[40:43], a[20:23], a[208:211], v[40:43]
    v_mfma_f32_16x16x32_bf16 v[40:43], a[24:27], v[200:203], v[40:43]
    ds_read_b64_tr_b16 a[56:57], v8 offset:4096
    ds_read_b64_tr_b16 a[58:59], v8 offset:6144
    s_waitcnt vmcnt(10)
    v_cmp_ne_u32 vcc, s58, v7
    s_and_b32 s37, vcc_lo, 0x4
    s_cbranch_scc1 L_chk_P2_spin
L_chk_P2:
    v_mfma_f32_16x16x32_bf16 v[40:43], v[252:255], v[204:207], v[40:43]
    s_add_u32 s37, s50, 4194304
    buffer_load_dwordx4 v[12:15], v9, s[4:7], s37 offen offset:0 sc1
    v_mfma_f32_16x16x32_bf16 v[44:47], v[164:167], a[40:43], v[44:47]
    ds_read_b128 a[216:219], v11 offset:28672
    ds_read_b64_tr_b16 a[172:173], v8 offset:8192
    ds_read_b64_tr_b16 a[174:175], v8 offset:10240
    v_mfma_f32_16x16x32_bf16 v[44:47], a[148:151], v[212:215], v[44:47]
    v_mfma_f32_16x16x32_bf16 v[44:47], a[4:7], a[28:31], v[44:47]
    v_mfma_f32_16x16x32_bf16 v[44:47], a[20:23], v[224:227], v[44:47]
    v_mfma_f32_16x16x32_bf16 v[44:47], a[24:27], v[228:231], v[44:47]
    s_waitcnt lgkmcnt(5)
    v_mfma_f32_16x16x32_bf16 v[44:47], v[252:255], a[88:91], v[44:47]
    ds_read_b128 v[116:119], v11 offset:25600
    v_mfma_f32_16x16x32_bf16 v[32:35], a[0:3], v[236:239], v[32:35]
    v_mfma_f32_16x16x32_bf16 v[32:35], a[76:79], a[32:35], v[32:35]
    buffer_load_dwordx4 v[136:139], v9, s[12:15], s40 offen offset:1024 sc1
    v_mfma_f32_16x16x32_bf16 v[32:35], a[60:63], v[248:251], v[32:35]
    v_mfma_f32_16x16x32_bf16 v[32:35], v[216:219], a[128:131], v[32:35]
    s_waitcnt lgkmcnt(4)
    s_waitcnt lgkmcnt(3)
    v_mfma_f32_16x16x32_bf16 v[32:35], a[56:59], a[216:219], v[32:35]
    ds_read_b128 a[228:231], v11 offset:22528
    s_waitcnt lgkmcnt(2)
    v_mfma_f32_16x16x32_bf16 v[32:35], a[172:175], a[196:199], v[32:35]
    s_add_u32 s40, s40, 4096
    buffer_load_dwordx4 a[84:87], v9, s[12:15], s40 offen offset:0 sc1
    v_mfma_f32_16x16x32_bf16 v[36:39], a[0:3], a[92:95], v[36:39]
    v_mfma_f32_16x16x32_bf16 v[36:39], a[76:79], a[212:215], v[36:39]
    buffer_load_dwordx4 v[16:19], v9, s[4:7], s37 offen offset:1024 sc1
    v_mfma_f32_16x16x32_bf16 v[36:39], a[60:63], a[36:39], v[36:39]
    s_waitcnt lgkmcnt(1)
    v_mfma_f32_16x16x32_bf16 v[36:39], v[216:219], v[116:119], v[36:39]
    ds_read_b128 v[244:247], v11 offset:19456
    v_mfma_f32_16x16x32_bf16 v[36:39], a[56:59], v[112:115], v[36:39]
    v_mfma_f32_16x16x32_bf16 v[36:39], a[172:175], a[100:103], v[36:39]
    v_mfma_f32_16x16x32_bf16 v[64:67], v[86:89], v[96:99], v[64:67]
    v_mfma_f32_16x16x32_bf16 v[68:71], v[84:87], v[96:99], v[68:71]
    v_mfma_f32_16x16x32_bf16 v[72:75], v[86:89], v[100:103], v[72:75]
    v_mfma_f32_16x16x32_bf16 v[76:79], v[84:87], v[100:103], v[76:79]
    v_mfma_f32_16x16x32_bf16 v[40:43], a[0:3], v[140:143], v[40:43]
    v_mfma_f32_16x16x32_bf16 v[40:43], a[76:79], v[148:151], v[40:43]
    s_waitcnt lgkmcnt(1)
    v_mfma_f32_16x16x32_bf16 v[40:43], a[60:63], a[228:231], v[40:43]
    v_mfma_f32_16x16x32_bf16 v[40:43], v[216:219], v[172:175], v[40:43]
    buffer_load_dwordx4 v[196:199], v9, s[12:15], s40 offen offset:1024 sc1
    v_mfma_f32_16x16x32_bf16 v[40:43], a[56:59], a[68:71], v[40:43]
    v_mfma_f32_16x16x32_bf16 v[40:43], a[172:175], a[8:11], v[40:43]
    v_mfma_f32_16x16x32_bf16 v[44:47], a[0:3], a[44:47], v[44:47]
    buffer_load_dwordx4 v[164:167], v9, s[12:15], s40 offen offset:2048 sc1
    s_waitcnt lgkmcnt(0)
    v_mfma_f32_16x16x32_bf16 v[44:47], a[76:79], v[244:247], v[44:47]
    v_mfma_f32_16x16x32_bf16 v[44:47], a[60:63], v[220:223], v[44:47]
    v_mfma_f32_16x16x32_bf16 v[44:47], v[216:219], a[108:111], v[44:47]
    buffer_load_dwordx4 a[148:151], v9, s[12:15], s40 offen offset:3072 sc1
    v_mfma_f32_16x16x32_bf16 v[44:47], a[56:59], a[16:19], v[44:47]
    v_mfma_f32_16x16x32_bf16 v[44:47], a[172:175], v[232:235], v[44:47]
    v_mfma_f32_16x16x32_bf16 v[48:51], a[232:235], a[120:123], 0
    buffer_load_dword v7, v3, s[24:27], s51 offen sc1
    v_mfma_f32_16x16x32_bf16 v[48:51], v[208:211], a[124:127], v[48:51]
    s_add_u32 s40, s40, 4096
    buffer_load_dwordx4 a[4:7], v9, s[12:15], s40 offen offset:0 sc1
    v_mfma_f32_16x16x32_bf16 v[48:51], a[244:247], a[64:67], v[48:51]
    s_add_u32 s35, s28, 5
    s_and_b32 s35, s35, 7
    v_mfma_f32_16x16x32_bf16 v[48:51], a[72:75], a[132:135], v[48:51]
    s_lshl_b32 s35, s35, 2
    v_mfma_f32_16x16x32_bf16 v[48:51], a[224:227], a[136:139], v[48:51]
    s_add_u32 s35, s35, s30
    s_lshl_b32 s55, s35, 7
    v_mfma_f32_16x16x32_bf16 v[48:51], a[96:99], a[140:143], v[48:51]
    s_lshl_b32 s35, s35, 11
    s_add_u32 s35, s35, 10485760
    v_mfma_f32_16x16x32_bf16 v[52:55], a[232:235], a[144:147], 0
    s_add_u32 s36, s35, 1024
    v_cvt_pk_bf16_f32 v28, v32, v33
    v_mfma_f32_16x16x32_bf16 v[52:55], v[208:211], a[192:195], v[52:55]
    v_cvt_pk_bf16_f32 v29, v34, v35
    v_cvt_pk_bf16_f32 v30, v36, v37
    v_mfma_f32_16x16x32_bf16 v[52:55], a[244:247], a[152:155], v[52:55]
    v_cvt_pk_bf16_f32 v31, v38, v39
    buffer_store_dwordx4 v[28:31], v9, s[4:7], s35 offen sc1
    v_mfma_f32_16x16x32_bf16 v[52:55], a[72:75], a[156:159], v[52:55]
    v_mfma_f32_16x16x32_bf16 v[52:55], a[224:227], a[160:163], v[52:55]
    v_mfma_f32_16x16x32_bf16 v[52:55], a[96:99], a[168:171], v[52:55]
    v_mfma_f32_16x16x32_bf16 v[56:59], a[232:235], a[80:83], 0
    v_mfma_f32_16x16x32_bf16 v[56:59], v[208:211], a[176:179], v[56:59]
    buffer_load_dwordx4 a[20:23], v9, s[12:15], s40 offen offset:1024 sc1
    v_mfma_f32_16x16x32_bf16 v[56:59], a[244:247], a[180:183], v[56:59]
    v_mfma_f32_16x16x32_bf16 v[56:59], a[72:75], a[184:187], v[56:59]
    v_mfma_f32_16x16x32_bf16 v[56:59], a[224:227], a[188:191], v[56:59]
    buffer_load_dwordx4 a[24:27], v9, s[12:15], s40 offen offset:2048 sc1
    v_mfma_f32_16x16x32_bf16 v[56:59], a[96:99], a[248:251], v[56:59]
    v_cvt_pk_bf16_f32 v20, v40, v41
    v_cvt_pk_bf16_f32 v21, v42, v43
    v_mfma_f32_16x16x32_bf16 v[60:63], a[232:235], a[200:203], 0
    v_cvt_pk_bf16_f32 v22, v44, v45
    v_cvt_pk_bf16_f32 v23, v46, v47
    v_mfma_f32_16x16x32_bf16 v[60:63], v[208:211], a[204:207], v[60:63]
    buffer_store_dwordx4 v[20:23], v9, s[4:7], s36 offen sc1
    v_mfma_f32_16x16x32_bf16 v[60:63], a[244:247], v[104:107], v[60:63]
    v_mfma_f32_16x16x32_bf16 v[60:63], a[72:75], v[108:111], v[60:63]
    v_mfma_f32_16x16x32_bf16 v[60:63], a[224:227], v[240:243], v[60:63]
    v_mfma_f32_16x16x32_bf16 v[60:63], a[96:99], v[120:123], v[60:63]
    v_mfma_f32_16x16x32_bf16 v[48:51], a[236:239], v[124:127], v[48:51]
    v_mfma_f32_16x16x32_bf16 v[48:51], v[184:187], v[128:131], v[48:51]
    s_waitcnt vmcnt(20)
    v_mfma_f32_16x16x32_bf16 v[48:51], a[52:55], v[132:135], v[48:51]
    v_mfma_f32_16x16x32_bf16 v[48:51], a[220:223], a[104:107], v[48:51]
    s_waitcnt vmcnt(17)
    v_mfma_f32_16x16x32_bf16 v[48:51], a[252:255], v[144:147], v[48:51]
    buffer_load_dwordx4 v[252:255], v9, s[12:15], s40 offen offset:3072 sc1
    v_mfma_f32_16x16x32_bf16 v[48:51], a[240:243], a[12:15], v[48:51]
    v_mfma_f32_16x16x32_bf16 v[52:55], a[236:239], v[152:155], v[52:55]
    v_mfma_f32_16x16x32_bf16 v[52:55], v[184:187], v[156:159], v[52:55]
    s_add_u32 s40, s40, 4096
    buffer_load_dwordx4 a[0:3], v9, s[12:15], s40 offen offset:0 sc1
    v_mfma_f32_16x16x32_bf16 v[52:55], a[52:55], v[192:195], v[52:55]
    v_mfma_f32_16x16x32_bf16 v[52:55], a[220:223], v[168:171], v[52:55]
    buffer_store_dword v5, v1, s[24:27], s54 offen offset:16 sc1
    v_mfma_f32_16x16x32_bf16 v[52:55], a[252:255], a[48:51], v[52:55]
    v_mfma_f32_16x16x32_bf16 v[52:55], a[240:243], v[176:179], v[52:55]
    buffer_load_dwordx4 a[76:79], v9, s[12:15], s40 offen offset:1024 sc1
    v_mfma_f32_16x16x32_bf16 v[56:59], a[236:239], v[180:183], v[56:59]
    v_mfma_f32_16x16x32_bf16 v[56:59], v[184:187], v[160:163], v[56:59]
    v_mfma_f32_16x16x32_bf16 v[56:59], a[52:55], v[188:191], v[56:59]
    buffer_load_dwordx4 a[60:63], v9, s[12:15], s40 offen offset:2048 sc1
    v_mfma_f32_16x16x32_bf16 v[56:59], a[220:223], a[208:211], v[56:59]
    v_mfma_f32_16x16x32_bf16 v[56:59], a[252:255], v[200:203], v[56:59]
    ds_read_b64_tr_b16 v[216:217], v8 offset:12288
    ds_read_b64_tr_b16 v[218:219], v8 offset:14336
    s_waitcnt vmcnt(10)
    v_cmp_ne_u32 vcc, s58, v7
    s_and_b32 s37, vcc_lo, 0x8
    s_cbranch_scc1 L_chk_P3_spin
L_chk_P3:
    v_mfma_f32_16x16x32_bf16 v[56:59], a[240:243], v[204:207], v[56:59]
    s_add_u32 s37, s50, 6291456
    buffer_load_dwordx4 v[96:99], v9, s[4:7], s37 offen offset:0 sc1
L_pg9:
    s_cbranch_execz L_wret1
    s_nop 0
    v_mfma_f32_16x16x32_bf16 v[60:63], a[236:239], a[40:43], v[60:63]
    ds_read_b64_tr_b16 a[56:57], v8 offset:16384
    ds_read_b64_tr_b16 a[58:59], v8 offset:18432
    v_mfma_f32_16x16x32_bf16 v[60:63], v[184:187], v[212:215], v[60:63]
    v_mfma_f32_16x16x32_bf16 v[60:63], a[52:55], a[28:31], v[60:63]
    v_mfma_f32_16x16x32_bf16 v[60:63], a[220:223], v[224:227], v[60:63]
    v_mfma_f32_16x16x32_bf16 v[60:63], a[252:255], v[228:231], v[60:63]
    v_mfma_f32_16x16x32_bf16 v[60:63], a[240:243], a[88:91], v[60:63]
    v_mfma_f32_16x16x32_bf16 v[48:51], a[112:115], v[236:239], v[48:51]
    v_mfma_f32_16x16x32_bf16 v[48:51], a[116:119], a[32:35], v[48:51]
    buffer_load_dwordx4 a[172:175], v9, s[12:15], s40 offen offset:3072 sc1
    v_mfma_f32_16x16x32_bf16 v[48:51], a[164:167], v[248:251], v[48:51]
    v_mfma_f32_16x16x32_bf16 v[48:51], v[136:139], a[128:131], v[48:51]
    s_waitcnt lgkmcnt(2)
    v_mfma_f32_16x16x32_bf16 v[48:51], v[216:219], a[216:219], v[48:51]
    s_add_u32 s40, s40, 4096
    buffer_load_dwordx4 a[232:235], v9, s[12:15], s40 offen offset:0 sc1
    s_waitcnt lgkmcnt(0)
    v_mfma_f32_16x16x32_bf16 v[48:51], a[56:59], a[196:199], v[48:51]
    v_mfma_f32_16x16x32_bf16 v[52:55], a[112:115], a[92:95], v[52:55]
    v_mfma_f32_16x16x32_bf16 v[52:55], a[116:119], a[212:215], v[52:55]
    buffer_load_dwordx4 v[100:103], v9, s[4:7], s37 offen offset:1024 sc1
    v_mfma_f32_16x16x32_bf16 v[52:55], a[164:167], a[36:39], v[52:55]
    v_mfma_f32_16x16x32_bf16 v[52:55], v[136:139], v[116:119], v[52:55]
    v_mfma_f32_16x16x32_bf16 v[52:55], v[216:219], v[112:115], v[52:55]
    v_mfma_f32_16x16x32_bf16 v[52:55], a[56:59], a[100:103], v[52:55]
    v_mfma_f32_16x16x32_bf16 v[64:67], v[86:89], v[12:15], v[64:67]
    v_mfma_f32_16x16x32_bf16 v[68:71], v[84:87], v[12:15], v[68:71]
    v_mfma_f32_16x16x32_bf16 v[72:75], v[86:89], v[16:19], v[72:75]
    v_mfma_f32_16x16x32_bf16 v[76:79], v[84:87], v[16:19], v[76:79]
    v_mfma_f32_16x16x32_bf16 v[56:59], a[112:115], v[140:143], v[56:59]
    v_mfma_f32_16x16x32_bf16 v[56:59], a[116:119], v[148:151], v[56:59]
    v_mfma_f32_16x16x32_bf16 v[56:59], a[164:167], a[228:231], v[56:59]
    v_mfma_f32_16x16x32_bf16 v[56:59], v[136:139], v[172:175], v[56:59]
    buffer_load_dwordx4 v[208:211], v9, s[12:15], s40 offen offset:1024 sc1
    v_mfma_f32_16x16x32_bf16 v[56:59], v[216:219], a[68:71], v[56:59]
    v_mfma_f32_16x16x32_bf16 v[56:59], a[56:59], a[8:11], v[56:59]
    v_mfma_f32_16x16x32_bf16 v[60:63], a[112:115], a[44:47], v[60:63]
    buffer_load_dwordx4 a[244:247], v9, s[12:15], s40 offen offset:2048 sc1
    v_mfma_f32_16x16x32_bf16 v[60:63], a[116:119], v[244:247], v[60:63]
    v_mfma_f32_16x16x32_bf16 v[60:63], a[164:167], v[220:223], v[60:63]
    v_mfma_f32_16x16x32_bf16 v[60:63], v[136:139], a[108:111], v[60:63]
    buffer_load_dwordx4 a[72:75], v9, s[12:15], s40 offen offset:3072 sc1
    v_mfma_f32_16x16x32_bf16 v[60:63], v[216:219], a[16:19], v[60:63]
    v_mfma_f32_16x16x32_bf16 v[60:63], a[56:59], v[232:235], v[60:63]
    v_mfma_f32_16x16x32_bf16 v[32:35], a[84:87], a[120:123], 0
    buffer_load_dword v7, v3, s[24:27], s51 offen sc1
    v_mfma_f32_16x16x32_bf16 v[32:35], v[196:199], a[124:127], v[32:35]
    s_add_u32 s40, s40, 4096
    buffer_load_dwordx4 a[224:227], v9, s[12:15], s40 offen offset:2048 sc1
    v_mfma_f32_16x16x32_bf16 v[32:35], v[164:167], a[64:67], v[32:35]
    s_add_u32 s35, s28, 6
    s_and_b32 s35, s35, 7
    v_mfma_f32_16x16x32_bf16 v[32:35], a[148:151], a[132:135], v[32:35]
    s_lshl_b32 s35, s35, 2
    s_waitcnt vmcnt(16)
    v_mfma_f32_16x16x32_bf16 v[32:35], a[4:7], a[136:139], v[32:35]
    s_add_u32 s35, s35, s30
    s_lshl_b32 s54, s35, 7
    v_mfma_f32_16x16x32_bf16 v[32:35], a[20:23], a[140:143], v[32:35]
    s_lshl_b32 s35, s35, 11
    s_add_u32 s35, s35, 12582912
    v_mfma_f32_16x16x32_bf16 v[36:39], a[84:87], a[144:147], 0
    s_add_u32 s36, s35, 1024
    v_cvt_pk_bf16_f32 v28, v48, v49
    v_mfma_f32_16x16x32_bf16 v[36:39], v[196:199], a[192:195], v[36:39]
    v_cvt_pk_bf16_f32 v29, v50, v51
    v_cvt_pk_bf16_f32 v30, v52, v53
    v_mfma_f32_16x16x32_bf16 v[36:39], v[164:167], a[152:155], v[36:39]
    v_cvt_pk_bf16_f32 v31, v54, v55
    buffer_store_dwordx4 v[28:31], v9, s[4:7], s35 offen sc1
    v_mfma_f32_16x16x32_bf16 v[36:39], a[148:151], a[156:159], v[36:39]
    v_mfma_f32_16x16x32_bf16 v[36:39], a[4:7], a[160:163], v[36:39]
    v_mfma_f32_16x16x32_bf16 v[36:39], a[20:23], a[168:171], v[36:39]
    v_mfma_f32_16x16x32_bf16 v[40:43], a[84:87], a[80:83], 0
    v_mfma_f32_16x16x32_bf16 v[40:43], v[196:199], a[176:179], v[40:43]
    buffer_load_dwordx4 a[96:99], v9, s[12:15], s40 offen offset:3072 sc1
    v_mfma_f32_16x16x32_bf16 v[40:43], v[164:167], a[180:183], v[40:43]
    v_mfma_f32_16x16x32_bf16 v[40:43], a[148:151], a[184:187], v[40:43]
    v_mfma_f32_16x16x32_bf16 v[40:43], a[4:7], a[188:191], v[40:43]
    s_add_u32 s40, s40, 4096
    buffer_load_dwordx4 a[236:239], v9, s[12:15], s40 offen offset:0 sc1
    v_mfma_f32_16x16x32_bf16 v[40:43], a[20:23], a[248:251], v[40:43]
    v_cvt_pk_bf16_f32 v20, v56, v57
    v_cvt_pk_bf16_f32 v21, v58, v59
    v_mfma_f32_16x16x32_bf16 v[44:47], a[84:87], a[200:203], 0
    v_cvt_pk_bf16_f32 v22, v60, v61
    v_cvt_pk_bf16_f32 v23, v62, v63
    v_mfma_f32_16x16x32_bf16 v[44:47], v[196:199], a[204:207], v[44:47]
    buffer_store_dwordx4 v[20:23], v9, s[4:7], s36 offen sc1
    v_mfma_f32_16x16x32_bf16 v[44:47], v[164:167], v[104:107], v[44:47]
    v_mfma_f32_16x16x32_bf16 v[44:47], a[148:151], v[108:111], v[44:47]
    v_mfma_f32_16x16x32_bf16 v[44:47], a[4:7], v[240:243], v[44:47]
    v_mfma_f32_16x16x32_bf16 v[44:47], a[20:23], v[120:123], v[44:47]
    s_waitcnt vmcnt(17)
    v_mfma_f32_16x16x32_bf16 v[32:35], a[24:27], v[124:127], v[32:35]
    v_mfma_f32_16x16x32_bf16 v[32:35], v[252:255], v[128:131], v[32:35]
    s_waitcnt vmcnt(14)
    v_mfma_f32_16x16x32_bf16 v[32:35], a[0:3], v[132:135], v[32:35]
    v_mfma_f32_16x16x32_bf16 v[32:35], a[76:79], a[104:107], v[32:35]
    s_waitcnt vmcnt(11)
    v_mfma_f32_16x16x32_bf16 v[32:35], a[60:63], v[144:147], v[32:35]
    buffer_load_dwordx4 v[184:187], v9, s[12:15], s40 offen offset:1024 sc1
    v_mfma_f32_16x16x32_bf16 v[32:35], a[172:175], a[12:15], v[32:35]
    v_mfma_f32_16x16x32_bf16 v[36:39], a[24:27], v[152:155], v[36:39]
    v_mfma_f32_16x16x32_bf16 v[36:39], v[252:255], v[156:159], v[36:39]
    buffer_load_dwordx4 a[52:55], v9, s[12:15], s40 offen offset:2048 sc1
    v_mfma_f32_16x16x32_bf16 v[36:39], a[0:3], v[192:195], v[36:39]
    v_mfma_f32_16x16x32_bf16 v[36:39], a[76:79], v[168:171], v[36:39]
    buffer_store_dword v5, v1, s[24:27], s55 offen offset:20 sc1
    v_mfma_f32_16x16x32_bf16 v[36:39], a[60:63], a[48:51], v[36:39]
    v_mfma_f32_16x16x32_bf16 v[36:39], a[172:175], v[176:179], v[36:39]
    buffer_load_dwordx4 a[220:223], v9, s[12:15], s40 offen offset:3072 sc1
    v_mfma_f32_16x16x32_bf16 v[40:43], a[24:27], v[180:183], v[40:43]
    v_mfma_f32_16x16x32_bf16 v[40:43], v[252:255], v[160:163], v[40:43]
    v_mfma_f32_16x16x32_bf16 v[40:43], a[0:3], v[188:191], v[40:43]
    s_add_u32 s40, s40, 4096
    buffer_load_dwordx4 a[252:255], v9, s[12:15], s40 offen offset:0 sc1
    v_mfma_f32_16x16x32_bf16 v[40:43], a[76:79], a[208:211], v[40:43]
    v_mfma_f32_16x16x32_bf16 v[40:43], a[60:63], v[200:203], v[40:43]
    ds_read_b64_tr_b16 a[240:241], v8 offset:20480
    ds_read_b64_tr_b16 a[242:243], v8 offset:22528
    s_waitcnt vmcnt(10)
    v_cmp_ne_u32 vcc, s58, v7
    s_and_b32 s37, vcc_lo, 0x10
    s_cbranch_scc1 L_chk_P4_spin
L_chk_P4:
    v_mfma_f32_16x16x32_bf16 v[40:43], a[172:175], v[204:207], v[40:43]
    s_add_u32 s37, s50, 8388608
    buffer_load_dwordx4 v[12:15], v9, s[4:7], s37 offen offset:0 sc1
    v_mfma_f32_16x16x32_bf16 v[44:47], a[24:27], a[40:43], v[44:47]
    ds_read_b64_tr_b16 a[112:113], v8 offset:24576
    ds_read_b64_tr_b16 a[114:115], v8 offset:26624
    v_mfma_f32_16x16x32_bf16 v[44:47], v[252:255], v[212:215], v[44:47]
    v_mfma_f32_16x16x32_bf16 v[44:47], a[0:3], a[28:31], v[44:47]
    v_mfma_f32_16x16x32_bf16 v[44:47], a[76:79], v[224:227], v[44:47]
    v_mfma_f32_16x16x32_bf16 v[44:47], a[60:63], v[228:231], v[44:47]
    v_mfma_f32_16x16x32_bf16 v[44:47], a[172:175], a[88:91], v[44:47]
    v_mfma_f32_16x16x32_bf16 v[32:35], a[232:235], v[236:239], v[32:35]
    v_mfma_f32_16x16x32_bf16 v[32:35], v[208:211], a[32:35], v[32:35]
    buffer_load_dwordx4 a[116:119], v9, s[12:15], s40 offen offset:1024 sc1
    v_mfma_f32_16x16x32_bf16 v[32:35], a[244:247], v[248:251], v[32:35]
    v_mfma_f32_16x16x32_bf16 v[32:35], a[72:75], a[128:131], v[32:35]
    s_waitcnt lgkmcnt(2)
    v_mfma_f32_16x16x32_bf16 v[32:35], a[240:243], a[216:219], v[32:35]
    buffer_load_dwordx4 a[164:167], v9, s[12:15], s40 offen offset:2048 sc1
    s_waitcnt lgkmcnt(0)
    v_mfma_f32_16x16x32_bf16 v[32:35], a[112:115], a[196:199], v[32:35]
    v_mfma_f32_16x16x32_bf16 v[36:39], a[232:235], a[92:95], v[36:39]
    v_mfma_f32_16x16x32_bf16 v[36:39], v[208:211], a[212:215], v[36:39]
    buffer_load_dwordx4 v[16:19], v9, s[4:7], s37 offen offset:1024 sc1
    v_mfma_f32_16x16x32_bf16 v[36:39], a[244:247], a[36:39], v[36:39]
    v_mfma_f32_16x16x32_bf16 v[36:39], a[72:75], v[116:119], v[36:39]
    v_mfma_f32_16x16x32_bf16 v[36:39], a[240:243], v[112:115], v[36:39]
    v_mfma_f32_16x16x32_bf16 v[36:39], a[112:115], a[100:103], v[36:39]
    v_mfma_f32_16x16x32_bf16 v[64:67], v[86:89], v[96:99], v[64:67]
    v_mfma_f32_16x16x32_bf16 v[68:71], v[84:87], v[96:99], v[68:71]
    v_mfma_f32_16x16x32_bf16 v[72:75], v[86:89], v[100:103], v[72:75]
    v_mfma_f32_16x16x32_bf16 v[76:79], v[84:87], v[100:103], v[76:79]
    v_mfma_f32_16x16x32_bf16 v[40:43], a[232:235], v[140:143], v[40:43]
    v_mfma_f32_16x16x32_bf16 v[40:43], v[208:211], v[148:151], v[40:43]
    v_mfma_f32_16x16x32_bf16 v[40:43], a[244:247], a[228:231], v[40:43]
    v_mfma_f32_16x16x32_bf16 v[40:43], a[72:75], v[172:175], v[40:43]
    buffer_load_dwordx4 v[136:139], v9, s[12:15], s40 offen offset:3072 sc1
    v_mfma_f32_16x16x32_bf16 v[40:43], a[240:243], a[68:71], v[40:43]
    v_mfma_f32_16x16x32_bf16 v[40:43], a[112:115], a[8:11], v[40:43]
    v_mfma_f32_16x16x32_bf16 v[44:47], a[232:235], a[44:47], v[44:47]
    s_add_u32 s40, s40, 4096
    buffer_load_dwordx4 v[216:219], v9, s[12:15], s40 offen offset:0 sc1
    v_mfma_f32_16x16x32_bf16 v[44:47], v[208:211], v[244:247], v[44:47]
    v_mfma_f32_16x16x32_bf16 v[44:47], a[244:247], v[220:223], v[44:47]
    v_mfma_f32_16x16x32_bf16 v[44:47], a[72:75], a[108:111], v[44:47]
    buffer_load_dwordx4 a[56:59], v9, s[12:15], s40 offen offset:1024 sc1
    v_mfma_f32_16x16x32_bf16 v[44:47], a[240:243], a[16:19], v[44:47]
    v_mfma_f32_16x16x32_bf16 v[44:47], a[112:115], v[232:235], v[44:47]
    s_waitcnt vmcnt(14)
    v_mfma_f32_16x16x32_bf16 v[64:67], a[224:227], a[120:123], v[64:67]
    buffer_load_dword v7, v3, s[24:27], s51 offen sc1
    s_waitcnt vmcnt(13)
    v_mfma_f32_16x16x32_bf16 v[64:67], a[96:99], a[124:127], v[64:67]
    buffer_store_dword v5, v1, s[24:27], s54 offen offset:24 sc1
    s_waitcnt vmcnt(13)
    v_mfma_f32_16x16x32_bf16 v[64:67], a[236:239], a[64:67], v[64:67]
    s_add_u32 s35, s28, 7
    s_and_b32 s35, s35, 7
    v_mfma_f32_16x16x32_bf16 v[64:67], v[184:187], a[132:135], v[64:67]
    s_lshl_b32 s35, s35, 2
    s_waitcnt vmcnt(10)
    v_mfma_f32_16x16x32_bf16 v[64:67], a[52:55], a[136:139], v[64:67]
    s_add_u32 s35, s35, s30
    s_lshl_b32 s55, s35, 7
    v_mfma_f32_16x16x32_bf16 v[64:67], a[220:223], a[140:143], v[64:67]
    s_lshl_b32 s35, s35, 11
    s_add_u32 s35, s35, 14680064
    v_mfma_f32_16x16x32_bf16 v[68:71], a[224:227], a[144:147], v[68:71]
    s_add_u32 s36, s35, 1024
    v_cvt_pk_bf16_f32 v28, v32, v33
    v_mfma_f32_16x16x32_bf16 v[68:71], a[96:99], a[192:195], v[68:71]
    v_cvt_pk_bf16_f32 v29, v34, v35
    v_cvt_pk_bf16_f32 v30, v36, v37
    v_mfma_f32_16x16x32_bf16 v[68:71], a[236:239], a[152:155], v[68:71]
    v_cvt_pk_bf16_f32 v31, v38, v39
    buffer_store_dwordx4 v[28:31], v9, s[4:7], s35 offen sc1
    v_mfma_f32_16x16x32_bf16 v[68:71], v[184:187], a[156:159], v[68:71]
    v_mfma_f32_16x16x32_bf16 v[68:71], a[52:55], a[160:163], v[68:71]
    v_mfma_f32_16x16x32_bf16 v[68:71], a[220:223], a[168:171], v[68:71]
    v_cvt_pk_bf16_f32 v20, v40, v41
    v_cvt_pk_bf16_f32 v21, v42, v43
    v_mfma_f32_16x16x32_bf16 v[72:75], a[224:227], a[80:83], v[72:75]
    v_cvt_pk_bf16_f32 v22, v44, v45
    v_cvt_pk_bf16_f32 v23, v46, v47
    v_mfma_f32_16x16x32_bf16 v[72:75], a[96:99], a[176:179], v[72:75]
    buffer_store_dwordx4 v[20:23], v9, s[4:7], s36 offen sc1
    v_mfma_f32_16x16x32_bf16 v[72:75], a[236:239], a[180:183], v[72:75]
    v_mfma_f32_16x16x32_bf16 v[72:75], v[184:187], a[184:187], v[72:75]
    v_mfma_f32_16x16x32_bf16 v[72:75], a[52:55], a[188:191], v[72:75]
    v_mfma_f32_16x16x32_bf16 v[72:75], a[220:223], a[248:251], v[72:75]
    v_mfma_f32_16x16x32_bf16 v[76:79], a[224:227], a[200:203], v[76:79]
    v_mfma_f32_16x16x32_bf16 v[76:79], a[96:99], a[204:207], v[76:79]
    v_mfma_f32_16x16x32_bf16 v[76:79], a[236:239], v[104:107], v[76:79]
    v_mfma_f32_16x16x32_bf16 v[76:79], v[184:187], v[108:111], v[76:79]
    v_mfma_f32_16x16x32_bf16 v[76:79], a[52:55], v[240:243], v[76:79]
    v_mfma_f32_16x16x32_bf16 v[76:79], a[220:223], v[120:123], v[76:79]
    buffer_load_dwordx4 a[84:87], v9, s[12:15], s40 offen offset:2048 sc1
    s_waitcnt vmcnt(10)
    v_mfma_f32_16x16x32_bf16 v[64:67], a[252:255], v[124:127], v[64:67]
    v_mfma_f32_16x16x32_bf16 v[64:67], a[116:119], v[128:131], v[64:67]
    s_waitcnt vmcnt(7)
    v_mfma_f32_16x16x32_bf16 v[64:67], a[164:167], v[132:135], v[64:67]
    buffer_load_dwordx4 v[196:199], v9, s[12:15], s40 offen offset:3072 sc1
    v_mfma_f32_16x16x32_bf16 v[64:67], v[136:139], a[104:107], v[64:67]
    s_waitcnt vmcnt(6)
    v_mfma_f32_16x16x32_bf16 v[64:67], v[216:219], v[144:147], v[64:67]
    v_mfma_f32_16x16x32_bf16 v[64:67], a[56:59], a[12:15], v[64:67]
    s_add_u32 s40, s40, 4096
    buffer_load_dwordx4 v[164:167], v9, s[12:15], s40 offen offset:0 sc1
    v_mfma_f32_16x16x32_bf16 v[68:71], a[252:255], v[152:155], v[68:71]
    v_mfma_f32_16x16x32_bf16 v[68:71], a[116:119], v[156:159], v[68:71]
    v_mfma_f32_16x16x32_bf16 v[68:71], a[164:167], v[192:195], v[68:71]
    buffer_load_dwordx4 a[148:151], v9, s[12:15], s40 offen offset:1024 sc1
    v_mfma_f32_16x16x32_bf16 v[68:71], v[136:139], v[168:171], v[68:71]
    v_mfma_f32_16x16x32_bf16 v[68:71], v[216:219], a[48:51], v[68:71]
    s_waitcnt vmcnt(7)
    v_cmp_ne_u32 vcc, s58, v7
    s_and_b32 s37, vcc_lo, 0x20
    s_cbranch_scc1 L_chk_P5_spin
L_chk_P5:
    s_add_u32 s37, s50, 10485760
    v_mfma_f32_16x16x32_bf16 v[68:71], a[56:59], v[176:179], v[68:71]
    buffer_load_dwordx4 v[96:99], v9, s[4:7], s37 offen offset:0 sc1
    v_mfma_f32_16x16x32_bf16 v[72:75], a[252:255], v[180:183], v[72:75]
    v_mfma_f32_16x16x32_bf16 v[72:75], a[116:119], v[160:163], v[72:75]
    v_mfma_f32_16x16x32_bf16 v[72:75], a[164:167], v[188:191], v[72:75]
    v_mfma_f32_16x16x32_bf16 v[72:75], v[136:139], a[208:211], v[72:75]
    v_mfma_f32_16x16x32_bf16 v[72:75], v[216:219], v[200:203], v[72:75]
    ds_read_b64_tr_b16 a[4:5], v8 offset:28672
    ds_read_b64_tr_b16 a[6:7], v8 offset:30720
    v_mfma_f32_16x16x32_bf16 v[72:75], a[56:59], v[204:207], v[72:75]
    v_mfma_f32_16x16x32_bf16 v[76:79], a[252:255], a[40:43], v[76:79]
    ds_read_b64_tr_b16 a[20:21], v8 offset:32768
    ds_read_b64_tr_b16 a[22:23], v8 offset:34816
    v_mfma_f32_16x16x32_bf16 v[76:79], a[116:119], v[212:215], v[76:79]
    v_mfma_f32_16x16x32_bf16 v[76:79], a[164:167], a[28:31], v[76:79]
    v_mfma_f32_16x16x32_bf16 v[76:79], v[136:139], v[224:227], v[76:79]
    buffer_load_dwordx4 v[100:103], v9, s[4:7], s37 offen offset:1024 sc1
    v_mfma_f32_16x16x32_bf16 v[76:79], v[216:219], v[228:231], v[76:79]
    v_mfma_f32_16x16x32_bf16 v[76:79], a[56:59], a[88:91], v[76:79]
    s_waitcnt vmcnt(4)
    v_mfma_f32_16x16x32_bf16 v[64:67], a[84:87], v[236:239], v[64:67]
    v_mfma_f32_16x16x32_bf16 v[64:67], v[196:199], a[32:35], v[64:67]
    s_waitcnt vmcnt(2)
    v_mfma_f32_16x16x32_bf16 v[64:67], v[164:167], v[248:251], v[64:67]
    v_mfma_f32_16x16x32_bf16 v[64:67], a[148:151], a[128:131], v[64:67]
    s_waitcnt lgkmcnt(2)
    v_mfma_f32_16x16x32_bf16 v[64:67], a[4:7], a[216:219], v[64:67]
    s_waitcnt lgkmcnt(0)
    v_mfma_f32_16x16x32_bf16 v[64:67], a[20:23], a[196:199], v[64:67]
    v_mfma_f32_16x16x32_bf16 v[68:71], a[84:87], a[92:95], v[68:71]
    buffer_load_dword v7, v3, s[24:27], s51 offen sc1
    v_mfma_f32_16x16x32_bf16 v[68:71], v[196:199], a[212:215], v[68:71]
    v_mfma_f32_16x16x32_bf16 v[68:71], v[164:167], a[36:39], v[68:71]
    v_mfma_f32_16x16x32_bf16 v[68:71], a[148:151], v[116:119], v[68:71]
    v_mfma_f32_16x16x32_bf16 v[68:71], a[4:7], v[112:115], v[68:71]
    v_mfma_f32_16x16x32_bf16 v[68:71], a[20:23], a[100:103], v[68:71]
    v_mfma_f32_16x16x32_bf16 v[64:67], v[86:89], v[12:15], v[64:67]
    v_mfma_f32_16x16x32_bf16 v[68:71], v[84:87], v[12:15], v[68:71]
    v_mfma_f32_16x16x32_bf16 v[72:75], v[86:89], v[16:19], v[72:75]
    v_mfma_f32_16x16x32_bf16 v[76:79], v[84:87], v[16:19], v[76:79]
    v_mfma_f32_16x16x32_bf16 v[72:75], a[84:87], v[140:143], v[72:75]
    v_mfma_f32_16x16x32_bf16 v[72:75], v[196:199], v[148:151], v[72:75]
    v_mfma_f32_16x16x32_bf16 v[72:75], v[164:167], a[228:231], v[72:75]
    v_mfma_f32_16x16x32_bf16 v[72:75], a[148:151], v[172:175], v[72:75]
    v_mfma_f32_16x16x32_bf16 v[72:75], a[4:7], a[68:71], v[72:75]
    v_mfma_f32_16x16x32_bf16 v[72:75], a[20:23], a[8:11], v[72:75]
    v_mfma_f32_16x16x32_bf16 v[76:79], a[84:87], a[44:47], v[76:79]
    v_mfma_f32_16x16x32_bf16 v[76:79], v[196:199], v[244:247], v[76:79]
    v_mfma_f32_16x16x32_bf16 v[76:79], v[164:167], v[220:223], v[76:79]
    v_mfma_f32_16x16x32_bf16 v[76:79], a[148:151], a[108:111], v[76:79]
    v_mfma_f32_16x16x32_bf16 v[76:79], a[4:7], a[16:19], v[76:79]
    v_mfma_f32_16x16x32_bf16 v[76:79], a[20:23], v[232:235], v[76:79]
    s_waitcnt vmcnt(0)
    v_cmp_ne_u32 vcc, s58, v7
    s_and_b32 s37, vcc_lo, 0x40
    s_cbranch_scc1 L_chk_P6_spin
L_chk_P6:
    s_add_u32 s37, s50, 12582912
    buffer_load_dwordx4 v[152:155], v9, s[4:7], s37 offen offset:0 sc1
    buffer_load_dwordx4 v[156:159], v9, s[4:7], s37 offen offset:1024 sc1
    s_add_u32 s37, s50, 14680064
    buffer_load_dwordx4 v[160:163], v9, s[4:7], s37 offen offset:0 sc1
    buffer_load_dwordx4 v[164:167], v9, s[4:7], s37 offen offset:1024 sc1
    v_mfma_f32_16x16x32_bf16 v[64:67], v[86:89], v[96:99], v[64:67]
    v_mfma_f32_16x16x32_bf16 v[68:71], v[84:87], v[96:99], v[68:71]
    v_mfma_f32_16x16x32_bf16 v[72:75], v[86:89], v[100:103], v[72:75]
    v_mfma_f32_16x16x32_bf16 v[76:79], v[84:87], v[100:103], v[76:79]
    v_and_b32 v18, 15, v2
    v_lshl_add_u32 v19, v95, 4, v18
    v_mul_u32_u24 v19, 1152, v19
    s_mul_i32 s38, s29, 73728
    s_lshl_b32 s35, s42, 3
    s_add_u32 s35, s35, 1024
    s_add_u32 s35, s35, s38
    v_bfe_u32 v16, v2, 4, 1
    v_lshl_add_u32 v18, v16, 4, v18
    v_mul_u32_u24 v18, 1152, v18
    v_bfe_u32 v16, v2, 5, 1
    v_lshl_add_u32 v18, v16, 4, v18
    s_lshl_b32 s36, s31, 5
    s_add_u32 s38, s38, s36
    s_add_u32 s39, s38, 36864
    v_mul_f32 v80, v0, v80
    v_mul_f32 v81, v0, v81
    v_mul_f32 v82, v0, v82
    v_mul_f32 v83, v0, v83
    v_cvt_pk_bf16_f32 v116, v80, v81
    v_cvt_pk_bf16_f32 v117, v82, v83
    s_mov_b32 exec_hi, 0
    buffer_store_dwordx2 v[116:117], v19, s[44:47], s35 offen
    s_mov_b64 exec, -1
    s_waitcnt vmcnt(3)
    v_mfma_f32_16x16x32_bf16 v[64:67], v[86:89], v[152:155], v[64:67]
    v_mfma_f32_16x16x32_bf16 v[68:71], v[84:87], v[152:155], v[68:71]
    v_mfma_f32_16x16x32_bf16 v[72:75], v[86:89], v[156:159], v[72:75]
    v_mfma_f32_16x16x32_bf16 v[76:79], v[84:87], v[156:159], v[76:79]
    s_waitcnt vmcnt(1)
    s_mov_b32 s41, 0x40000
L_s7:
    v_max3_u32 v12, v160, v161, v162
    v_max3_u32 v13, v163, v164, v165
    v_max3_u32 v12, v12, v166, v167
    v_max_u32 v12, v12, v13
    v_cmp_eq_u32 vcc, -1, v12
    s_cbranch_vccnz L_s7_spin
L_s7_ok:
    v_mfma_f32_16x16x32_bf16 v[64:67], v[86:89], v[160:163], v[64:67]
    v_mfma_f32_16x16x32_bf16 v[68:71], v[84:87], v[160:163], v[68:71]
    v_mfma_f32_16x16x32_bf16 v[72:75], v[86:89], v[164:167], v[72:75]
    v_mfma_f32_16x16x32_bf16 v[76:79], v[84:87], v[164:167], v[76:79]
    s_nop 4
    v_pk_mul_f32 v[64:65], v[64:65], v[24:25] op_sel:[0,0] op_sel_hi:[1,0]
    v_pk_mul_f32 v[66:67], v[66:67], v[24:25] op_sel:[0,0] op_sel_hi:[1,0]
    v_cvt_pk_bf16_f32 v104, v64, v65
    v_cvt_pk_bf16_f32 v105, v66, v67
    v_pk_mul_f32 v[68:69], v[68:69], v[24:25] op_sel:[0,1] op_sel_hi:[1,1]
    v_pk_mul_f32 v[70:71], v[70:71], v[24:25] op_sel:[0,1] op_sel_hi:[1,1]
    v_cvt_pk_bf16_f32 v106, v68, v69
    v_cvt_pk_bf16_f32 v107, v70, v71
    s_nop 1
    v_permlane16_swap_b32 v104, v106
    v_permlane16_swap_b32 v105, v107
    buffer_store_dwordx4 v[104:107], v18, s[44:47], s38 offen
    v_pk_mul_f32 v[72:73], v[72:73], v[26:27] op_sel:[0,0] op_sel_hi:[1,0]
    v_pk_mul_f32 v[74:75], v[74:75], v[26:27] op_sel:[0,0] op_sel_hi:[1,0]
    v_cvt_pk_bf16_f32 v108, v72, v73
    v_cvt_pk_bf16_f32 v109, v74, v75
    v_pk_mul_f32 v[76:77], v[76:77], v[26:27] op_sel:[0,1] op_sel_hi:[1,1]
    v_pk_mul_f32 v[78:79], v[78:79], v[26:27] op_sel:[0,1] op_sel_hi:[1,1]
    v_cvt_pk_bf16_f32 v110, v76, v77
    v_cvt_pk_bf16_f32 v111, v78, v79
    s_nop 1
    v_permlane16_swap_b32 v108, v110
    v_permlane16_swap_b32 v109, v111
    buffer_store_dwordx4 v[108:111], v18, s[44:47], s39 offen
L_end:
    s_endpgm
L_chk_P0_spin:
    s_mov_b32 s41, 0x40000
L_chk_P0_again:
    buffer_load_dword v7, v3, s[24:27], s51 offen sc1
    s_sub_u32 s41, s41, 1
    s_cmp_eq_u32 s41, 0
    s_cbranch_scc1 L_chk_P0
    s_waitcnt vmcnt(0)
    v_cmp_ne_u32 vcc, s58, v7
    s_and_b32 s37, vcc_lo, 0xff00
    s_cbranch_scc1 L_chk_P0_again
    s_branch L_chk_P0
L_chk_P1_spin:
    s_mov_b32 s41, 0x40000
L_chk_P1_again:
    buffer_load_dword v7, v3, s[24:27], s51 offen sc1
    s_sub_u32 s41, s41, 1
    s_cmp_eq_u32 s41, 0
    s_cbranch_scc1 L_chk_P1
    s_waitcnt vmcnt(0)
    v_cmp_ne_u32 vcc, s58, v7
    s_and_b32 s37, vcc_lo, 0x2
    s_cbranch_scc1 L_chk_P1_again
    s_branch L_chk_P1
L_chk_P2_spin:
    s_mov_b32 s41, 0x40000
L_chk_P2_again:
    buffer_load_dword v7, v3, s[24:27], s51 offen sc1
    s_sub_u32 s41, s41, 1
    s_cmp_eq_u32 s41, 0
    s_cbranch_scc1 L_chk_P2
    s_waitcnt vmcnt(0)
    v_cmp_ne_u32 vcc, s58, v7
    s_and_b32 s37, vcc_lo, 0x4
    s_cbranch_scc1 L_chk_P2_again
    s_branch L_chk_P2
L_chk_P3_spin:
    s_mov_b32 s41, 0x40000
L_chk_P3_again:
    buffer_load_dword v7, v3, s[24:27], s51 offen sc1
    s_sub_u32 s41, s41, 1
    s_cmp_eq_u32 s41, 0
    s_cbranch_scc1 L_chk_P3
    s_waitcnt vmcnt(0)
    v_cmp_ne_u32 vcc, s58, v7
    s_and_b32 s37, vcc_lo, 0x8
    s_cbranch_scc1 L_chk_P3_again
    s_branch L_chk_P3
L_chk_P4_spin:
    s_mov_b32 s41, 0x40000
L_chk_P4_again:
    buffer_load_dword v7, v3, s[24:27], s51 offen sc1
    s_sub_u32 s41, s41, 1
    s_cmp_eq_u32 s41, 0
    s_cbranch_scc1 L_chk_P4
    s_waitcnt vmcnt(0)
    v_cmp_ne_u32 vcc, s58, v7
    s_and_b32 s37, vcc_lo, 0x10
    s_cbranch_scc1 L_chk_P4_again
    s_branch L_chk_P4
L_chk_P5_spin:
    s_mov_b32 s41, 0x40000
L_chk_P5_again:
    buffer_load_dword v7, v3, s[24:27], s51 offen sc1
    s_sub_u32 s41, s41, 1
    s_cmp_eq_u32 s41, 0
    s_cbranch_scc1 L_chk_P5
    s_waitcnt vmcnt(0)
    v_cmp_ne_u32 vcc, s58, v7
    s_and_b32 s37, vcc_lo, 0x20
    s_cbranch_scc1 L_chk_P5_again
    s_branch L_chk_P5
L_chk_P6_spin:
    s_mov_b32 s41, 0x40000
L_chk_P6_again:
    buffer_load_dword v7, v3, s[24:27], s51 offen sc1
    s_sub_u32 s41, s41, 1
    s_cmp_eq_u32 s41, 0
    s_cbranch_scc1 L_chk_P6
    s_waitcnt vmcnt(0)
    v_cmp_ne_u32 vcc, s58, v7
    s_and_b32 s37, vcc_lo, 0x40
    s_cbranch_scc1 L_chk_P6_again
    s_branch L_chk_P6
L_spoll_spin:
    s_sub_u32 s39, s39, 1
    s_cmp_eq_u32 s39, 0
    s_cbranch_scc1 L_spoll_ok
    buffer_load_dwordx4 v[32:35], v4, s[44:47], s48 offen sc1
    buffer_load_dwordx4 v[36:39], v4, s[44:47], s49 offen sc1
    buffer_load_dwordx4 v[40:43], v4, s[44:47], s50 offen sc1
    buffer_load_dwordx4 v[44:47], v4, s[44:47], s51 offen sc1
    s_branch L_spoll
L_s7_spin:
    s_sub_u32 s41, s41, 1
    s_cmp_eq_u32 s41, 0
    s_cbranch_scc1 L_s7_ok
    s_add_u32 s37, s50, 14680064
    buffer_load_dwordx4 v[160:163], v9, s[4:7], s37 offen offset:0 sc1
    buffer_load_dwordx4 v[164:167], v9, s[4:7], s37 offen offset:1024 sc1
    s_waitcnt vmcnt(0)
    s_branch L_s7
L_a_spin:
    s_mov_b32 s41, 0x40000
L_a_again:
    buffer_load_dword v7, v3, s[16:19], s61 offen sc1
    s_sub_u32 s41, s41, 1
    s_cmp_eq_u32 s41, 0
    s_cbranch_scc1 L_a_ok
    s_waitcnt vmcnt(0)
    v_cmp_ne_u32 vcc, s58, v7
    s_cbranch_vccnz L_a_again
    s_branch L_a_ok
.p2align 12
L_other:
    s_waitcnt vmcnt(5)
    v_lshlrev_b32 v28, 16, v16
    v_and_b32 v29, 0xffff0000, v16
    v_lshlrev_b32 v30, 16, v17
    v_and_b32 v31, 0xffff0000, v17
    v_lshlrev_b32 v32, 16, v18
    v_and_b32 v33, 0xffff0000, v18
    v_lshlrev_b32 v34, 16, v20
    v_and_b32 v35, 0xffff0000, v20
    v_lshlrev_b32 v36, 16, v21
    v_and_b32 v37, 0xffff0000, v21
    v_lshlrev_b32 v38, 16, v22
    v_and_b32 v39, 0xffff0000, v22
    v_lshlrev_b32 v40, 16, v24
    v_and_b32 v41, 0xffff0000, v24
    v_lshlrev_b32 v42, 16, v25
    v_and_b32 v43, 0xffff0000, v25
    v_lshlrev_b32 v10, 16, v26
    v_and_b32 v11, 0xffff0000, v26
    v_pk_add_f32 v[16:17], v[28:29], v[30:31]
    v_pk_mul_f32 v[18:19], v[28:29], v[28:29]
    v_pk_fma_f32 v[18:19], v[30:31], v[30:31], v[18:19]
    v_pk_add_f32 v[16:17], v[16:17], v[32:33]
    v_pk_fma_f32 v[18:19], v[32:33], v[32:33], v[18:19]
    v_pk_add_f32 v[16:17], v[16:17], v[34:35]
    v_pk_fma_f32 v[18:19], v[34:35], v[34:35], v[18:19]
    v_pk_add_f32 v[16:17], v[16:17], v[36:37]
    v_pk_fma_f32 v[18:19], v[36:37], v[36:37], v[18:19]
    v_pk_add_f32 v[16:17], v[16:17], v[38:39]
    v_pk_fma_f32 v[18:19], v[38:39], v[38:39], v[18:19]
    v_pk_add_f32 v[16:17], v[16:17], v[40:41]
    v_pk_fma_f32 v[18:19], v[40:41], v[40:41], v[18:19]
    v_pk_add_f32 v[16:17], v[16:17], v[42:43]
    v_pk_fma_f32 v[18:19], v[42:43], v[42:43], v[18:19]
    v_pk_add_f32 v[16:17], v[16:17], v[10:11]
    v_pk_fma_f32 v[18:19], v[10:11], v[10:11], v[18:19]
    v_add_f32 v16, v16, v17
    v_add_f32 v17, v18, v19
    s_nop 0
    v_add_f32_dpp v16, v16, v16 quad_perm:[1,0,3,2] row_mask:0xf bank_mask:0xf
    v_add_f32_dpp v17, v17, v17 quad_perm:[1,0,3,2] row_mask:0xf bank_mask:0xf
    s_nop 0
    v_add_f32_dpp v16, v16, v16 quad_perm:[2,3,0,1] row_mask:0xf bank_mask:0xf
    v_add_f32_dpp v17, v17, v17 quad_perm:[2,3,0,1] row_mask:0xf bank_mask:0xf
    s_nop 0
    v_add_f32_dpp v16, v16, v16 row_half_mirror row_mask:0xf bank_mask:0xf
    v_add_f32_dpp v17, v17, v17 row_half_mirror row_mask:0xf bank_mask:0xf
    s_nop 0
    v_add_f32_dpp v16, v16, v16 row_mirror row_mask:0xf bank_mask:0xf
    v_add_f32_dpp v17, v17, v17 row_mirror row_mask:0xf bank_mask:0xf
    v_mov_b32 v18, v16
    v_mov_b32 v19, v17
    s_add_u32 s44, s22, 10649600
    s_addc_u32 s45, s23, 0
    s_and_b32 s45, s45, 0xffff
    s_mov_b32 s46, 16384
    s_mov_b32 s47, 0x20000
    v_permlane16_swap_b32 v16, v18
    v_permlane16_swap_b32 v17, v19
    v_add_f32 v16, v16, v18
    v_add_f32 v17, v17, v19
    v_mul_f32 v16, 0x3ae38e39, v16
    v_mul_f32 v17, 0x3ae38e39, v17
    v_fma_f32 v17, -v16, v16, v17
    v_max_f32 v17, 0, v17
    v_cvt_pk_bf16_f32 v16, v16, v17
    v_and_b32 v17, 0xffff0000, v16
    v_add_f32 v17, 0x3727c5ac, v17
    v_cvt_pk_bf16_f32 v17, v17, v17
    v_and_b32 v17, 0xffff0000, v17
    v_sqrt_f32 v17, v17
    s_nop 0
    v_cvt_pk_bf16_f32 v17, v17, v17
    v_and_b32 v17, 0xffff0000, v17
    v_and_b32 v16, 0xffff, v16
    v_or_b32 v14, v16, v17
    s_lshl_b32 s36, s30, 12
    s_lshl_b32 s37, s2, 4
    s_add_u32 s36, s36, s37
    v_lshlrev_b32 v8, 3, v8
    s_waitcnt lgkmcnt(0)
    s_add_u32 s58, s58, 1
    v_mov_b32 v15, s58
    s_mov_b32 exec_lo, 1
    s_mov_b32 exec_hi, 1
    buffer_store_dwordx2 v[14:15], v8, s[44:47], s36 offen sc1
    s_mov_b64 exec, -1
    s_barrier
    buffer_load_dword v45, v12, s[52:55], s7 offen
    buffer_load_dword v45, v13, s[52:55], s7 offen offset:1024
    s_lshl_b32 s32, s39, 2
    v_bfe_u32 v104, v2, 3, 2
    v_add_u32 v104, s32, v104
    v_min_u32 v104, 53, v104
    v_mul_u32_u24 v105, 57, v104
    v_lshrrev_b32 v105, 9, v105
    v_mul_u32_u24 v106, 9, v105
    v_sub_u32 v104, v104, v106
    v_add_u32 v105, 10, v105
    s_lshr_b32 s36, s30, 1
    s_lshl_b32 s37, s36, 6
    s_and_b32 s36, s30, 1
    s_lshl_b32 s36, s36, 3
    s_add_u32 s36, s36, s37
    s_mul_i32 s37, s28, 576
    s_add_u32 s36, s36, s37
    v_lshrrev_b32 v106, 2, v105
    v_lshl_add_u32 v106, v106, 4, s36
    v_and_b32 v107, 3, v105
    v_lshl_add_u32 v106, v107, 7, v106
    v_mul_u32_u24 v106, 1152, v106
    v_lshl_add_u32 v26, v104, 7, v106
    v_subrev_u32 v106, s28, v104
    v_add_u32 v106, -1, v106
    v_and_b32 v106, 7, v106
    v_add_u32 v106, 1, v106
    v_cmp_ne_u32 vcc, 8, v104
    v_add_u32 v105, 162, v105
    v_lshlrev_b32 v105, 10, v105
    v_cndmask_b32 v106, 0, v106, vcc
    v_mul_u32_u24 v106, 18432, v106
    v_add_u32 v1, v105, v106
    v_add_u32 v27, v27, v26
    buffer_load_dword v45, v27, s[8:11], 0 offen
    v_lshrrev_b32 v7, 3, v2
    v_mul_u32_u24 v6, 9216, v7
    v_bfe_u32 v7, v2, 1, 2
    v_bfe_u32 v8, v2, 4, 2
    v_xor_b32 v7, v7, v8
    v_lshl_add_u32 v6, v7, 5, v6
    v_and_b32 v7, 1, v2
    v_lshl_add_u32 v6, v7, 4, v6
    v_lshrrev_b32 v7, 3, v2
    v_mul_u32_u24 v10, 1152, v7
    v_bfe_u32 v7, v2, 1, 2
    v_bfe_u32 v8, v2, 4, 2
    v_xor_b32 v7, v7, v8
    v_lshl_add_u32 v10, v7, 5, v10
    v_and_b32 v7, 1, v2
    v_lshl_add_u32 v10, v7, 4, v10
    s_cmp_lt_u32 s39, 4
    s_cselect_b64 vcc, -1, 0
    s_lshl_b32 s34, s30, 10
    v_cndmask_b32 v12, v10, v6, vcc
    v_readlane_b32 s94, v26, 0
    v_readlane_b32 s95, v26, 8
    v_readlane_b32 s96, v26, 16
    v_readlane_b32 s97, v26, 24
    s_add_u32 s16, s22, 10682368
    s_addc_u32 s17, s23, 0
    s_and_b32 s17, s17, 0xffff
    s_mov_b32 s18, 57344
    s_mov_b32 s19, 0x20000
    s_mov_b32 m0, s34
    s_add_u32 s34, s34, 4096
    buffer_load_dwordx4 v6, s[40:43], s6 offen lds
    s_add_u32 s6, s6, 128
    s_mov_b32 m0, s34
    s_add_u32 s34, s34, 4096
    buffer_load_dwordx4 v6, s[40:43], s6 offen lds
    s_add_u32 s6, s6, 128
    s_mov_b32 m0, s34
    s_add_u32 s34, s34, 4096
    buffer_load_dwordx4 v6, s[40:43], s6 offen lds
    s_add_u32 s6, s6, 128
    s_mov_b32 m0, s34
    s_add_u32 s34, s34, 4096
    buffer_load_dwordx4 v6, s[40:43], s6 offen lds
    s_add_u32 s6, s6, 128
    s_mov_b32 m0, s34
    s_add_u32 s34, s34, 4096
    buffer_load_dwordx4 v6, s[40:43], s6 offen lds
    s_add_u32 s6, s6, 128
    s_mov_b32 m0, s34
    s_add_u32 s34, s34, 4096
    buffer_load_dwordx4 v6, s[40:43], s6 offen lds
    s_add_u32 s6, s6, 128
    s_mov_b32 m0, s34
    s_add_u32 s34, s34, 4096
    buffer_load_dwordx4 v6, s[40:43], s6 offen lds
    s_add_u32 s6, s6, 128
    s_mov_b32 m0, s34
    s_add_u32 s34, s34, 4096
    buffer_load_dwordx4 v6, s[40:43], s6 offen lds
    s_add_u32 s6, s6, 128
    s_mov_b32 m0, s34
    s_add_u32 s34, s34, 4096
    buffer_load_dwordx4 v6, s[40:43], s6 offen lds
    s_add_u32 s6, s6, 128
    s_mov_b32 m0, s34
    s_add_u32 s34, s34, 4096
    buffer_load_dwordx4 v12, s[52:55], s7 offen lds
    s_add_u32 s7, s7, 128
    s_mov_b32 m0, s34
    s_add_u32 s34, s34, 4096
    buffer_load_dwordx4 v12, s[52:55], s7 offen lds
    s_add_u32 s7, s7, 128
    s_mov_b32 m0, s34
    s_add_u32 s34, s34, 4096
    buffer_load_dwordx4 v12, s[52:55], s7 offen lds
    s_add_u32 s7, s7, 128
    s_mov_b32 m0, s34
    s_add_u32 s34, s34, 4096
    buffer_load_dwordx4 v12, s[52:55], s7 offen lds
    s_add_u32 s7, s7, 128
    s_mov_b32 m0, s34
    s_add_u32 s34, s34, 4096
    buffer_load_dwordx4 v12, s[52:55], s7 offen lds
    s_add_u32 s7, s7, 128
    s_mov_b32 m0, s34
    s_add_u32 s34, s34, 4096
    buffer_load_dwordx4 v12, s[52:55], s7 offen lds
    s_add_u32 s7, s7, 128
    s_mov_b32 m0, s34
    s_add_u32 s34, s34, 4096
    buffer_load_dwordx4 v12, s[52:55], s7 offen lds
    s_add_u32 s7, s7, 128
    s_mov_b32 m0, s34
    s_add_u32 s34, s34, 4096
    buffer_load_dwordx4 v12, s[52:55], s7 offen lds
    s_add_u32 s7, s7, 128
    s_mov_b32 m0, s34
    s_add_u32 s34, s34, 4096
    buffer_load_dwordx4 v12, s[52:55], s7 offen lds
    s_add_u32 s7, s7, 128
    s_mov_b32 m0, s34
    s_add_u32 s34, s34, 4096
    buffer_load_dwordx4 v10, s[8:11], s94 offen lds
    s_mov_b32 m0, s34
    s_add_u32 s34, s34, 4096
    buffer_load_dwordx4 v10, s[8:11], s95 offen lds
    s_mov_b32 m0, s34
    s_add_u32 s34, s34, 4096
    buffer_load_dwordx4 v10, s[8:11], s96 offen lds
    s_mov_b32 m0, s34
    s_add_u32 s34, s34, 4096
    buffer_load_dwordx4 v10, s[8:11], s97 offen lds
    v_lshrrev_b32 v4, 2, v2
    v_lshlrev_b32 v3, 7, v4
    v_and_b32 v5, 3, v2
    v_lshl_add_u32 v3, v5, 3, v3
    v_bfe_u32 v5, v2, 3, 2
    v_lshlrev_b32 v9, 4, v2
    s_lshl_b32 s31, s28, 2
    s_add_u32 s31, s31, s30
    s_mul_i32 s32, s31, 331776
    v_xor_b32 v5, s30, v5
    v_lshl_add_u32 v3, v5, 5, v3
    s_add_u32 s44, s22, s32
    s_addc_u32 s45, s23, 0
    s_and_b32 s45, s45, 0xffff
    s_mov_b32 s46, 331776
    s_mov_b32 s47, 0x20000
    s_mul_i32 s32, s31, 10368
    s_add_u32 s32, s32, 13238272
    s_add_u32 s48, s22, s32
    s_addc_u32 s49, s23, 0
    s_and_b32 s49, s49, 0xffff
    s_mov_b32 s50, 10368
    s_mov_b32 s51, 0x20000
    v_and_b32 v7, 15, v2
    v_and_b32 v8, 48, v2
    v_lshl_add_u32 v11, v7, 6, v8
    v_cmp_lt_u32 vcc, 8, v7
    v_mov_b32 v8, 0x100000
    v_mov_b32 v20, 0x3f803f80
    v_cndmask_b32 v11, v11, v8, vcc
    v_mov_b32 v21, v20
    v_mov_b32 v22, v20
    v_mov_b32 v23, v20
    s_lshl_b32 s38, s28, 4
    s_add_u32 s38, s38, s39
    s_lshl_b32 s38, s38, 7
    s_add_u32 s38, s38, 20480
    s_mov_b32 s35, s39
    s_waitcnt vmcnt(0)
    s_barrier
    s_sub_u32 s36, s39, 4
    s_cmp_lt_u32 s36, 2
    s_cselect_b32 s46, 0, s46
    s_lshr_b32 s36, s35, 1
    s_mul_i32 s36, s36, 18
    s_and_b32 s37, s35, 1
    s_add_u32 s36, s36, s37
    s_lshl_b32 s36, s36, 10
    ds_read_b64_tr_b16 v[128:129], v3 offset:0
    ds_read_b64_tr_b16 v[130:131], v3 offset:2048
    ds_read_b64_tr_b16 v[132:133], v3 offset:4096
    ds_read_b64_tr_b16 v[134:135], v3 offset:6144
    ds_read_b64_tr_b16 v[136:137], v3 offset:8192
    ds_read_b64_tr_b16 v[138:139], v3 offset:10240
    ds_read_b64_tr_b16 v[140:141], v3 offset:12288
    ds_read_b64_tr_b16 v[142:143], v3 offset:14336
    ds_read_b64_tr_b16 v[144:145], v3 offset:16384
    ds_read_b64_tr_b16 v[146:147], v3 offset:18432
    ds_read_b64_tr_b16 v[148:149], v3 offset:20480
    ds_read_b64_tr_b16 v[150:151], v3 offset:22528
    ds_read_b64_tr_b16 v[152:153], v3 offset:24576
    ds_read_b64_tr_b16 v[154:155], v3 offset:26624
    s_add_u32 s32, s36, 0
    s_waitcnt lgkmcnt(12)
    buffer_store_dwordx4 v[128:131], v9, s[44:47], s32 offen sc1
    v_mfma_f32_16x16x32_bf16 v[48:51], v[128:131], v[20:23], 0
    ds_read_b64_tr_b16 v[156:157], v3 offset:28672
    ds_read_b64_tr_b16 v[158:159], v3 offset:30720
    s_add_u32 s32, s36, 2048
    s_waitcnt lgkmcnt(12)
    buffer_store_dwordx4 v[132:135], v9, s[44:47], s32 offen sc1
    v_mfma_f32_16x16x32_bf16 v[52:55], v[132:135], v[20:23], 0
    ds_read_b64_tr_b16 v[160:161], v3 offset:32768
    ds_read_b64_tr_b16 v[162:163], v3 offset:34816
    s_add_u32 s32, s36, 4096
    s_waitcnt lgkmcnt(12)
    buffer_store_dwordx4 v[136:139], v9, s[44:47], s32 offen sc1
    v_mfma_f32_16x16x32_bf16 v[56:59], v[136:139], v[20:23], 0
    s_add_u32 s32, s36, 6144
    s_waitcnt lgkmcnt(10)
    buffer_store_dwordx4 v[140:143], v9, s[44:47], s32 offen sc1
    v_mfma_f32_16x16x32_bf16 v[60:63], v[140:143], v[20:23], 0
    s_add_u32 s32, s36, 8192
    s_waitcnt lgkmcnt(8)
    buffer_store_dwordx4 v[144:147], v9, s[44:47], s32 offen sc1
    v_mfma_f32_16x16x32_bf16 v[64:67], v[144:147], v[20:23], 0
    s_add_u32 s32, s36, 10240
    s_waitcnt lgkmcnt(6)
    buffer_store_dwordx4 v[148:151], v9, s[44:47], s32 offen sc1
    v_mfma_f32_16x16x32_bf16 v[68:71], v[148:151], v[20:23], 0
    s_add_u32 s32, s36, 12288
    s_waitcnt lgkmcnt(4)
    buffer_store_dwordx4 v[152:155], v9, s[44:47], s32 offen sc1
    v_mfma_f32_16x16x32_bf16 v[72:75], v[152:155], v[20:23], 0
    s_add_u32 s32, s36, 14336
    s_waitcnt lgkmcnt(2)
    buffer_store_dwordx4 v[156:159], v9, s[44:47], s32 offen sc1
    v_mfma_f32_16x16x32_bf16 v[76:79], v[156:159], v[20:23], 0
    s_add_u32 s32, s36, 16384
    s_waitcnt lgkmcnt(0)
    buffer_store_dwordx4 v[160:163], v9, s[44:47], s32 offen sc1
    v_mfma_f32_16x16x32_bf16 v[80:83], v[160:163], v[20:23], 0
    s_mov_b32 exec_lo, 0x20002
    s_mov_b32 exec_hi, 0x20002
    v_mov_b64 v[48:49], v[52:53]
    v_mov_b64 v[50:51], v[54:55]
    s_mov_b32 exec_lo, 0x40004
    s_mov_b32 exec_hi, 0x40004
    v_mov_b64 v[48:49], v[56:57]
    v_mov_b64 v[50:51], v[58:59]
    s_mov_b32 exec_lo, 0x80008
    s_mov_b32 exec_hi, 0x80008
    v_mov_b64 v[48:49], v[60:61]
    v_mov_b64 v[50:51], v[62:63]
    s_mov_b32 exec_lo, 0x100010
    s_mov_b32 exec_hi, 0x100010
    v_mov_b64 v[48:49], v[64:65]
    v_mov_b64 v[50:51], v[66:67]
    s_mov_b32 exec_lo, 0x200020
    s_mov_b32 exec_hi, 0x200020
    v_mov_b64 v[48:49], v[68:69]
    v_mov_b64 v[50:51], v[70:71]
    s_mov_b32 exec_lo, 0x400040
    s_mov_b32 exec_hi, 0x400040
    v_mov_b64 v[48:49], v[72:73]
    v_mov_b64 v[50:51], v[74:75]
    s_mov_b32 exec_lo, 0x800080
    s_mov_b32 exec_hi, 0x800080
    v_mov_b64 v[48:49], v[76:77]
    v_mov_b64 v[50:51], v[78:79]
    s_mov_b32 exec_lo, 0x1000100
    s_mov_b32 exec_hi, 0x1000100
    v_mov_b64 v[48:49], v[80:81]
    v_mov_b64 v[50:51], v[82:83]
    s_mov_b64 exec, -1
    s_mul_i32 s32, s35, 576
    buffer_store_dwordx4 v[48:51], v11, s[48:51], s32 offen sc1
    v_add_u32 v3, 36864, v3
    s_mov_b32 s46, 331776
    s_add_u32 s35, s39, 14
    s_lshr_b32 s36, s35, 1
    s_mul_i32 s36, s36, 18
    s_and_b32 s37, s35, 1
    s_add_u32 s36, s36, s37
    s_add_u32 s37, s35, 144
    s_cmp_lt_u32 s35, 18
    s_cselect_b32 s36, s36, s37
    s_lshl_b32 s36, s36, 10
    ds_read_b64_tr_b16 v[128:129], v3 offset:0
    ds_read_b64_tr_b16 v[130:131], v3 offset:2048
    ds_read_b64_tr_b16 v[132:133], v3 offset:4096
    ds_read_b64_tr_b16 v[134:135], v3 offset:6144
    ds_read_b64_tr_b16 v[136:137], v3 offset:8192
    ds_read_b64_tr_b16 v[138:139], v3 offset:10240
    ds_read_b64_tr_b16 v[140:141], v3 offset:12288
    ds_read_b64_tr_b16 v[142:143], v3 offset:14336
    ds_read_b64_tr_b16 v[144:145], v3 offset:16384
    ds_read_b64_tr_b16 v[146:147], v3 offset:18432
    ds_read_b64_tr_b16 v[148:149], v3 offset:20480
    ds_read_b64_tr_b16 v[150:151], v3 offset:22528
    ds_read_b64_tr_b16 v[152:153], v3 offset:24576
    ds_read_b64_tr_b16 v[154:155], v3 offset:26624
    s_sub_u32 s32, -1, s28
    s_and_b32 s32, s32, 7
    s_add_u32 s32, s32, 1
    s_mul_i32 s32, s32, 18432
    s_cmp_lt_u32 s35, 18
    s_cselect_b32 s32, 0, s32
    s_add_u32 s32, s32, s36
    s_waitcnt lgkmcnt(12)
    buffer_store_dwordx4 v[128:131], v9, s[44:47], s32 offen sc1
    v_mfma_f32_16x16x32_bf16 v[48:51], v[128:131], v[20:23], 0
    ds_read_b64_tr_b16 v[156:157], v3 offset:28672
    ds_read_b64_tr_b16 v[158:159], v3 offset:30720
    s_sub_u32 s32, 0, s28
    s_and_b32 s32, s32, 7
    s_add_u32 s32, s32, 1
    s_mul_i32 s32, s32, 18432
    s_cmp_lt_u32 s35, 18
    s_cselect_b32 s32, 2048, s32
    s_add_u32 s32, s32, s36
    s_waitcnt lgkmcnt(12)
    buffer_store_dwordx4 v[132:135], v9, s[44:47], s32 offen sc1
    v_mfma_f32_16x16x32_bf16 v[52:55], v[132:135], v[20:23], 0
    ds_read_b64_tr_b16 v[160:161], v3 offset:32768
    ds_read_b64_tr_b16 v[162:163], v3 offset:34816
    s_sub_u32 s32, 1, s28
    s_and_b32 s32, s32, 7
    s_add_u32 s32, s32, 1
    s_mul_i32 s32, s32, 18432
    s_cmp_lt_u32 s35, 18
    s_cselect_b32 s32, 4096, s32
    s_add_u32 s32, s32, s36
    s_waitcnt lgkmcnt(12)
    buffer_store_dwordx4 v[136:139], v9, s[44:47], s32 offen sc1
    v_mfma_f32_16x16x32_bf16 v[56:59], v[136:139], v[20:23], 0
    s_sub_u32 s32, 2, s28
    s_and_b32 s32, s32, 7
    s_add_u32 s32, s32, 1
    s_mul_i32 s32, s32, 18432
    s_cmp_lt_u32 s35, 18
    s_cselect_b32 s32, 6144, s32
    s_add_u32 s32, s32, s36
    s_waitcnt lgkmcnt(10)
    buffer_store_dwordx4 v[140:143], v9, s[44:47], s32 offen sc1
    v_mfma_f32_16x16x32_bf16 v[60:63], v[140:143], v[20:23], 0
    s_sub_u32 s32, 3, s28
    s_and_b32 s32, s32, 7
    s_add_u32 s32, s32, 1
    s_mul_i32 s32, s32, 18432
    s_cmp_lt_u32 s35, 18
    s_cselect_b32 s32, 8192, s32
    s_add_u32 s32, s32, s36
    s_waitcnt lgkmcnt(8)
    buffer_store_dwordx4 v[144:147], v9, s[44:47], s32 offen sc1
    v_mfma_f32_16x16x32_bf16 v[64:67], v[144:147], v[20:23], 0
    s_sub_u32 s32, 4, s28
    s_and_b32 s32, s32, 7
    s_add_u32 s32, s32, 1
    s_mul_i32 s32, s32, 18432
    s_cmp_lt_u32 s35, 18
    s_cselect_b32 s32, 10240, s32
    s_add_u32 s32, s32, s36
    s_waitcnt lgkmcnt(6)
    buffer_store_dwordx4 v[148:151], v9, s[44:47], s32 offen sc1
    v_mfma_f32_16x16x32_bf16 v[68:71], v[148:151], v[20:23], 0
    s_sub_u32 s32, 5, s28
    s_and_b32 s32, s32, 7
    s_add_u32 s32, s32, 1
    s_mul_i32 s32, s32, 18432
    s_cmp_lt_u32 s35, 18
    s_cselect_b32 s32, 12288, s32
    s_add_u32 s32, s32, s36
    s_waitcnt lgkmcnt(4)
    buffer_store_dwordx4 v[152:155], v9, s[44:47], s32 offen sc1
    v_mfma_f32_16x16x32_bf16 v[72:75], v[152:155], v[20:23], 0
    s_sub_u32 s32, 6, s28
    s_and_b32 s32, s32, 7
    s_add_u32 s32, s32, 1
    s_mul_i32 s32, s32, 18432
    s_cmp_lt_u32 s35, 18
    s_cselect_b32 s32, 14336, s32
    s_add_u32 s32, s32, s36
    s_waitcnt lgkmcnt(2)
    buffer_store_dwordx4 v[156:159], v9, s[44:47], s32 offen sc1
    v_mfma_f32_16x16x32_bf16 v[76:79], v[156:159], v[20:23], 0
    s_mov_b32 s32, 0
    s_cmp_lt_u32 s35, 18
    s_cselect_b32 s32, 16384, s32
    s_add_u32 s32, s32, s36
    s_waitcnt lgkmcnt(0)
    buffer_store_dwordx4 v[160:163], v9, s[44:47], s32 offen sc1
    v_mfma_f32_16x16x32_bf16 v[80:83], v[160:163], v[20:23], 0
    s_mov_b32 exec_lo, 0x20002
    s_mov_b32 exec_hi, 0x20002
    v_mov_b64 v[48:49], v[52:53]
    v_mov_b64 v[50:51], v[54:55]
    s_mov_b32 exec_lo, 0x40004
    s_mov_b32 exec_hi, 0x40004
    v_mov_b64 v[48:49], v[56:57]
    v_mov_b64 v[50:51], v[58:59]
    s_mov_b32 exec_lo, 0x80008
    s_mov_b32 exec_hi, 0x80008
    v_mov_b64 v[48:49], v[60:61]
    v_mov_b64 v[50:51], v[62:63]
    s_mov_b32 exec_lo, 0x100010
    s_mov_b32 exec_hi, 0x100010
    v_mov_b64 v[48:49], v[64:65]
    v_mov_b64 v[50:51], v[66:67]
    s_mov_b32 exec_lo, 0x200020
    s_mov_b32 exec_hi, 0x200020
    v_mov_b64 v[48:49], v[68:69]
    v_mov_b64 v[50:51], v[70:71]
    s_mov_b32 exec_lo, 0x400040
    s_mov_b32 exec_hi, 0x400040
    v_mov_b64 v[48:49], v[72:73]
    v_mov_b64 v[50:51], v[74:75]
    s_mov_b32 exec_lo, 0x800080
    s_mov_b32 exec_hi, 0x800080
    v_mov_b64 v[48:49], v[76:77]
    v_mov_b64 v[50:51], v[78:79]
    s_mov_b32 exec_lo, 0x1000100
    s_mov_b32 exec_hi, 0x1000100
    v_mov_b64 v[48:49], v[80:81]
    v_mov_b64 v[50:51], v[82:83]
    s_mov_b64 exec, -1
    s_mul_i32 s32, s35, 576
    buffer_store_dwordx4 v[48:51], v11, s[48:51], s32 offen sc1
    v_add_u32 v3, 36864, v3
    v_readlane_b32 s94, v1, 0
    ds_read_b64_tr_b16 v[192:193], v3 offset:0
    ds_read_b64_tr_b16 v[194:195], v3 offset:2048
    v_readlane_b32 s95, v1, 8
    ds_read_b64_tr_b16 v[196:197], v3 offset:4096
    ds_read_b64_tr_b16 v[198:199], v3 offset:6144
    v_readlane_b32 s96, v1, 16
    ds_read_b64_tr_b16 v[200:201], v3 offset:8192
    ds_read_b64_tr_b16 v[202:203], v3 offset:10240
    v_readlane_b32 s97, v1, 24
    ds_read_b64_tr_b16 v[204:205], v3 offset:12288
    ds_read_b64_tr_b16 v[206:207], v3 offset:14336
    s_waitcnt lgkmcnt(6)
    buffer_store_dwordx4 v[192:195], v9, s[44:47], s94 offen sc1
    s_waitcnt lgkmcnt(4)
    buffer_store_dwordx4 v[196:199], v9, s[44:47], s95 offen sc1
    s_waitcnt lgkmcnt(2)
    buffer_store_dwordx4 v[200:203], v9, s[44:47], s96 offen sc1
    s_waitcnt lgkmcnt(0)
    buffer_store_dwordx4 v[204:207], v9, s[44:47], s97 offen sc1
    s_mov_b32 s61, s38
    v_lshlrev_b32 v9, 4, v2
    s_lshl_b32 s31, s28, 2
    s_add_u32 s31, s31, s30
    s_mul_i32 s32, s31, 331776
    s_add_u32 s12, s22, s32
    s_addc_u32 s13, s23, 0
    s_and_b32 s13, s13, 0xffff
    s_mov_b32 s14, 331776
    s_mov_b32 s15, 0x20000
    s_add_u32 s16, s22, 10682368
    s_addc_u32 s17, s23, 0
    s_and_b32 s17, s17, 0xffff
    s_mov_b32 s18, 57344
    s_mov_b32 s19, 0x20000
    s_add_u32 s8, s22, 10747904
    s_addc_u32 s9, s23, 0
    s_and_b32 s9, s9, 0xffff
    s_mov_b32 s10, 2359296
    s_mov_b32 s11, 0x20000
    s_lshl_b32 s35, s28, 11
    s_add_u32 s35, s35, 20480
    v_min_u32 v3, 13, v2
    v_lshlrev_b32 v3, 7, v3
    s_mov_b32 s40, 0
    v_lshrrev_b32 v7, 3, v2
    v_mul_u32_u24 v6, 4096, v7
    v_bfe_u32 v7, v2, 1, 2
    v_bfe_u32 v8, v2, 4, 2
    v_xor_b32 v7, v7, v8
    v_lshl_add_u32 v6, v7, 5, v6
    v_and_b32 v7, 1, v2
    v_lshl_add_u32 v6, v7, 4, v6
    v_lshrrev_b32 v7, 2, v2
    v_lshlrev_b32 v4, 7, v7
    v_and_b32 v5, 3, v2
    v_lshl_add_u32 v4, v5, 3, v4
    v_bfe_u32 v5, v2, 3, 2
    s_xor_b32 s36, s30, 0
    v_xor_b32 v7, s36, v5
    v_lshl_add_u32 v10, v7, 5, v4
    s_xor_b32 s36, s30, 1
    v_xor_b32 v7, s36, v5
    v_lshl_add_u32 v11, v7, 5, v4
    s_xor_b32 s36, s30, 2
    v_xor_b32 v7, s36, v5
    v_lshl_add_u32 v12, v7, 5, v4
    s_xor_b32 s36, s30, 3
    v_xor_b32 v7, s36, v5
    v_lshl_add_u32 v13, v7, 5, v4
    v_min_u32 v4, 35, v2
    v_lshlrev_b32 v4, 4, v4
    v_lshrrev_b32 v7, 3, v2
    v_mul_u32_u24 v33, 5120, v7
    v_add_u32 v33, v33, v6
    v_mul_u32_u24 v32, 2944, v7
    v_sub_u32 v32, v6, v32
    v_add_u32 v46, 73728, v10
    v_add_u32 v47, 110592, v10
    s_lshl_b32 s37, s29, 16
    s_add_u32 s37, s37, 13631488
    s_add_u32 s4, s22, s37
    s_addc_u32 s5, s23, 0
    s_and_b32 s5, s5, 0xffff
    s_mov_b32 s6, 14745600
    s_mov_b32 s7, 0x20000
    v_mov_b32 v36, -1
    v_mov_b32 v37, -1
    v_mov_b32 v38, -1
    v_mov_b32 v39, -1
    s_lshl_b32 s37, s31, 11
    s_add_u32 s37, s37, 14680064
    buffer_store_dwordx4 v[36:39], v9, s[4:7], s37 offen offset:0 sc1
    buffer_store_dwordx4 v[36:39], v9, s[4:7], s37 offen offset:1024 sc1
    v_lshlrev_b32 v14, 16, v0
    s_branch L_join
.fill 400, 4, 0xbf810000
.section .rodata,"a"
.p2align 6
.amdhsa_kernel sequential_preLN__ssm_conv_s4__dense_activation_relu__prompt_kernel
  .amdhsa_next_free_vgpr 512
  .amdhsa_next_free_sgpr 100
  .amdhsa_accum_offset 256
  .amdhsa_group_segment_fixed_size 0
  .amdhsa_kernarg_size 120
  .amdhsa_user_sgpr_count 2
  .amdhsa_user_sgpr_kernarg_segment_ptr 1
  .amdhsa_system_sgpr_workgroup_id_x 1
  .amdhsa_float_denorm_mode_32 3
.end_amdhsa_kernel
```
